```python
import torch

def _softmax(x, axis=-1):
    return torch.softmax(x, dim=axis)
def _gelu(x):
    return torch.nn.functional.gelu(x, approximate="tanh")
def _silu(x):
    return torch.nn.functional.silu(x)
def _sigmoid(x):
    return torch.sigmoid(x)
def _layernorm(x, axis=-1, eps=1e-5):
    m = x.mean(dim=axis, keepdim=True)
    v = x.var(dim=axis, keepdim=True, unbiased=False)
    return (x - m) / torch.sqrt(v + eps)
def _scatter_add(tgt, idx, src, axis=0):
    return tgt.clone().index_add_(axis, idx, src)
def _segment_sum(src, seg, n):
    out = torch.zeros((n,) + src.shape[1:], dtype=src.dtype)
    return out.index_add_(0, seg, src)
def _pad(x, pw):
    flat = tuple(v for pair in reversed(pw) for v in pair)
    return torch.nn.functional.pad(x, flat)

kernel_name = 'interleave_layers__linear_attn_block__dense_activation_silu__prompt'

def setup_inputs():

    _w = (lambda a: (lambda t: t.to(torch.bfloat16) if t.is_floating_point() else t)(torch.as_tensor(a)))
    def _A_setup():
        B, S, D = 1, 2048, 1024
        return {
            "x": _w((lambda *s: torch.randn(*s, dtype=torch.bfloat16) * 0.05)(B, S, D)),
            "wqkv": _w((lambda *s: torch.randn(*s, dtype=torch.bfloat16) * 0.05)(D, 3 * D)),
            "wo": _w((lambda *s: torch.randn(*s, dtype=torch.bfloat16) * 0.05)(D, D)),
        }
    _A_in = _A_setup()

    def _B_setup():
        B, S, D, F = 1, 2048, 1024, 3584
        return {
            "x": _w((lambda *s: torch.randn(*s, dtype=torch.bfloat16) * 0.05)(B, S, D)),
            "w1": _w((lambda *s: torch.randn(*s, dtype=torch.bfloat16) * 3.2)(D, F) * (D ** -0.5)),
            "w2": _w((lambda *s: torch.randn(*s, dtype=torch.bfloat16) * 0.8)(F, D) * (F ** -0.5)),
        }
    _B_in = _B_setup()

    return {
        "A_x": _A_in["x"],
        "A_wqkv": _A_in["wqkv"],
        "A_wo": _A_in["wo"],
        "B_x": _B_in["x"],
        "B_w1": _B_in["w1"],
        "B_w2": _B_in["w2"],
    }

def reference(A_x, A_wqkv, A_wo, B_x, B_w1, B_w2):
    def _A_ref(x, wqkv, wo):
        B, S, D = x.shape
        H = 32; Dh = D // H
        qkv = (lambda x, *d: x.permute(*d))((x @ wqkv).reshape(B, S, 3, H, Dh), 2, 0, 3, 1, 4)
        q, k, v = qkv[0], qkv[1], qkv[2]
        phi = lambda t: torch.where(t > 0, t + 1, torch.exp(t)) + 1e-6
        pq, pk = phi(q), phi(k)
        kv = torch.einsum("bhsd,bhse->bhde", pk, v)
        z = torch.einsum("bhsd->bhd", pk)
        num = torch.einsum("bhqd,bhde->bhqe", pq, kv)
        den = torch.einsum("bhqd,bhd->bhq", pq, z)[..., None] + 1e-6
        o = num / den
        return (lambda x, *d: x.permute(*d))(o, 0, 2, 1, 3).reshape(B, S, D) @ wo

    def _B_ref(x, w1, w2):
        h = torch.einsum("bsd,df->bsf", x, w1)
        h = _silu(h)
        out = torch.einsum("bsf,fd->bsd", h, w2)
        return out

    x = A_x
    x = x + _A_ref(_layernorm(x, axis=-1), A_wqkv, A_wo)
    x = x + _B_ref(_layernorm(x, axis=-1), B_w1, B_w2)
    x = x + _A_ref(_layernorm(x, axis=-1), A_wqkv, A_wo)
    x = x + _B_ref(_layernorm(x, axis=-1), B_w1, B_w2)
    return x
```

```asm
; @launch grid=(256,1,1) block=(512,1,1) lds=155776
.amdgcn_target "amdgcn-amd-amdhsa--gfx950"
.text
.globl interleave_layers__linear_attn_block__dense_activation_silu__prompt_kernel
.p2align 8
.type interleave_layers__linear_attn_block__dense_activation_silu__prompt_kernel,@function
interleave_layers__linear_attn_block__dense_activation_silu__prompt_kernel:
    s_cmp_ge_u32 s2, 256
    s_cbranch_scc1 L_end_1
    s_load_dwordx16 s[48:63], s[0:1], 0
    s_load_dwordx2 s[64:65], s[0:1], 64
    v_lshrrev_b32 v1, 6, v0
    s_nop 0
    v_readfirstlane_b32 s3, v1
    s_waitcnt lgkmcnt(0)
    s_add_u32 s88, s64, 0x3f00000
    s_addc_u32 s89, s65, 0
    s_mov_b32 s90, 0x100000
    s_mov_b32 s91, 0x20000
    s_cmp_ge_u32 s3, 4
    s_cbranch_scc1 L_loader_2
    s_and_b32 s37, s2, 1
    s_lshl_b32 s37, s37, 3
    s_bfe_u32 s38, s2, 0x30003
    s_add_u32 s4, s37, s38
    s_bfe_u32 s37, s2, 0x20001
    s_lshl_b32 s37, s37, 2
    s_lshr_b32 s38, s2, 6
    s_add_u32 s5, s37, s38
    s_add_u32 s39, s4, s5
    s_and_b32 s39, s39, 15
    v_and_b32 v1, 63, v0
    s_mov_b32 s8, s48
    s_mov_b32 s9, s49
    s_mov_b32 s10, 0x400000
    s_mov_b32 s11, 0x20000
    s_mov_b32 s12, s50
    s_mov_b32 s13, s51
    s_mov_b32 s14, 0x600000
    s_mov_b32 s15, 0x20000
    s_cmp_ge_u32 s3, 2
    s_cbranch_scc1 L_ew_3
    s_lshl_b32 s37, s4, 7
    s_lshl_b32 s38, s3, 6
    s_add_u32 s37, s37, s38
    v_add_u32 v2, s37, v1
    v_lshlrev_b32 v2, 11, v2
    s_lshl_b32 s38, s39, 7
    buffer_load_dword v253, v2, s[8:11], s38 offen sc1
    s_branch L_ee_4
L_ew_3:
    s_lshl_b32 s37, s39, 6
    v_add_u32 v2, s37, v1
    v_mul_u32_u24 v2, 6144, v2
    s_sub_u32 s38, s3, 2
    s_lshl_b32 s38, s38, 11
    s_lshl_b32 s37, s5, 7
    s_add_u32 s38, s38, s37
    buffer_load_dword v253, v2, s[12:15], s38 offen
L_ee_4:
    s_lshl_b32 s37, s39, 6
    s_lshl_b32 s38, s3, 4
    s_add_u32 s37, s37, s38
    v_lshrrev_b32 v2, 2, v1
    v_add_u32 v2, s37, v2
    v_mul_u32_u24 v2, 6144, v2
    s_lshl_b32 s38, s5, 7
    s_add_u32 s38, s38, 4096
    buffer_load_dword v253, v2, s[12:15], s38 offen
    v_mov_b32 v1, 155648
    v_mov_b32 v2, 0
    ds_write_b32 v1, v2
    s_and_b32 s37, s2, 1
    s_lshl_b32 s37, s37, 3
    s_bfe_u32 s38, s2, 0x30003
    s_add_u32 s4, s37, s38
    s_bfe_u32 s37, s2, 0x20001
    s_lshl_b32 s37, s37, 2
    s_lshr_b32 s38, s2, 6
    s_add_u32 s5, s37, s38
    v_and_b32 v1, 63, v0
    s_lshr_b32 s6, s3, 1
    s_and_b32 s7, s3, 1
    s_mul_i32 s39, s6, 8192
    v_and_b32 v2, 15, v1
    v_lshrrev_b32 v3, 1, v2
    v_lshlrev_b32 v2, 7, v2
    v_add_u32 v2, s39, v2
    v_lshrrev_b32 v4, 4, v1
    v_xor_b32 v3, v3, v4
    v_lshl_add_u32 v4, v3, 4, v2
    v_xor_b32 v5, 64, v4
    v_lshrrev_b32 v2, 4, v1
    v_lshlrev_b32 v2, 3, v2
    v_bfe_u32 v3, v1, 2, 2
    v_add_u32 v104, v2, v3
    v_bfe_u32 v105, v1, 3, 1
    v_lshlrev_b32 v105, 1, v105
    v_bfe_u32 v3, v1, 4, 1
    v_lshl_add_u32 v105, v3, 2, v105
    v_bfe_u32 v3, v1, 1, 1
    s_lshl_b32 s39, s7, 2
    s_add_u32 s39, s39, 0
    v_add_u32 v3, s39, v3
    v_xor_b32 v3, v3, v105
    v_lshlrev_b32 v3, 4, v3
    v_lshl_add_u32 v3, v104, 7, v3
    v_and_b32 v2, 1, v1
    v_lshl_add_u32 v3, v2, 3, v3
    v_add_u32 v6, 16384, v3
    v_bfe_u32 v3, v1, 1, 1
    s_lshl_b32 s39, s7, 2
    s_add_u32 s39, s39, 2
    v_add_u32 v3, s39, v3
    v_xor_b32 v3, v3, v105
    v_lshlrev_b32 v3, 4, v3
    v_lshl_add_u32 v3, v104, 7, v3
    v_and_b32 v2, 1, v1
    v_lshl_add_u32 v3, v2, 3, v3
    v_add_u32 v7, 16384, v3
    v_mov_b32 v8, 0
    v_mov_b32 v9, 0
    v_mov_b32 v10, 0
    v_mov_b32 v11, 0
    v_mov_b32 v12, 0
    v_mov_b32 v13, 0
    v_mov_b32 v14, 0
    v_mov_b32 v15, 0
    v_mov_b32 v16, 0
    v_mov_b32 v17, 0
    v_mov_b32 v18, 0
    v_mov_b32 v19, 0
    v_mov_b32 v20, 0
    v_mov_b32 v21, 0
    v_mov_b32 v22, 0
    v_mov_b32 v23, 0
    v_mov_b32 v24, 0
    v_mov_b32 v25, 0
    v_mov_b32 v26, 0
    v_mov_b32 v27, 0
    v_mov_b32 v28, 0
    v_mov_b32 v29, 0
    v_mov_b32 v30, 0
    v_mov_b32 v31, 0
    v_mov_b32 v32, 0
    v_mov_b32 v33, 0
    v_mov_b32 v34, 0
    v_mov_b32 v35, 0
    v_mov_b32 v36, 0
    v_mov_b32 v37, 0
    v_mov_b32 v38, 0
    v_mov_b32 v39, 0
    v_mov_b32 v40, 0
    v_mov_b32 v41, 0
    v_mov_b32 v42, 0
    v_mov_b32 v43, 0
    v_mov_b32 v44, 0
    v_mov_b32 v45, 0
    v_mov_b32 v46, 0
    v_mov_b32 v47, 0
    v_mov_b32 v48, 0
    v_mov_b32 v49, 0
    v_mov_b32 v50, 0
    v_mov_b32 v51, 0
    v_mov_b32 v52, 0
    v_mov_b32 v53, 0
    v_mov_b32 v54, 0
    v_mov_b32 v55, 0
    v_mov_b32 v56, 0
    v_mov_b32 v57, 0
    v_mov_b32 v58, 0
    v_mov_b32 v59, 0
    v_mov_b32 v60, 0
    v_mov_b32 v61, 0
    v_mov_b32 v62, 0
    v_mov_b32 v63, 0
    v_mov_b32 v64, 0
    v_mov_b32 v65, 0
    v_mov_b32 v66, 0
    v_mov_b32 v67, 0
    v_mov_b32 v68, 0
    v_mov_b32 v69, 0
    v_mov_b32 v70, 0
    v_mov_b32 v71, 0
    v_mov_b32 v72, 0
    v_mov_b32 v73, 0
    v_mov_b32 v74, 0
    v_mov_b32 v75, 0
    v_mov_b32 v76, 0
    v_mov_b32 v77, 0
    v_mov_b32 v78, 0
    v_mov_b32 v79, 0
    v_mov_b32 v80, 0
    v_mov_b32 v81, 0
    v_mov_b32 v82, 0
    v_mov_b32 v83, 0
    v_mov_b32 v84, 0
    v_mov_b32 v85, 0
    v_mov_b32 v86, 0
    v_mov_b32 v87, 0
    v_mov_b32 v88, 0
    v_mov_b32 v89, 0
    v_mov_b32 v90, 0
    v_mov_b32 v91, 0
    v_mov_b32 v92, 0
    v_mov_b32 v93, 0
    v_mov_b32 v94, 0
    v_mov_b32 v95, 0
    v_mov_b32 v96, 0
    v_mov_b32 v97, 0
    v_mov_b32 v98, 0
    v_mov_b32 v99, 0
    v_mov_b32 v100, 0
    v_mov_b32 v101, 0
    v_mov_b32 v102, 0
    v_mov_b32 v103, 0
    s_waitcnt lgkmcnt(0)
    s_barrier
    s_mov_b32 s34, 0
    s_mov_b32 s46, -81920
    s_mov_b32 s47, 40960
    s_setprio 2
    s_barrier
    ds_read_b128 v[104:107], v4 offset:0
    ds_read_b64_tr_b16 v[136:137], v6 offset:0
    ds_read_b64_tr_b16 v[138:139], v6 offset:512
    ds_read_b128 v[108:111], v4 offset:2048
    ds_read_b128 v[112:115], v4 offset:4096
    ds_read_b128 v[116:119], v4 offset:6144
    ds_read_b64_tr_b16 v[140:141], v7 offset:0
    ds_read_b64_tr_b16 v[142:143], v7 offset:512
    ds_read_b64_tr_b16 v[144:145], v6 offset:8192
    ds_read_b64_tr_b16 v[146:147], v6 offset:8704
    ds_read_b64_tr_b16 v[148:149], v7 offset:8192
    ds_read_b64_tr_b16 v[150:151], v7 offset:8704
    ds_read_b64_tr_b16 v[152:153], v6 offset:16384
    ds_read_b64_tr_b16 v[154:155], v6 offset:16896
    ds_read_b64_tr_b16 v[156:157], v7 offset:16384
    ds_read_b64_tr_b16 v[158:159], v7 offset:16896
    v_mov_b32 v184, 0x3f803f80
    v_mov_b32 v185, 0x3f803f80
    v_mov_b32 v186, 0x3f803f80
    v_mov_b32 v187, 0x3f803f80
    s_waitcnt lgkmcnt(0)
    v_mfma_f32_16x16x32_bf16 v[8:11], v[136:139], v[104:107], v[8:11]
    ds_read_b128 v[120:123], v5 offset:0
    v_mfma_f32_16x16x32_bf16 v[12:15], v[136:139], v[108:111], v[12:15]
    ds_read_b64_tr_b16 v[160:161], v6 offset:4096
    v_mfma_f32_16x16x32_bf16 v[16:19], v[136:139], v[112:115], v[16:19]
    ds_read_b64_tr_b16 v[162:163], v6 offset:4608
    v_mfma_f32_16x16x32_bf16 v[20:23], v[136:139], v[116:119], v[20:23]
    ds_read_b128 v[124:127], v5 offset:2048
    v_mfma_f32_16x16x32_bf16 v[24:27], v[140:143], v[104:107], v[24:27]
    ds_read_b128 v[128:131], v5 offset:4096
    v_mfma_f32_16x16x32_bf16 v[28:31], v[140:143], v[108:111], v[28:31]
    ds_read_b128 v[132:135], v5 offset:6144
    v_mfma_f32_16x16x32_bf16 v[32:35], v[140:143], v[112:115], v[32:35]
    ds_read_b64_tr_b16 v[164:165], v7 offset:4096
    v_mfma_f32_16x16x32_bf16 v[36:39], v[140:143], v[116:119], v[36:39]
    ds_read_b64_tr_b16 v[166:167], v7 offset:4608
    v_mfma_f32_16x16x32_bf16 v[40:43], v[104:107], v[144:147], v[40:43]
    ds_read_b64_tr_b16 v[168:169], v6 offset:12288
    v_mfma_f32_16x16x32_bf16 v[44:47], v[108:111], v[144:147], v[44:47]
    ds_read_b64_tr_b16 v[170:171], v6 offset:12800
    v_mfma_f32_16x16x32_bf16 v[48:51], v[112:115], v[144:147], v[48:51]
    ds_read_b64_tr_b16 v[172:173], v7 offset:12288
    v_mfma_f32_16x16x32_bf16 v[52:55], v[116:119], v[144:147], v[52:55]
    ds_read_b64_tr_b16 v[174:175], v7 offset:12800
    v_mfma_f32_16x16x32_bf16 v[56:59], v[104:107], v[148:151], v[56:59]
    ds_read_b64_tr_b16 v[176:177], v6 offset:20480
    v_mfma_f32_16x16x32_bf16 v[60:63], v[108:111], v[148:151], v[60:63]
    ds_read_b64_tr_b16 v[178:179], v6 offset:20992
    v_mfma_f32_16x16x32_bf16 v[64:67], v[112:115], v[148:151], v[64:67]
    ds_read_b64_tr_b16 v[180:181], v7 offset:20480
    v_mfma_f32_16x16x32_bf16 v[68:71], v[116:119], v[148:151], v[68:71]
    ds_read_b64_tr_b16 v[182:183], v7 offset:20992
    v_mfma_f32_16x16x32_bf16 v[72:75], v[104:107], v[152:155], v[72:75]
    s_add_u32 s34, s34, 40960
    v_mfma_f32_16x16x32_bf16 v[76:79], v[108:111], v[152:155], v[76:79]
    s_cmp_eq_u32 s34, 122880
    v_mfma_f32_16x16x32_bf16 v[80:83], v[112:115], v[152:155], v[80:83]
    s_cselect_b32 s36, s46, s47
    v_mfma_f32_16x16x32_bf16 v[84:87], v[116:119], v[152:155], v[84:87]
    s_cselect_b32 s34, 0, s34
    v_mfma_f32_16x16x32_bf16 v[88:91], v[104:107], v[156:159], v[88:91]
    v_add_u32 v4, s36, v4
    v_mfma_f32_16x16x32_bf16 v[92:95], v[108:111], v[156:159], v[92:95]
    v_add_u32 v5, s36, v5
    v_mfma_f32_16x16x32_bf16 v[96:99], v[112:115], v[156:159], v[96:99]
    v_add_u32 v6, s36, v6
    v_mfma_f32_16x16x32_bf16 v[100:103], v[116:119], v[156:159], v[100:103]
    v_add_u32 v7, s36, v7
    v_mfma_f32_16x16x32_bf16 v[188:191], v[184:187], v[136:139], 0
    v_mfma_f32_16x16x32_bf16 v[192:195], v[184:187], v[140:143], 0
    v_mfma_f32_16x16x32_bf16 v[196:199], v[184:187], v[144:147], 0
    v_mfma_f32_16x16x32_bf16 v[200:203], v[184:187], v[148:151], 0
    v_mfma_f32_16x16x32_bf16 v[204:207], v[184:187], v[152:155], 0
    v_mfma_f32_16x16x32_bf16 v[208:211], v[184:187], v[156:159], 0
    v_mfma_f32_16x16x32_bf16 v[212:215], v[104:107], v[184:187], 0
    v_mfma_f32_16x16x32_bf16 v[228:231], v[104:107], v[104:107], 0
    v_mfma_f32_16x16x32_bf16 v[216:219], v[108:111], v[184:187], 0
    v_mfma_f32_16x16x32_bf16 v[232:235], v[108:111], v[108:111], 0
    v_mfma_f32_16x16x32_bf16 v[220:223], v[112:115], v[184:187], 0
    v_mfma_f32_16x16x32_bf16 v[236:239], v[112:115], v[112:115], 0
    v_mfma_f32_16x16x32_bf16 v[224:227], v[116:119], v[184:187], 0
    v_mfma_f32_16x16x32_bf16 v[240:243], v[116:119], v[116:119], 0
    s_waitcnt lgkmcnt(0)
    s_barrier
    v_mfma_f32_16x16x32_bf16 v[8:11], v[160:163], v[120:123], v[8:11]
    ds_read_b128 v[104:107], v4 offset:0
    v_mfma_f32_16x16x32_bf16 v[12:15], v[160:163], v[124:127], v[12:15]
    ds_read_b64_tr_b16 v[136:137], v6 offset:0
    v_mfma_f32_16x16x32_bf16 v[16:19], v[160:163], v[128:131], v[16:19]
    ds_read_b64_tr_b16 v[138:139], v6 offset:512
    v_mfma_f32_16x16x32_bf16 v[20:23], v[160:163], v[132:135], v[20:23]
    ds_read_b128 v[108:111], v4 offset:2048
    v_mfma_f32_16x16x32_bf16 v[24:27], v[164:167], v[120:123], v[24:27]
    ds_read_b128 v[112:115], v4 offset:4096
    v_mfma_f32_16x16x32_bf16 v[28:31], v[164:167], v[124:127], v[28:31]
    ds_read_b128 v[116:119], v4 offset:6144
    v_mfma_f32_16x16x32_bf16 v[32:35], v[164:167], v[128:131], v[32:35]
    ds_read_b64_tr_b16 v[140:141], v7 offset:0
    v_mfma_f32_16x16x32_bf16 v[36:39], v[164:167], v[132:135], v[36:39]
    ds_read_b64_tr_b16 v[142:143], v7 offset:512
    v_mfma_f32_16x16x32_bf16 v[40:43], v[120:123], v[168:171], v[40:43]
    ds_read_b64_tr_b16 v[144:145], v6 offset:8192
    v_mfma_f32_16x16x32_bf16 v[44:47], v[124:127], v[168:171], v[44:47]
    ds_read_b64_tr_b16 v[146:147], v6 offset:8704
    v_mfma_f32_16x16x32_bf16 v[48:51], v[128:131], v[168:171], v[48:51]
    ds_read_b64_tr_b16 v[148:149], v7 offset:8192
    v_mfma_f32_16x16x32_bf16 v[52:55], v[132:135], v[168:171], v[52:55]
    ds_read_b64_tr_b16 v[150:151], v7 offset:8704
    v_mfma_f32_16x16x32_bf16 v[56:59], v[120:123], v[172:175], v[56:59]
    ds_read_b64_tr_b16 v[152:153], v6 offset:16384
    v_mfma_f32_16x16x32_bf16 v[60:63], v[124:127], v[172:175], v[60:63]
    ds_read_b64_tr_b16 v[154:155], v6 offset:16896
    v_mfma_f32_16x16x32_bf16 v[64:67], v[128:131], v[172:175], v[64:67]
    ds_read_b64_tr_b16 v[156:157], v7 offset:16384
    v_mfma_f32_16x16x32_bf16 v[68:71], v[132:135], v[172:175], v[68:71]
    ds_read_b64_tr_b16 v[158:159], v7 offset:16896
    v_mfma_f32_16x16x32_bf16 v[72:75], v[120:123], v[176:179], v[72:75]
    v_mfma_f32_16x16x32_bf16 v[76:79], v[124:127], v[176:179], v[76:79]
    v_mfma_f32_16x16x32_bf16 v[80:83], v[128:131], v[176:179], v[80:83]
    v_mfma_f32_16x16x32_bf16 v[84:87], v[132:135], v[176:179], v[84:87]
    v_mfma_f32_16x16x32_bf16 v[88:91], v[120:123], v[180:183], v[88:91]
    v_mfma_f32_16x16x32_bf16 v[92:95], v[124:127], v[180:183], v[92:95]
    v_mfma_f32_16x16x32_bf16 v[96:99], v[128:131], v[180:183], v[96:99]
    v_mfma_f32_16x16x32_bf16 v[100:103], v[132:135], v[180:183], v[100:103]
    v_mfma_f32_16x16x32_bf16 v[188:191], v[184:187], v[160:163], v[188:191]
    v_mfma_f32_16x16x32_bf16 v[192:195], v[184:187], v[164:167], v[192:195]
    v_mfma_f32_16x16x32_bf16 v[196:199], v[184:187], v[168:171], v[196:199]
    v_mfma_f32_16x16x32_bf16 v[200:203], v[184:187], v[172:175], v[200:203]
    v_mfma_f32_16x16x32_bf16 v[204:207], v[184:187], v[176:179], v[204:207]
    v_mfma_f32_16x16x32_bf16 v[208:211], v[184:187], v[180:183], v[208:211]
    v_mfma_f32_16x16x32_bf16 v[212:215], v[120:123], v[184:187], v[212:215]
    v_mfma_f32_16x16x32_bf16 v[228:231], v[120:123], v[120:123], v[228:231]
    v_mfma_f32_16x16x32_bf16 v[216:219], v[124:127], v[184:187], v[216:219]
    v_mfma_f32_16x16x32_bf16 v[232:235], v[124:127], v[124:127], v[232:235]
    v_mfma_f32_16x16x32_bf16 v[220:223], v[128:131], v[184:187], v[220:223]
    v_mfma_f32_16x16x32_bf16 v[236:239], v[128:131], v[128:131], v[236:239]
    v_mfma_f32_16x16x32_bf16 v[224:227], v[132:135], v[184:187], v[224:227]
    v_mfma_f32_16x16x32_bf16 v[240:243], v[132:135], v[132:135], v[240:243]
    s_add_u32 s69, s4, s5
    s_and_b32 s69, s69, 15
    s_cmp_lg_u32 s6, 0
    s_cbranch_scc1 L_nocs_6
    s_add_u32 s16, s64, 0x3e00000
    s_addc_u32 s17, s65, 0
    s_mov_b32 s18, 0x30000
    s_mov_b32 s19, 0x20000
    s_mul_i32 s37, s69, 12288
    s_lshl_b32 s38, s5, 8
    s_add_u32 s37, s37, s38
    s_lshl_b32 s38, s7, 7
    s_add_u32 s68, s37, s38
    v_lshlrev_b32 v2, 2, v1
    v_cmp_le_u32 vcc, 16, v1
    s_nop 1
    v_cndmask_b32 v188, v188, v192, vcc
    v_cndmask_b32 v196, v196, v200, vcc
    v_cndmask_b32 v204, v204, v208, vcc
    s_mov_b32 exec_hi, 0
    s_add_u32 s38, s68, 0
    buffer_store_dword v188, v2, s[16:19], s38 offen sc1
    s_add_u32 s38, s68, 4096
    buffer_store_dword v196, v2, s[16:19], s38 offen sc1
    s_add_u32 s38, s68, 8192
    buffer_store_dword v204, v2, s[16:19], s38 offen sc1
    s_mov_b64 exec, -1
L_nocs_6:
    s_cmp_lg_u32 s7, 0
    s_cbranch_scc1 L_nost_7
    s_add_u32 s24, s64, 0x3c00000
    s_addc_u32 s25, s65, 0
    s_mov_b32 s26, 0x40000
    s_mov_b32 s27, 0x20000
    v_and_b32 v2, 1, v1
    v_cmp_ne_u32 vcc, 0, v2
    s_nop 1
    v_cndmask_b32 v212, v212, v213, vcc
    v_cndmask_b32 v228, v228, v229, vcc
    v_cndmask_b32 v216, v216, v217, vcc
    v_cndmask_b32 v232, v232, v233, vcc
    v_cndmask_b32 v220, v220, v221, vcc
    v_cndmask_b32 v236, v236, v237, vcc
    v_cndmask_b32 v224, v224, v225, vcc
    v_cndmask_b32 v240, v240, v241, vcc
    v_and_b32 v2, 1, v1
    v_cmp_ne_u32 vcc, 0, v2
    s_nop 1
    v_cndmask_b32 v214, v214, v215, vcc
    v_cndmask_b32 v230, v230, v231, vcc
    v_cndmask_b32 v218, v218, v219, vcc
    v_cndmask_b32 v234, v234, v235, vcc
    v_cndmask_b32 v222, v222, v223, vcc
    v_cndmask_b32 v238, v238, v239, vcc
    v_cndmask_b32 v226, v226, v227, vcc
    v_cndmask_b32 v242, v242, v243, vcc
    v_and_b32 v2, 2, v1
    v_cmp_ne_u32 vcc, 0, v2
    s_nop 1
    v_cndmask_b32 v212, v212, v214, vcc
    v_cndmask_b32 v228, v228, v230, vcc
    v_cndmask_b32 v216, v216, v218, vcc
    v_cndmask_b32 v232, v232, v234, vcc
    v_cndmask_b32 v220, v220, v222, vcc
    v_cndmask_b32 v236, v236, v238, vcc
    v_cndmask_b32 v224, v224, v226, vcc
    v_cndmask_b32 v240, v240, v242, vcc
    v_mov_b32 v213, v228
    v_mov_b32 v217, v232
    v_mov_b32 v221, v236
    v_mov_b32 v225, v240
    v_and_b32 v2, 15, v1
    v_lshlrev_b32 v2, 3, v2
    s_lshl_b32 s37, s69, 14
    s_lshl_b32 s38, s4, 10
    s_add_u32 s37, s37, s38
    s_lshl_b32 s38, s6, 9
    s_add_u32 s37, s37, s38
    s_mov_b32 exec_lo, 0x00f0000f
    s_mov_b32 exec_hi, 0xf0000f00
    buffer_store_dwordx2 v[212:213], v2, s[24:27], s37 offen offset:0 sc1
    buffer_store_dwordx2 v[216:217], v2, s[24:27], s37 offen offset:128 sc1
    buffer_store_dwordx2 v[220:221], v2, s[24:27], s37 offen offset:256 sc1
    buffer_store_dwordx2 v[224:225], v2, s[24:27], s37 offen offset:384 sc1
    s_mov_b64 exec, -1
L_nost_7:
    s_mov_b32 s35, 14
    s_waitcnt lgkmcnt(0)
.p2align 6
L_cl_5:
    s_cmp_lg_u32 s35, 13
    s_cbranch_scc1 L_vm_8
    s_waitcnt vmcnt(0)
L_vm_8:
    v_mfma_f32_16x16x32_bf16 v[8:11], v[136:139], v[104:107], v[8:11]
    ds_read_b128 v[120:123], v5 offset:0
    v_mfma_f32_16x16x32_bf16 v[12:15], v[136:139], v[108:111], v[12:15]
    ds_read_b64_tr_b16 v[160:161], v6 offset:4096
    v_mfma_f32_16x16x32_bf16 v[16:19], v[136:139], v[112:115], v[16:19]
    ds_read_b64_tr_b16 v[162:163], v6 offset:4608
    v_mfma_f32_16x16x32_bf16 v[20:23], v[136:139], v[116:119], v[20:23]
    ds_read_b128 v[124:127], v5 offset:2048
    v_mfma_f32_16x16x32_bf16 v[24:27], v[140:143], v[104:107], v[24:27]
    ds_read_b128 v[128:131], v5 offset:4096
    v_mfma_f32_16x16x32_bf16 v[28:31], v[140:143], v[108:111], v[28:31]
    ds_read_b128 v[132:135], v5 offset:6144
    v_mfma_f32_16x16x32_bf16 v[32:35], v[140:143], v[112:115], v[32:35]
    ds_read_b64_tr_b16 v[164:165], v7 offset:4096
    v_mfma_f32_16x16x32_bf16 v[36:39], v[140:143], v[116:119], v[36:39]
    ds_read_b64_tr_b16 v[166:167], v7 offset:4608
    v_mfma_f32_16x16x32_bf16 v[40:43], v[104:107], v[144:147], v[40:43]
    ds_read_b64_tr_b16 v[168:169], v6 offset:12288
    v_mfma_f32_16x16x32_bf16 v[44:47], v[108:111], v[144:147], v[44:47]
    ds_read_b64_tr_b16 v[170:171], v6 offset:12800
    v_mfma_f32_16x16x32_bf16 v[48:51], v[112:115], v[144:147], v[48:51]
    ds_read_b64_tr_b16 v[172:173], v7 offset:12288
    v_mfma_f32_16x16x32_bf16 v[52:55], v[116:119], v[144:147], v[52:55]
    ds_read_b64_tr_b16 v[174:175], v7 offset:12800
    v_mfma_f32_16x16x32_bf16 v[56:59], v[104:107], v[148:151], v[56:59]
    ds_read_b64_tr_b16 v[176:177], v6 offset:20480
    v_mfma_f32_16x16x32_bf16 v[60:63], v[108:111], v[148:151], v[60:63]
    ds_read_b64_tr_b16 v[178:179], v6 offset:20992
    v_mfma_f32_16x16x32_bf16 v[64:67], v[112:115], v[148:151], v[64:67]
    ds_read_b64_tr_b16 v[180:181], v7 offset:20480
    v_mfma_f32_16x16x32_bf16 v[68:71], v[116:119], v[148:151], v[68:71]
    ds_read_b64_tr_b16 v[182:183], v7 offset:20992
    v_mfma_f32_16x16x32_bf16 v[72:75], v[104:107], v[152:155], v[72:75]
    s_add_u32 s34, s34, 40960
    v_mfma_f32_16x16x32_bf16 v[76:79], v[108:111], v[152:155], v[76:79]
    s_cmp_eq_u32 s34, 122880
    v_mfma_f32_16x16x32_bf16 v[80:83], v[112:115], v[152:155], v[80:83]
    s_cselect_b32 s36, s46, s47
    v_mfma_f32_16x16x32_bf16 v[84:87], v[116:119], v[152:155], v[84:87]
    s_cselect_b32 s34, 0, s34
    v_mfma_f32_16x16x32_bf16 v[88:91], v[104:107], v[156:159], v[88:91]
    v_add_u32 v4, s36, v4
    v_mfma_f32_16x16x32_bf16 v[92:95], v[108:111], v[156:159], v[92:95]
    v_add_u32 v5, s36, v5
    v_mfma_f32_16x16x32_bf16 v[96:99], v[112:115], v[156:159], v[96:99]
    v_add_u32 v6, s36, v6
    v_mfma_f32_16x16x32_bf16 v[100:103], v[116:119], v[156:159], v[100:103]
    v_add_u32 v7, s36, v7
    s_waitcnt lgkmcnt(0)
    s_barrier
    v_mfma_f32_16x16x32_bf16 v[8:11], v[160:163], v[120:123], v[8:11]
    ds_read_b128 v[104:107], v4 offset:0
    v_mfma_f32_16x16x32_bf16 v[12:15], v[160:163], v[124:127], v[12:15]
    ds_read_b64_tr_b16 v[136:137], v6 offset:0
    v_mfma_f32_16x16x32_bf16 v[16:19], v[160:163], v[128:131], v[16:19]
    ds_read_b64_tr_b16 v[138:139], v6 offset:512
    v_mfma_f32_16x16x32_bf16 v[20:23], v[160:163], v[132:135], v[20:23]
    ds_read_b128 v[108:111], v4 offset:2048
    v_mfma_f32_16x16x32_bf16 v[24:27], v[164:167], v[120:123], v[24:27]
    ds_read_b128 v[112:115], v4 offset:4096
    v_mfma_f32_16x16x32_bf16 v[28:31], v[164:167], v[124:127], v[28:31]
    ds_read_b128 v[116:119], v4 offset:6144
    v_mfma_f32_16x16x32_bf16 v[32:35], v[164:167], v[128:131], v[32:35]
    ds_read_b64_tr_b16 v[140:141], v7 offset:0
    v_mfma_f32_16x16x32_bf16 v[36:39], v[164:167], v[132:135], v[36:39]
    ds_read_b64_tr_b16 v[142:143], v7 offset:512
    v_mfma_f32_16x16x32_bf16 v[40:43], v[120:123], v[168:171], v[40:43]
    ds_read_b64_tr_b16 v[144:145], v6 offset:8192
    v_mfma_f32_16x16x32_bf16 v[44:47], v[124:127], v[168:171], v[44:47]
    ds_read_b64_tr_b16 v[146:147], v6 offset:8704
    v_mfma_f32_16x16x32_bf16 v[48:51], v[128:131], v[168:171], v[48:51]
    ds_read_b64_tr_b16 v[148:149], v7 offset:8192
    v_mfma_f32_16x16x32_bf16 v[52:55], v[132:135], v[168:171], v[52:55]
    ds_read_b64_tr_b16 v[150:151], v7 offset:8704
    v_mfma_f32_16x16x32_bf16 v[56:59], v[120:123], v[172:175], v[56:59]
    ds_read_b64_tr_b16 v[152:153], v6 offset:16384
    v_mfma_f32_16x16x32_bf16 v[60:63], v[124:127], v[172:175], v[60:63]
    ds_read_b64_tr_b16 v[154:155], v6 offset:16896
    v_mfma_f32_16x16x32_bf16 v[64:67], v[128:131], v[172:175], v[64:67]
    ds_read_b64_tr_b16 v[156:157], v7 offset:16384
    v_mfma_f32_16x16x32_bf16 v[68:71], v[132:135], v[172:175], v[68:71]
    ds_read_b64_tr_b16 v[158:159], v7 offset:16896
    v_mfma_f32_16x16x32_bf16 v[72:75], v[120:123], v[176:179], v[72:75]
    v_mfma_f32_16x16x32_bf16 v[76:79], v[124:127], v[176:179], v[76:79]
    v_mfma_f32_16x16x32_bf16 v[80:83], v[128:131], v[176:179], v[80:83]
    v_mfma_f32_16x16x32_bf16 v[84:87], v[132:135], v[176:179], v[84:87]
    v_mfma_f32_16x16x32_bf16 v[88:91], v[120:123], v[180:183], v[88:91]
    v_mfma_f32_16x16x32_bf16 v[92:95], v[124:127], v[180:183], v[92:95]
    v_mfma_f32_16x16x32_bf16 v[96:99], v[128:131], v[180:183], v[96:99]
    v_mfma_f32_16x16x32_bf16 v[100:103], v[132:135], v[180:183], v[100:103]
    s_sub_u32 s35, s35, 1
    s_cmp_lg_u32 s35, 0
    s_waitcnt lgkmcnt(0)
    s_cbranch_scc1 L_cl_5
    v_mfma_f32_16x16x32_bf16 v[8:11], v[136:139], v[104:107], v[8:11]
    ds_read_b128 v[120:123], v5 offset:0
    v_mfma_f32_16x16x32_bf16 v[12:15], v[136:139], v[108:111], v[12:15]
    ds_read_b64_tr_b16 v[160:161], v6 offset:4096
    v_mfma_f32_16x16x32_bf16 v[16:19], v[136:139], v[112:115], v[16:19]
    ds_read_b64_tr_b16 v[162:163], v6 offset:4608
    v_mfma_f32_16x16x32_bf16 v[20:23], v[136:139], v[116:119], v[20:23]
    ds_read_b128 v[124:127], v5 offset:2048
    v_mfma_f32_16x16x32_bf16 v[24:27], v[140:143], v[104:107], v[24:27]
    ds_read_b128 v[128:131], v5 offset:4096
    v_mfma_f32_16x16x32_bf16 v[28:31], v[140:143], v[108:111], v[28:31]
    ds_read_b128 v[132:135], v5 offset:6144
    v_mfma_f32_16x16x32_bf16 v[32:35], v[140:143], v[112:115], v[32:35]
    ds_read_b64_tr_b16 v[164:165], v7 offset:4096
    v_mfma_f32_16x16x32_bf16 v[36:39], v[140:143], v[116:119], v[36:39]
    ds_read_b64_tr_b16 v[166:167], v7 offset:4608
    v_mfma_f32_16x16x32_bf16 v[40:43], v[104:107], v[144:147], v[40:43]
    ds_read_b64_tr_b16 v[168:169], v6 offset:12288
    v_mfma_f32_16x16x32_bf16 v[44:47], v[108:111], v[144:147], v[44:47]
    ds_read_b64_tr_b16 v[170:171], v6 offset:12800
    v_mfma_f32_16x16x32_bf16 v[48:51], v[112:115], v[144:147], v[48:51]
    ds_read_b64_tr_b16 v[172:173], v7 offset:12288
    v_mfma_f32_16x16x32_bf16 v[52:55], v[116:119], v[144:147], v[52:55]
    ds_read_b64_tr_b16 v[174:175], v7 offset:12800
    v_mfma_f32_16x16x32_bf16 v[56:59], v[104:107], v[148:151], v[56:59]
    ds_read_b64_tr_b16 v[176:177], v6 offset:20480
    v_mfma_f32_16x16x32_bf16 v[60:63], v[108:111], v[148:151], v[60:63]
    ds_read_b64_tr_b16 v[178:179], v6 offset:20992
    v_mfma_f32_16x16x32_bf16 v[64:67], v[112:115], v[148:151], v[64:67]
    ds_read_b64_tr_b16 v[180:181], v7 offset:20480
    v_mfma_f32_16x16x32_bf16 v[68:71], v[116:119], v[148:151], v[68:71]
    ds_read_b64_tr_b16 v[182:183], v7 offset:20992
    v_mfma_f32_16x16x32_bf16 v[72:75], v[104:107], v[152:155], v[72:75]
    v_mfma_f32_16x16x32_bf16 v[76:79], v[108:111], v[152:155], v[76:79]
    v_mfma_f32_16x16x32_bf16 v[80:83], v[112:115], v[152:155], v[80:83]
    v_mfma_f32_16x16x32_bf16 v[84:87], v[116:119], v[152:155], v[84:87]
    v_mfma_f32_16x16x32_bf16 v[88:91], v[104:107], v[156:159], v[88:91]
    v_mfma_f32_16x16x32_bf16 v[92:95], v[108:111], v[156:159], v[92:95]
    v_mfma_f32_16x16x32_bf16 v[96:99], v[112:115], v[156:159], v[96:99]
    v_mfma_f32_16x16x32_bf16 v[100:103], v[116:119], v[156:159], v[100:103]
    s_waitcnt lgkmcnt(0)
    s_barrier
    v_mfma_f32_16x16x32_bf16 v[8:11], v[160:163], v[120:123], v[8:11]
    v_mfma_f32_16x16x32_bf16 v[12:15], v[160:163], v[124:127], v[12:15]
    v_mfma_f32_16x16x32_bf16 v[16:19], v[160:163], v[128:131], v[16:19]
    v_mfma_f32_16x16x32_bf16 v[20:23], v[160:163], v[132:135], v[20:23]
    v_mfma_f32_16x16x32_bf16 v[24:27], v[164:167], v[120:123], v[24:27]
    v_mfma_f32_16x16x32_bf16 v[28:31], v[164:167], v[124:127], v[28:31]
    v_mfma_f32_16x16x32_bf16 v[32:35], v[164:167], v[128:131], v[32:35]
    v_mfma_f32_16x16x32_bf16 v[36:39], v[164:167], v[132:135], v[36:39]
    v_mfma_f32_16x16x32_bf16 v[40:43], v[120:123], v[168:171], v[40:43]
    v_mfma_f32_16x16x32_bf16 v[44:47], v[124:127], v[168:171], v[44:47]
    v_mfma_f32_16x16x32_bf16 v[48:51], v[128:131], v[168:171], v[48:51]
    v_mfma_f32_16x16x32_bf16 v[52:55], v[132:135], v[168:171], v[52:55]
    v_mfma_f32_16x16x32_bf16 v[56:59], v[120:123], v[172:175], v[56:59]
    v_mfma_f32_16x16x32_bf16 v[60:63], v[124:127], v[172:175], v[60:63]
    v_mfma_f32_16x16x32_bf16 v[64:67], v[128:131], v[172:175], v[64:67]
    v_mfma_f32_16x16x32_bf16 v[68:71], v[132:135], v[172:175], v[68:71]
    v_mfma_f32_16x16x32_bf16 v[72:75], v[120:123], v[176:179], v[72:75]
    v_mfma_f32_16x16x32_bf16 v[76:79], v[124:127], v[176:179], v[76:79]
    v_mfma_f32_16x16x32_bf16 v[80:83], v[128:131], v[176:179], v[80:83]
    v_mfma_f32_16x16x32_bf16 v[84:87], v[132:135], v[176:179], v[84:87]
    v_mfma_f32_16x16x32_bf16 v[88:91], v[120:123], v[180:183], v[88:91]
    v_mfma_f32_16x16x32_bf16 v[92:95], v[124:127], v[180:183], v[92:95]
    v_mfma_f32_16x16x32_bf16 v[96:99], v[128:131], v[180:183], v[96:99]
    v_mfma_f32_16x16x32_bf16 v[100:103], v[132:135], v[180:183], v[100:103]
    s_setprio 0
    s_mov_b32 s82, 0x3fb8aa3b
    s_mov_b32 s84, 0x358637bd
    s_lshl_b32 s69, s6, 8
    s_add_u32 s69, s69, 151552
    v_lshrrev_b32 v140, 4, v1
    v_lshlrev_b32 v140, 4, v140
    v_add_u32 v140, s69, v140
    ds_read_b128 v[104:107], v140 offset:0
    ds_read_b128 v[120:123], v140 offset:512
    ds_read_b128 v[108:111], v140 offset:64
    ds_read_b128 v[124:127], v140 offset:576
    ds_read_b128 v[112:115], v140 offset:128
    ds_read_b128 v[128:131], v140 offset:640
    ds_read_b128 v[116:119], v140 offset:192
    ds_read_b128 v[132:135], v140 offset:704
    v_and_b32 v141, 15, v1
    v_lshlrev_b32 v141, 2, v141
    s_lshl_b32 s37, s7, 7
    s_add_u32 s37, s37, 154624
    v_add_u32 v141, s37, v141
    ds_read_b32 v136, v141 offset:256
    ds_read_b32 v137, v141 offset:320
    ds_read_b32 v138, v141 offset:512
    ds_read_b32 v139, v141 offset:576
    s_waitcnt lgkmcnt(0)
    v_fmac_f32 v40, v104, v136
    v_fmac_f32 v41, v105, v136
    v_fmac_f32 v42, v106, v136
    v_fmac_f32 v43, v107, v136
    v_fmaak_f32 v40, v40, v120, 0x358637bd
    v_fmaak_f32 v41, v41, v121, 0x358637bd
    v_fmaak_f32 v42, v42, v122, 0x358637bd
    v_fmaak_f32 v43, v43, v123, 0x358637bd
    v_mul_f32 v180, s82, v40
    v_mul_f32 v181, s82, v41
    v_mul_f32 v182, s82, v42
    v_mul_f32 v183, s82, v43
    v_exp_f32 v180, v180 clamp
    v_exp_f32 v181, v181 clamp
    v_exp_f32 v182, v182 clamp
    v_exp_f32 v183, v183 clamp
    v_max_f32 v40, s84, v40
    v_max_f32 v41, s84, v41
    v_max_f32 v42, s84, v42
    v_max_f32 v43, s84, v43
    v_add_f32 v40, v40, v180
    v_add_f32 v41, v41, v181
    v_add_f32 v42, v42, v182
    v_add_f32 v43, v43, v183
    v_cvt_pk_bf16_f32 v148, v40, v41
    v_cvt_pk_bf16_f32 v149, v42, v43
    v_fmac_f32 v72, v104, v138
    v_fmac_f32 v73, v105, v138
    v_fmac_f32 v74, v106, v138
    v_fmac_f32 v75, v107, v138
    v_mul_f32 v72, v72, v120
    v_mul_f32 v73, v73, v121
    v_mul_f32 v74, v74, v122
    v_mul_f32 v75, v75, v123
    v_cvt_pk_bf16_f32 v164, v72, v73
    v_cvt_pk_bf16_f32 v165, v74, v75
    v_fmac_f32 v56, v104, v137
    v_fmac_f32 v57, v105, v137
    v_fmac_f32 v58, v106, v137
    v_fmac_f32 v59, v107, v137
    v_fmaak_f32 v56, v56, v120, 0x358637bd
    v_fmaak_f32 v57, v57, v121, 0x358637bd
    v_fmaak_f32 v58, v58, v122, 0x358637bd
    v_fmaak_f32 v59, v59, v123, 0x358637bd
    v_mul_f32 v144, s82, v56
    v_mul_f32 v145, s82, v57
    v_mul_f32 v146, s82, v58
    v_mul_f32 v147, s82, v59
    v_exp_f32 v144, v144 clamp
    v_exp_f32 v145, v145 clamp
    v_exp_f32 v146, v146 clamp
    v_exp_f32 v147, v147 clamp
    v_max_f32 v56, s84, v56
    v_max_f32 v57, s84, v57
    v_max_f32 v58, s84, v58
    v_max_f32 v59, s84, v59
    v_add_f32 v56, v56, v144
    v_add_f32 v57, v57, v145
    v_add_f32 v58, v58, v146
    v_add_f32 v59, v59, v147
    v_cvt_pk_bf16_f32 v156, v56, v57
    v_cvt_pk_bf16_f32 v157, v58, v59
    v_fmac_f32 v88, v104, v139
    v_fmac_f32 v89, v105, v139
    v_fmac_f32 v90, v106, v139
    v_fmac_f32 v91, v107, v139
    v_mul_f32 v88, v88, v120
    v_mul_f32 v89, v89, v121
    v_mul_f32 v90, v90, v122
    v_mul_f32 v91, v91, v123
    v_cvt_pk_bf16_f32 v172, v88, v89
    v_cvt_pk_bf16_f32 v173, v90, v91
    v_fmac_f32 v44, v108, v136
    v_fmac_f32 v45, v109, v136
    v_fmac_f32 v46, v110, v136
    v_fmac_f32 v47, v111, v136
    v_fmaak_f32 v44, v44, v124, 0x358637bd
    v_fmaak_f32 v45, v45, v125, 0x358637bd
    v_fmaak_f32 v46, v46, v126, 0x358637bd
    v_fmaak_f32 v47, v47, v127, 0x358637bd
    v_mul_f32 v180, s82, v44
    v_mul_f32 v181, s82, v45
    v_mul_f32 v182, s82, v46
    v_mul_f32 v183, s82, v47
    v_exp_f32 v180, v180 clamp
    v_exp_f32 v181, v181 clamp
    v_exp_f32 v182, v182 clamp
    v_exp_f32 v183, v183 clamp
    v_max_f32 v44, s84, v44
    v_max_f32 v45, s84, v45
    v_max_f32 v46, s84, v46
    v_max_f32 v47, s84, v47
    v_add_f32 v44, v44, v180
    v_add_f32 v45, v45, v181
    v_add_f32 v46, v46, v182
    v_add_f32 v47, v47, v183
    v_cvt_pk_bf16_f32 v150, v44, v45
    v_cvt_pk_bf16_f32 v151, v46, v47
    v_fmac_f32 v76, v108, v138
    v_fmac_f32 v77, v109, v138
    v_fmac_f32 v78, v110, v138
    v_fmac_f32 v79, v111, v138
    v_mul_f32 v76, v76, v124
    v_mul_f32 v77, v77, v125
    v_mul_f32 v78, v78, v126
    v_mul_f32 v79, v79, v127
    v_cvt_pk_bf16_f32 v166, v76, v77
    v_cvt_pk_bf16_f32 v167, v78, v79
    v_fmac_f32 v60, v108, v137
    v_fmac_f32 v61, v109, v137
    v_fmac_f32 v62, v110, v137
    v_fmac_f32 v63, v111, v137
    v_fmaak_f32 v60, v60, v124, 0x358637bd
    v_fmaak_f32 v61, v61, v125, 0x358637bd
    v_fmaak_f32 v62, v62, v126, 0x358637bd
    v_fmaak_f32 v63, v63, v127, 0x358637bd
    v_mul_f32 v144, s82, v60
    v_mul_f32 v145, s82, v61
    v_mul_f32 v146, s82, v62
    v_mul_f32 v147, s82, v63
    v_exp_f32 v144, v144 clamp
    v_exp_f32 v145, v145 clamp
    v_exp_f32 v146, v146 clamp
    v_exp_f32 v147, v147 clamp
    v_max_f32 v60, s84, v60
    v_max_f32 v61, s84, v61
    v_max_f32 v62, s84, v62
    v_max_f32 v63, s84, v63
    v_add_f32 v60, v60, v144
    v_add_f32 v61, v61, v145
    v_add_f32 v62, v62, v146
    v_add_f32 v63, v63, v147
    v_cvt_pk_bf16_f32 v158, v60, v61
    v_cvt_pk_bf16_f32 v159, v62, v63
    v_fmac_f32 v92, v108, v139
    v_fmac_f32 v93, v109, v139
    v_fmac_f32 v94, v110, v139
    v_fmac_f32 v95, v111, v139
    v_mul_f32 v92, v92, v124
    v_mul_f32 v93, v93, v125
    v_mul_f32 v94, v94, v126
    v_mul_f32 v95, v95, v127
    v_cvt_pk_bf16_f32 v174, v92, v93
    v_cvt_pk_bf16_f32 v175, v94, v95
    v_fmac_f32 v48, v112, v136
    v_fmac_f32 v49, v113, v136
    v_fmac_f32 v50, v114, v136
    v_fmac_f32 v51, v115, v136
    v_fmaak_f32 v48, v48, v128, 0x358637bd
    v_fmaak_f32 v49, v49, v129, 0x358637bd
    v_fmaak_f32 v50, v50, v130, 0x358637bd
    v_fmaak_f32 v51, v51, v131, 0x358637bd
    v_mul_f32 v180, s82, v48
    v_mul_f32 v181, s82, v49
    v_mul_f32 v182, s82, v50
    v_mul_f32 v183, s82, v51
    v_exp_f32 v180, v180 clamp
    v_exp_f32 v181, v181 clamp
    v_exp_f32 v182, v182 clamp
    v_exp_f32 v183, v183 clamp
    v_max_f32 v48, s84, v48
    v_max_f32 v49, s84, v49
    v_max_f32 v50, s84, v50
    v_max_f32 v51, s84, v51
    v_add_f32 v48, v48, v180
    v_add_f32 v49, v49, v181
    v_add_f32 v50, v50, v182
    v_add_f32 v51, v51, v183
    v_cvt_pk_bf16_f32 v152, v48, v49
    v_cvt_pk_bf16_f32 v153, v50, v51
    v_fmac_f32 v80, v112, v138
    v_fmac_f32 v81, v113, v138
    v_fmac_f32 v82, v114, v138
    v_fmac_f32 v83, v115, v138
    v_mul_f32 v80, v80, v128
    v_mul_f32 v81, v81, v129
    v_mul_f32 v82, v82, v130
    v_mul_f32 v83, v83, v131
    v_cvt_pk_bf16_f32 v168, v80, v81
    v_cvt_pk_bf16_f32 v169, v82, v83
    v_fmac_f32 v64, v112, v137
    v_fmac_f32 v65, v113, v137
    v_fmac_f32 v66, v114, v137
    v_fmac_f32 v67, v115, v137
    v_fmaak_f32 v64, v64, v128, 0x358637bd
    v_fmaak_f32 v65, v65, v129, 0x358637bd
    v_fmaak_f32 v66, v66, v130, 0x358637bd
    v_fmaak_f32 v67, v67, v131, 0x358637bd
    v_mul_f32 v144, s82, v64
    v_mul_f32 v145, s82, v65
    v_mul_f32 v146, s82, v66
    v_mul_f32 v147, s82, v67
    v_exp_f32 v144, v144 clamp
    v_exp_f32 v145, v145 clamp
    v_exp_f32 v146, v146 clamp
    v_exp_f32 v147, v147 clamp
    v_max_f32 v64, s84, v64
    v_max_f32 v65, s84, v65
    v_max_f32 v66, s84, v66
    v_max_f32 v67, s84, v67
    v_add_f32 v64, v64, v144
    v_add_f32 v65, v65, v145
    v_add_f32 v66, v66, v146
    v_add_f32 v67, v67, v147
    v_cvt_pk_bf16_f32 v160, v64, v65
    v_cvt_pk_bf16_f32 v161, v66, v67
    v_fmac_f32 v96, v112, v139
    v_fmac_f32 v97, v113, v139
    v_fmac_f32 v98, v114, v139
    v_fmac_f32 v99, v115, v139
    v_mul_f32 v96, v96, v128
    v_mul_f32 v97, v97, v129
    v_mul_f32 v98, v98, v130
    v_mul_f32 v99, v99, v131
    v_cvt_pk_bf16_f32 v176, v96, v97
    v_cvt_pk_bf16_f32 v177, v98, v99
    v_fmac_f32 v52, v116, v136
    v_fmac_f32 v53, v117, v136
    v_fmac_f32 v54, v118, v136
    v_fmac_f32 v55, v119, v136
    v_fmaak_f32 v52, v52, v132, 0x358637bd
    v_fmaak_f32 v53, v53, v133, 0x358637bd
    v_fmaak_f32 v54, v54, v134, 0x358637bd
    v_fmaak_f32 v55, v55, v135, 0x358637bd
    v_mul_f32 v180, s82, v52
    v_mul_f32 v181, s82, v53
    v_mul_f32 v182, s82, v54
    v_mul_f32 v183, s82, v55
    v_exp_f32 v180, v180 clamp
    v_exp_f32 v181, v181 clamp
    v_exp_f32 v182, v182 clamp
    v_exp_f32 v183, v183 clamp
    v_max_f32 v52, s84, v52
    v_max_f32 v53, s84, v53
    v_max_f32 v54, s84, v54
    v_max_f32 v55, s84, v55
    v_add_f32 v52, v52, v180
    v_add_f32 v53, v53, v181
    v_add_f32 v54, v54, v182
    v_add_f32 v55, v55, v183
    v_cvt_pk_bf16_f32 v154, v52, v53
    v_cvt_pk_bf16_f32 v155, v54, v55
    v_fmac_f32 v84, v116, v138
    v_fmac_f32 v85, v117, v138
    v_fmac_f32 v86, v118, v138
    v_fmac_f32 v87, v119, v138
    v_mul_f32 v84, v84, v132
    v_mul_f32 v85, v85, v133
    v_mul_f32 v86, v86, v134
    v_mul_f32 v87, v87, v135
    v_cvt_pk_bf16_f32 v170, v84, v85
    v_cvt_pk_bf16_f32 v171, v86, v87
    v_fmac_f32 v68, v116, v137
    v_fmac_f32 v69, v117, v137
    v_fmac_f32 v70, v118, v137
    v_fmac_f32 v71, v119, v137
    v_fmaak_f32 v68, v68, v132, 0x358637bd
    v_fmaak_f32 v69, v69, v133, 0x358637bd
    v_fmaak_f32 v70, v70, v134, 0x358637bd
    v_fmaak_f32 v71, v71, v135, 0x358637bd
    v_mul_f32 v144, s82, v68
    v_mul_f32 v145, s82, v69
    v_mul_f32 v146, s82, v70
    v_mul_f32 v147, s82, v71
    v_exp_f32 v144, v144 clamp
    v_exp_f32 v145, v145 clamp
    v_exp_f32 v146, v146 clamp
    v_exp_f32 v147, v147 clamp
    v_max_f32 v68, s84, v68
    v_max_f32 v69, s84, v69
    v_max_f32 v70, s84, v70
    v_max_f32 v71, s84, v71
    v_add_f32 v68, v68, v144
    v_add_f32 v69, v69, v145
    v_add_f32 v70, v70, v146
    v_add_f32 v71, v71, v147
    v_cvt_pk_bf16_f32 v162, v68, v69
    v_cvt_pk_bf16_f32 v163, v70, v71
    v_fmac_f32 v100, v116, v139
    v_fmac_f32 v101, v117, v139
    v_fmac_f32 v102, v118, v139
    v_fmac_f32 v103, v119, v139
    v_mul_f32 v100, v100, v132
    v_mul_f32 v101, v101, v133
    v_mul_f32 v102, v102, v134
    v_mul_f32 v103, v103, v135
    v_cvt_pk_bf16_f32 v178, v100, v101
    v_cvt_pk_bf16_f32 v179, v102, v103
    v_mov_b32 v184, 0x3f803f80
    v_mov_b32 v185, 0x3f803f80
    v_mov_b32 v186, 0x3f803f80
    v_mov_b32 v187, 0x3f803f80
    v_mfma_f32_16x16x32_bf16 v[40:43], v[148:151], v[164:167], 0
    v_mfma_f32_16x16x32_bf16 v[44:47], v[148:151], v[172:175], 0
    v_mfma_f32_16x16x32_bf16 v[48:51], v[148:151], v[184:187], 0
    v_mfma_f32_16x16x32_bf16 v[52:55], v[156:159], v[164:167], 0
    v_mfma_f32_16x16x32_bf16 v[56:59], v[156:159], v[172:175], 0
    v_mfma_f32_16x16x32_bf16 v[60:63], v[156:159], v[184:187], 0
    v_mfma_f32_16x16x32_bf16 v[40:43], v[152:155], v[168:171], v[40:43]
    v_mfma_f32_16x16x32_bf16 v[44:47], v[152:155], v[176:179], v[44:47]
    v_mfma_f32_16x16x32_bf16 v[48:51], v[152:155], v[184:187], v[48:51]
    v_mfma_f32_16x16x32_bf16 v[52:55], v[160:163], v[168:171], v[52:55]
    v_mfma_f32_16x16x32_bf16 v[56:59], v[160:163], v[176:179], v[56:59]
    v_mfma_f32_16x16x32_bf16 v[60:63], v[160:163], v[184:187], v[60:63]
    v_lshlrev_b32 v188, 4, v1
    s_mul_i32 s37, s7, 6144
    s_add_u32 s37, s37, 122880
    v_add_u32 v188, s37, v188
    s_cmp_eq_u32 s6, 0
    s_cbranch_scc1 L_wm1_9
    ds_write_b128 v188, v[40:43] offset:0
    ds_write_b128 v188, v[44:47] offset:1024
    ds_write_b128 v188, v[48:51] offset:2048
    ds_write_b128 v188, v[52:55] offset:3072
    ds_write_b128 v188, v[56:59] offset:4096
    ds_write_b128 v188, v[60:63] offset:5120
    s_waitcnt lgkmcnt(0)
L_wm1_9:
    s_barrier
    s_cmp_eq_u32 s6, 0
    s_cbranch_scc0 L_q_10
    ds_read_b128 v[192:195], v188 offset:0
    ds_read_b128 v[196:199], v188 offset:1024
    ds_read_b128 v[200:203], v188 offset:2048
    ds_read_b128 v[204:207], v188 offset:3072
    ds_read_b128 v[208:211], v188 offset:4096
    ds_read_b128 v[212:215], v188 offset:5120
    s_add_u32 s16, s64, 0x3400000
    s_addc_u32 s17, s65, 0
    s_mov_b32 s18, 0x400000
    s_mov_b32 s19, 0x20000
    s_lshl_b32 s37, s4, 5
    s_lshl_b32 s38, s5, 1
    s_add_u32 s38, s38, s7
    s_add_u32 s37, s37, s38
    s_lshl_b32 s37, s37, 11
    s_lshl_b32 s38, s38, 4
    s_add_u32 s38, s38, s4
    s_lshl_b32 s38, s38, 7
    s_add_u32 s39, s38, 2097152
    v_bfe_u32 v216, v1, 4, 1
    v_lshlrev_b32 v216, 5, v216
    v_bfe_u32 v2, v1, 5, 1
    v_lshl_add_u32 v216, v2, 4, v216
    v_and_b32 v2, 15, v1
    v_lshl_add_u32 v2, v2, 6, v216
    v_lshrrev_b32 v3, 4, v1
    v_lshlrev_b32 v3, 4, v3
    s_waitcnt lgkmcnt(0)
    v_add_f32 v40, v40, v192
    v_add_f32 v41, v41, v193
    v_add_f32 v42, v42, v194
    v_add_f32 v43, v43, v195
    v_add_f32 v44, v44, v196
    v_add_f32 v45, v45, v197
    v_add_f32 v46, v46, v198
    v_add_f32 v47, v47, v199
    v_add_f32 v48, v48, v200
    v_add_f32 v49, v49, v201
    v_add_f32 v50, v50, v202
    v_add_f32 v51, v51, v203
    v_add_f32 v52, v52, v204
    v_add_f32 v53, v53, v205
    v_add_f32 v54, v54, v206
    v_add_f32 v55, v55, v207
    v_add_f32 v56, v56, v208
    v_add_f32 v57, v57, v209
    v_add_f32 v58, v58, v210
    v_add_f32 v59, v59, v211
    v_add_f32 v60, v60, v212
    v_add_f32 v61, v61, v213
    v_add_f32 v62, v62, v214
    v_add_f32 v63, v63, v215
    v_cvt_pk_bf16_f32 v220, v40, v41
    v_cvt_pk_bf16_f32 v221, v42, v43
    v_cvt_pk_bf16_f32 v222, v52, v53
    v_cvt_pk_bf16_f32 v223, v54, v55
    s_nop 0
    v_permlane16_swap_b32 v220, v222
    v_permlane16_swap_b32 v221, v223
    buffer_store_dwordx4 v[220:223], v2, s[16:19], s37 offen offset:0 sc1
    v_cvt_pk_bf16_f32 v224, v44, v45
    v_cvt_pk_bf16_f32 v225, v46, v47
    v_cvt_pk_bf16_f32 v226, v56, v57
    v_cvt_pk_bf16_f32 v227, v58, v59
    s_nop 0
    v_permlane16_swap_b32 v224, v226
    v_permlane16_swap_b32 v225, v227
    buffer_store_dwordx4 v[224:227], v2, s[16:19], s37 offen offset:1024 sc1
    s_mov_b32 exec_lo, 0x00010001
    s_mov_b32 exec_hi, 0x00010001
    buffer_store_dwordx4 v[48:51], v3, s[16:19], s39 offen offset:0 sc1
    buffer_store_dwordx4 v[60:63], v3, s[16:19], s39 offen offset:64 sc1
    s_mov_b64 exec, -1
    s_lshl_b32 s67, s5, 12
    s_add_u32 s67, s67, 0
    s_lshl_b32 s68, s4, 1
    s_add_u32 s68, s68, s7
    s_lshl_b32 s68, s68, 7
    s_add_u32 s67, s67, s68
    s_waitcnt vmcnt(0)
    v_mov_b32 v2, 1
    v_mov_b32 v3, 0
    s_mov_b64 exec, 1
    buffer_store_dword v2, v3, s[88:91], s67 offen sc1
    s_mov_b64 exec, -1
L_q_10:
    v_and_b32 v140, 15, v1
    v_lshlrev_b32 v140, 2, v140
    v_add_u32 v140, s69, v140
    ds_read_b32 v104, v140 offset:0
    ds_read_b32 v108, v140 offset:512
    ds_read_b32 v105, v140 offset:64
    ds_read_b32 v109, v140 offset:576
    ds_read_b32 v106, v140 offset:128
    ds_read_b32 v110, v140 offset:640
    ds_read_b32 v107, v140 offset:192
    ds_read_b32 v111, v140 offset:704
    v_lshrrev_b32 v141, 4, v1
    v_lshlrev_b32 v141, 4, v141
    s_lshl_b32 s37, s7, 7
    s_add_u32 s37, s37, 154624
    v_add_u32 v141, s37, v141
    ds_read_b128 v[112:115], v141 offset:0
    ds_read_b128 v[116:119], v141 offset:64
    s_waitcnt lgkmcnt(0)
    v_fmac_f32 v8, v104, v112
    v_fmac_f32 v9, v104, v113
    v_fmac_f32 v10, v104, v114
    v_fmac_f32 v11, v104, v115
    v_fmaak_f32 v8, v8, v108, 0x358637bd
    v_fmaak_f32 v9, v9, v108, 0x358637bd
    v_fmaak_f32 v10, v10, v108, 0x358637bd
    v_fmaak_f32 v11, v11, v108, 0x358637bd
    v_mul_f32 v144, s82, v8
    v_mul_f32 v145, s82, v9
    v_mul_f32 v146, s82, v10
    v_mul_f32 v147, s82, v11
    v_exp_f32 v144, v144 clamp
    v_exp_f32 v145, v145 clamp
    v_exp_f32 v146, v146 clamp
    v_exp_f32 v147, v147 clamp
    v_max_f32 v8, s84, v8
    v_max_f32 v9, s84, v9
    v_max_f32 v10, s84, v10
    v_max_f32 v11, s84, v11
    v_add_f32 v8, v8, v144
    v_add_f32 v9, v9, v145
    v_add_f32 v10, v10, v146
    v_add_f32 v11, v11, v147
    v_cvt_pk_bf16_f32 v124, v8, v9
    v_cvt_pk_bf16_f32 v125, v10, v11
    v_fmac_f32 v24, v104, v116
    v_fmac_f32 v25, v104, v117
    v_fmac_f32 v26, v104, v118
    v_fmac_f32 v27, v104, v119
    v_fmaak_f32 v24, v24, v108, 0x358637bd
    v_fmaak_f32 v25, v25, v108, 0x358637bd
    v_fmaak_f32 v26, v26, v108, 0x358637bd
    v_fmaak_f32 v27, v27, v108, 0x358637bd
    v_mul_f32 v120, s82, v24
    v_mul_f32 v121, s82, v25
    v_mul_f32 v122, s82, v26
    v_mul_f32 v123, s82, v27
    v_exp_f32 v120, v120 clamp
    v_exp_f32 v121, v121 clamp
    v_exp_f32 v122, v122 clamp
    v_exp_f32 v123, v123 clamp
    v_max_f32 v24, s84, v24
    v_max_f32 v25, s84, v25
    v_max_f32 v26, s84, v26
    v_max_f32 v27, s84, v27
    v_add_f32 v24, v24, v120
    v_add_f32 v25, v25, v121
    v_add_f32 v26, v26, v122
    v_add_f32 v27, v27, v123
    v_cvt_pk_bf16_f32 v126, v24, v25
    v_cvt_pk_bf16_f32 v127, v26, v27
    v_fmac_f32 v12, v105, v112
    v_fmac_f32 v13, v105, v113
    v_fmac_f32 v14, v105, v114
    v_fmac_f32 v15, v105, v115
    v_fmaak_f32 v12, v12, v109, 0x358637bd
    v_fmaak_f32 v13, v13, v109, 0x358637bd
    v_fmaak_f32 v14, v14, v109, 0x358637bd
    v_fmaak_f32 v15, v15, v109, 0x358637bd
    v_mul_f32 v144, s82, v12
    v_mul_f32 v145, s82, v13
    v_mul_f32 v146, s82, v14
    v_mul_f32 v147, s82, v15
    v_exp_f32 v144, v144 clamp
    v_exp_f32 v145, v145 clamp
    v_exp_f32 v146, v146 clamp
    v_exp_f32 v147, v147 clamp
    v_max_f32 v12, s84, v12
    v_max_f32 v13, s84, v13
    v_max_f32 v14, s84, v14
    v_max_f32 v15, s84, v15
    v_add_f32 v12, v12, v144
    v_add_f32 v13, v13, v145
    v_add_f32 v14, v14, v146
    v_add_f32 v15, v15, v147
    v_cvt_pk_bf16_f32 v128, v12, v13
    v_cvt_pk_bf16_f32 v129, v14, v15
    v_fmac_f32 v28, v105, v116
    v_fmac_f32 v29, v105, v117
    v_fmac_f32 v30, v105, v118
    v_fmac_f32 v31, v105, v119
    v_fmaak_f32 v28, v28, v109, 0x358637bd
    v_fmaak_f32 v29, v29, v109, 0x358637bd
    v_fmaak_f32 v30, v30, v109, 0x358637bd
    v_fmaak_f32 v31, v31, v109, 0x358637bd
    v_mul_f32 v120, s82, v28
    v_mul_f32 v121, s82, v29
    v_mul_f32 v122, s82, v30
    v_mul_f32 v123, s82, v31
    v_exp_f32 v120, v120 clamp
    v_exp_f32 v121, v121 clamp
    v_exp_f32 v122, v122 clamp
    v_exp_f32 v123, v123 clamp
    v_max_f32 v28, s84, v28
    v_max_f32 v29, s84, v29
    v_max_f32 v30, s84, v30
    v_max_f32 v31, s84, v31
    v_add_f32 v28, v28, v120
    v_add_f32 v29, v29, v121
    v_add_f32 v30, v30, v122
    v_add_f32 v31, v31, v123
    v_cvt_pk_bf16_f32 v130, v28, v29
    v_cvt_pk_bf16_f32 v131, v30, v31
    v_fmac_f32 v16, v106, v112
    v_fmac_f32 v17, v106, v113
    v_fmac_f32 v18, v106, v114
    v_fmac_f32 v19, v106, v115
    v_fmaak_f32 v16, v16, v110, 0x358637bd
    v_fmaak_f32 v17, v17, v110, 0x358637bd
    v_fmaak_f32 v18, v18, v110, 0x358637bd
    v_fmaak_f32 v19, v19, v110, 0x358637bd
    v_mul_f32 v144, s82, v16
    v_mul_f32 v145, s82, v17
    v_mul_f32 v146, s82, v18
    v_mul_f32 v147, s82, v19
    v_exp_f32 v144, v144 clamp
    v_exp_f32 v145, v145 clamp
    v_exp_f32 v146, v146 clamp
    v_exp_f32 v147, v147 clamp
    v_max_f32 v16, s84, v16
    v_max_f32 v17, s84, v17
    v_max_f32 v18, s84, v18
    v_max_f32 v19, s84, v19
    v_add_f32 v16, v16, v144
    v_add_f32 v17, v17, v145
    v_add_f32 v18, v18, v146
    v_add_f32 v19, v19, v147
    v_cvt_pk_bf16_f32 v132, v16, v17
    v_cvt_pk_bf16_f32 v133, v18, v19
    v_fmac_f32 v32, v106, v116
    v_fmac_f32 v33, v106, v117
    v_fmac_f32 v34, v106, v118
    v_fmac_f32 v35, v106, v119
    v_fmaak_f32 v32, v32, v110, 0x358637bd
    v_fmaak_f32 v33, v33, v110, 0x358637bd
    v_fmaak_f32 v34, v34, v110, 0x358637bd
    v_fmaak_f32 v35, v35, v110, 0x358637bd
    v_mul_f32 v120, s82, v32
    v_mul_f32 v121, s82, v33
    v_mul_f32 v122, s82, v34
    v_mul_f32 v123, s82, v35
    v_exp_f32 v120, v120 clamp
    v_exp_f32 v121, v121 clamp
    v_exp_f32 v122, v122 clamp
    v_exp_f32 v123, v123 clamp
    v_max_f32 v32, s84, v32
    v_max_f32 v33, s84, v33
    v_max_f32 v34, s84, v34
    v_max_f32 v35, s84, v35
    v_add_f32 v32, v32, v120
    v_add_f32 v33, v33, v121
    v_add_f32 v34, v34, v122
    v_add_f32 v35, v35, v123
    v_cvt_pk_bf16_f32 v134, v32, v33
    v_cvt_pk_bf16_f32 v135, v34, v35
    v_fmac_f32 v20, v107, v112
    v_fmac_f32 v21, v107, v113
    v_fmac_f32 v22, v107, v114
    v_fmac_f32 v23, v107, v115
    v_fmaak_f32 v20, v20, v111, 0x358637bd
    v_fmaak_f32 v21, v21, v111, 0x358637bd
    v_fmaak_f32 v22, v22, v111, 0x358637bd
    v_fmaak_f32 v23, v23, v111, 0x358637bd
    v_mul_f32 v144, s82, v20
    v_mul_f32 v145, s82, v21
    v_mul_f32 v146, s82, v22
    v_mul_f32 v147, s82, v23
    v_exp_f32 v144, v144 clamp
    v_exp_f32 v145, v145 clamp
    v_exp_f32 v146, v146 clamp
    v_exp_f32 v147, v147 clamp
    v_max_f32 v20, s84, v20
    v_max_f32 v21, s84, v21
    v_max_f32 v22, s84, v22
    v_max_f32 v23, s84, v23
    v_add_f32 v20, v20, v144
    v_add_f32 v21, v21, v145
    v_add_f32 v22, v22, v146
    v_add_f32 v23, v23, v147
    v_cvt_pk_bf16_f32 v136, v20, v21
    v_cvt_pk_bf16_f32 v137, v22, v23
    v_fmac_f32 v36, v107, v116
    v_fmac_f32 v37, v107, v117
    v_fmac_f32 v38, v107, v118
    v_fmac_f32 v39, v107, v119
    v_fmaak_f32 v36, v36, v111, 0x358637bd
    v_fmaak_f32 v37, v37, v111, 0x358637bd
    v_fmaak_f32 v38, v38, v111, 0x358637bd
    v_fmaak_f32 v39, v39, v111, 0x358637bd
    v_mul_f32 v120, s82, v36
    v_mul_f32 v121, s82, v37
    v_mul_f32 v122, s82, v38
    v_mul_f32 v123, s82, v39
    v_exp_f32 v120, v120 clamp
    v_exp_f32 v121, v121 clamp
    v_exp_f32 v122, v122 clamp
    v_exp_f32 v123, v123 clamp
    v_max_f32 v36, s84, v36
    v_max_f32 v37, s84, v37
    v_max_f32 v38, s84, v38
    v_max_f32 v39, s84, v39
    v_add_f32 v36, v36, v120
    v_add_f32 v37, v37, v121
    v_add_f32 v38, v38, v122
    v_add_f32 v39, v39, v123
    v_cvt_pk_bf16_f32 v138, v36, v37
    v_cvt_pk_bf16_f32 v139, v38, v39
    s_barrier
    s_add_u32 s24, s64, 0x3400000
    s_addc_u32 s25, s65, 0
    s_mov_b32 s26, 0x400000
    s_mov_b32 s27, 0x20000
    v_lshlrev_b32 v2, 4, v1
    s_lshl_b32 s38, s5, 1
    s_add_u32 s38, s38, s7
    s_lshl_b32 s37, s6, 8
    s_add_u32 s37, s37, s38
    s_lshl_b32 s37, s37, 11
    s_lshl_b32 s38, s38, 4
    s_lshl_b32 s39, s6, 3
    s_add_u32 s38, s38, s39
    s_lshl_b32 s38, s38, 7
    s_add_u32 s38, s38, 2097152
    buffer_load_dwordx4 v[72:75], v2, s[24:27], s38 offen sc1
    buffer_load_dwordx4 v[8:11], v2, s[24:27], s37 offen offset:0 sc1
    buffer_load_dwordx4 v[12:15], v2, s[24:27], s37 offen offset:1024 sc1
    s_add_u32 s37, s37, 65536
    buffer_load_dwordx4 v[16:19], v2, s[24:27], s37 offen offset:0 sc1
    buffer_load_dwordx4 v[20:23], v2, s[24:27], s37 offen offset:1024 sc1
    s_add_u32 s37, s37, 65536
    buffer_load_dwordx4 v[24:27], v2, s[24:27], s37 offen offset:0 sc1
    buffer_load_dwordx4 v[28:31], v2, s[24:27], s37 offen offset:1024 sc1
    s_add_u32 s37, s37, 65536
    buffer_load_dwordx4 v[32:35], v2, s[24:27], s37 offen offset:0 sc1
    buffer_load_dwordx4 v[36:39], v2, s[24:27], s37 offen offset:1024 sc1
    s_add_u32 s37, s37, 65536
    buffer_load_dwordx4 v[40:43], v2, s[24:27], s37 offen offset:0 sc1
    buffer_load_dwordx4 v[44:47], v2, s[24:27], s37 offen offset:1024 sc1
    s_add_u32 s37, s37, 65536
    buffer_load_dwordx4 v[48:51], v2, s[24:27], s37 offen offset:0 sc1
    buffer_load_dwordx4 v[52:55], v2, s[24:27], s37 offen offset:1024 sc1
    s_add_u32 s37, s37, 65536
    buffer_load_dwordx4 v[56:59], v2, s[24:27], s37 offen offset:0 sc1
    buffer_load_dwordx4 v[60:63], v2, s[24:27], s37 offen offset:1024 sc1
    s_add_u32 s37, s37, 65536
    buffer_load_dwordx4 v[64:67], v2, s[24:27], s37 offen offset:0 sc1
    buffer_load_dwordx4 v[68:71], v2, s[24:27], s37 offen offset:1024 sc1
    v_mov_b32 v168, 0xffff0000
    s_waitcnt vmcnt(16)
    v_add_f32_dpp v72, v72, v72 row_ror:8 row_mask:0xf bank_mask:0xf
    v_add_f32_dpp v73, v73, v73 row_ror:8 row_mask:0xf bank_mask:0xf
    v_add_f32_dpp v74, v74, v74 row_ror:8 row_mask:0xf bank_mask:0xf
    v_add_f32_dpp v75, v75, v75 row_ror:8 row_mask:0xf bank_mask:0xf
    v_mov_b32 v164, v72
    v_mov_b32 v165, v73
    v_mov_b32 v166, v74
    v_mov_b32 v167, v75
    v_permlane16_swap_b32 v164, v72
    v_permlane16_swap_b32 v165, v73
    v_permlane16_swap_b32 v166, v74
    v_permlane16_swap_b32 v167, v75
    v_add_f32 v72, v72, v164
    v_add_f32 v73, v73, v165
    v_add_f32 v74, v74, v166
    v_add_f32 v75, v75, v167
    v_mov_b32 v164, v72
    v_mov_b32 v165, v73
    v_mov_b32 v166, v74
    v_mov_b32 v167, v75
    v_permlane32_swap_b32 v164, v72
    v_permlane32_swap_b32 v165, v73
    v_permlane32_swap_b32 v166, v74
    v_permlane32_swap_b32 v167, v75
    v_add_f32 v72, v72, v164
    v_add_f32 v73, v73, v165
    v_add_f32 v74, v74, v166
    v_add_f32 v75, v75, v167
    s_waitcnt vmcnt(14)
    v_lshlrev_b32 v148, 16, v8
    v_and_b32 v149, v168, v8
    v_lshlrev_b32 v150, 16, v9
    v_and_b32 v151, v168, v9
    v_lshlrev_b32 v152, 16, v10
    v_and_b32 v153, v168, v10
    v_lshlrev_b32 v154, 16, v11
    v_and_b32 v155, v168, v11
    v_lshlrev_b32 v156, 16, v12
    v_and_b32 v157, v168, v12
    v_lshlrev_b32 v158, 16, v13
    v_and_b32 v159, v168, v13
    v_lshlrev_b32 v160, 16, v14
    v_and_b32 v161, v168, v14
    v_lshlrev_b32 v162, 16, v15
    v_and_b32 v163, v168, v15
    s_waitcnt vmcnt(12)
    v_lshlrev_b32 v164, 16, v16
    v_and_b32 v165, v168, v16
    v_add_f32 v148, v148, v164
    v_add_f32 v149, v149, v165
    v_lshlrev_b32 v166, 16, v17
    v_and_b32 v167, v168, v17
    v_add_f32 v150, v150, v166
    v_add_f32 v151, v151, v167
    v_lshlrev_b32 v164, 16, v18
    v_and_b32 v165, v168, v18
    v_add_f32 v152, v152, v164
    v_add_f32 v153, v153, v165
    v_lshlrev_b32 v166, 16, v19
    v_and_b32 v167, v168, v19
    v_add_f32 v154, v154, v166
    v_add_f32 v155, v155, v167
    v_lshlrev_b32 v164, 16, v20
    v_and_b32 v165, v168, v20
    v_add_f32 v156, v156, v164
    v_add_f32 v157, v157, v165
    v_lshlrev_b32 v166, 16, v21
    v_and_b32 v167, v168, v21
    v_add_f32 v158, v158, v166
    v_add_f32 v159, v159, v167
    v_lshlrev_b32 v164, 16, v22
    v_and_b32 v165, v168, v22
    v_add_f32 v160, v160, v164
    v_add_f32 v161, v161, v165
    v_lshlrev_b32 v166, 16, v23
    v_and_b32 v167, v168, v23
    v_add_f32 v162, v162, v166
    v_add_f32 v163, v163, v167
    s_waitcnt vmcnt(10)
    v_lshlrev_b32 v164, 16, v24
    v_and_b32 v165, v168, v24
    v_add_f32 v148, v148, v164
    v_add_f32 v149, v149, v165
    v_lshlrev_b32 v166, 16, v25
    v_and_b32 v167, v168, v25
    v_add_f32 v150, v150, v166
    v_add_f32 v151, v151, v167
    v_lshlrev_b32 v164, 16, v26
    v_and_b32 v165, v168, v26
    v_add_f32 v152, v152, v164
    v_add_f32 v153, v153, v165
    v_lshlrev_b32 v166, 16, v27
    v_and_b32 v167, v168, v27
    v_add_f32 v154, v154, v166
    v_add_f32 v155, v155, v167
    v_lshlrev_b32 v164, 16, v28
    v_and_b32 v165, v168, v28
    v_add_f32 v156, v156, v164
    v_add_f32 v157, v157, v165
    v_lshlrev_b32 v166, 16, v29
    v_and_b32 v167, v168, v29
    v_add_f32 v158, v158, v166
    v_add_f32 v159, v159, v167
    v_lshlrev_b32 v164, 16, v30
    v_and_b32 v165, v168, v30
    v_add_f32 v160, v160, v164
    v_add_f32 v161, v161, v165
    v_lshlrev_b32 v166, 16, v31
    v_and_b32 v167, v168, v31
    v_add_f32 v162, v162, v166
    v_add_f32 v163, v163, v167
    s_waitcnt vmcnt(8)
    v_lshlrev_b32 v164, 16, v32
    v_and_b32 v165, v168, v32
    v_add_f32 v148, v148, v164
    v_add_f32 v149, v149, v165
    v_lshlrev_b32 v166, 16, v33
    v_and_b32 v167, v168, v33
    v_add_f32 v150, v150, v166
    v_add_f32 v151, v151, v167
    v_lshlrev_b32 v164, 16, v34
    v_and_b32 v165, v168, v34
    v_add_f32 v152, v152, v164
    v_add_f32 v153, v153, v165
    v_lshlrev_b32 v166, 16, v35
    v_and_b32 v167, v168, v35
    v_add_f32 v154, v154, v166
    v_add_f32 v155, v155, v167
    v_lshlrev_b32 v164, 16, v36
    v_and_b32 v165, v168, v36
    v_add_f32 v156, v156, v164
    v_add_f32 v157, v157, v165
    v_lshlrev_b32 v166, 16, v37
    v_and_b32 v167, v168, v37
    v_add_f32 v158, v158, v166
    v_add_f32 v159, v159, v167
    v_lshlrev_b32 v164, 16, v38
    v_and_b32 v165, v168, v38
    v_add_f32 v160, v160, v164
    v_add_f32 v161, v161, v165
    v_lshlrev_b32 v166, 16, v39
    v_and_b32 v167, v168, v39
    v_add_f32 v162, v162, v166
    v_add_f32 v163, v163, v167
    s_waitcnt vmcnt(6)
    v_lshlrev_b32 v164, 16, v40
    v_and_b32 v165, v168, v40
    v_add_f32 v148, v148, v164
    v_add_f32 v149, v149, v165
    v_lshlrev_b32 v166, 16, v41
    v_and_b32 v167, v168, v41
    v_add_f32 v150, v150, v166
    v_add_f32 v151, v151, v167
    v_lshlrev_b32 v164, 16, v42
    v_and_b32 v165, v168, v42
    v_add_f32 v152, v152, v164
    v_add_f32 v153, v153, v165
    v_lshlrev_b32 v166, 16, v43
    v_and_b32 v167, v168, v43
    v_add_f32 v154, v154, v166
    v_add_f32 v155, v155, v167
    v_lshlrev_b32 v164, 16, v44
    v_and_b32 v165, v168, v44
    v_add_f32 v156, v156, v164
    v_add_f32 v157, v157, v165
    v_lshlrev_b32 v166, 16, v45
    v_and_b32 v167, v168, v45
    v_add_f32 v158, v158, v166
    v_add_f32 v159, v159, v167
    v_lshlrev_b32 v164, 16, v46
    v_and_b32 v165, v168, v46
    v_add_f32 v160, v160, v164
    v_add_f32 v161, v161, v165
    v_lshlrev_b32 v166, 16, v47
    v_and_b32 v167, v168, v47
    v_add_f32 v162, v162, v166
    v_add_f32 v163, v163, v167
    s_waitcnt vmcnt(4)
    v_lshlrev_b32 v164, 16, v48
    v_and_b32 v165, v168, v48
    v_add_f32 v148, v148, v164
    v_add_f32 v149, v149, v165
    v_lshlrev_b32 v166, 16, v49
    v_and_b32 v167, v168, v49
    v_add_f32 v150, v150, v166
    v_add_f32 v151, v151, v167
    v_lshlrev_b32 v164, 16, v50
    v_and_b32 v165, v168, v50
    v_add_f32 v152, v152, v164
    v_add_f32 v153, v153, v165
    v_lshlrev_b32 v166, 16, v51
    v_and_b32 v167, v168, v51
    v_add_f32 v154, v154, v166
    v_add_f32 v155, v155, v167
    v_lshlrev_b32 v164, 16, v52
    v_and_b32 v165, v168, v52
    v_add_f32 v156, v156, v164
    v_add_f32 v157, v157, v165
    v_lshlrev_b32 v166, 16, v53
    v_and_b32 v167, v168, v53
    v_add_f32 v158, v158, v166
    v_add_f32 v159, v159, v167
    v_lshlrev_b32 v164, 16, v54
    v_and_b32 v165, v168, v54
    v_add_f32 v160, v160, v164
    v_add_f32 v161, v161, v165
    v_lshlrev_b32 v166, 16, v55
    v_and_b32 v167, v168, v55
    v_add_f32 v162, v162, v166
    v_add_f32 v163, v163, v167
    s_waitcnt vmcnt(2)
    v_lshlrev_b32 v164, 16, v56
    v_and_b32 v165, v168, v56
    v_add_f32 v148, v148, v164
    v_add_f32 v149, v149, v165
    v_lshlrev_b32 v166, 16, v57
    v_and_b32 v167, v168, v57
    v_add_f32 v150, v150, v166
    v_add_f32 v151, v151, v167
    v_lshlrev_b32 v164, 16, v58
    v_and_b32 v165, v168, v58
    v_add_f32 v152, v152, v164
    v_add_f32 v153, v153, v165
    v_lshlrev_b32 v166, 16, v59
    v_and_b32 v167, v168, v59
    v_add_f32 v154, v154, v166
    v_add_f32 v155, v155, v167
    v_lshlrev_b32 v164, 16, v60
    v_and_b32 v165, v168, v60
    v_add_f32 v156, v156, v164
    v_add_f32 v157, v157, v165
    v_lshlrev_b32 v166, 16, v61
    v_and_b32 v167, v168, v61
    v_add_f32 v158, v158, v166
    v_add_f32 v159, v159, v167
    v_lshlrev_b32 v164, 16, v62
    v_and_b32 v165, v168, v62
    v_add_f32 v160, v160, v164
    v_add_f32 v161, v161, v165
    v_lshlrev_b32 v166, 16, v63
    v_and_b32 v167, v168, v63
    v_add_f32 v162, v162, v166
    v_add_f32 v163, v163, v167
    s_waitcnt vmcnt(0)
    v_lshlrev_b32 v164, 16, v64
    v_and_b32 v165, v168, v64
    v_add_f32 v148, v148, v164
    v_add_f32 v149, v149, v165
    v_lshlrev_b32 v166, 16, v65
    v_and_b32 v167, v168, v65
    v_add_f32 v150, v150, v166
    v_add_f32 v151, v151, v167
    v_lshlrev_b32 v164, 16, v66
    v_and_b32 v165, v168, v66
    v_add_f32 v152, v152, v164
    v_add_f32 v153, v153, v165
    v_lshlrev_b32 v166, 16, v67
    v_and_b32 v167, v168, v67
    v_add_f32 v154, v154, v166
    v_add_f32 v155, v155, v167
    v_lshlrev_b32 v164, 16, v68
    v_and_b32 v165, v168, v68
    v_add_f32 v156, v156, v164
    v_add_f32 v157, v157, v165
    v_lshlrev_b32 v166, 16, v69
    v_and_b32 v167, v168, v69
    v_add_f32 v158, v158, v166
    v_add_f32 v159, v159, v167
    v_lshlrev_b32 v164, 16, v70
    v_and_b32 v165, v168, v70
    v_add_f32 v160, v160, v164
    v_add_f32 v161, v161, v165
    v_lshlrev_b32 v166, 16, v71
    v_and_b32 v167, v168, v71
    v_add_f32 v162, v162, v166
    v_add_f32 v163, v163, v167
    v_lshrrev_b32 v2, 2, v1
    v_lshlrev_b32 v2, 7, v2
    v_and_b32 v3, 3, v1
    v_lshl_add_u32 v2, v3, 5, v2
    s_mul_i32 s37, s3, 5120
    s_add_u32 s37, s37, 122880
    v_add_u32 v2, s37, v2
    ds_write_b128 v2, v[148:151] offset:0
    ds_write_b128 v2, v[152:155] offset:16
    ds_write_b128 v2, v[156:159] offset:2048
    ds_write_b128 v2, v[160:163] offset:2064
    v_and_b32 v3, 7, v1
    v_lshlrev_b32 v3, 4, v3
    v_add_u32 v3, s37, v3
    ds_write_b128 v3, v[72:75] offset:4096
    s_waitcnt lgkmcnt(0)
    s_barrier
    v_and_b32 v2, 15, v1
    v_lshlrev_b32 v2, 7, v2
    v_lshrrev_b32 v3, 4, v1
    v_lshl_add_u32 v2, v3, 4, v2
    v_lshlrev_b32 v3, 4, v3
    s_mul_i32 s37, s7, 5120
    s_add_u32 s37, s37, 122880
    v_add_u32 v2, s37, v2
    v_add_u32 v3, s37, v3
    ds_read_b128 v[8:11], v2 offset:0
    ds_read_b128 v[12:15], v2 offset:64
    ds_read_b128 v[16:19], v2 offset:2048
    ds_read_b128 v[20:23], v2 offset:2112
    ds_read_b128 v[24:27], v3 offset:4096
    ds_read_b128 v[28:31], v3 offset:4160
    ds_read_b128 v[32:35], v2 offset:10240
    ds_read_b128 v[36:39], v2 offset:10304
    ds_read_b128 v[40:43], v2 offset:12288
    ds_read_b128 v[44:47], v2 offset:12352
    ds_read_b128 v[48:51], v3 offset:14336
    ds_read_b128 v[52:55], v3 offset:14400
    s_waitcnt lgkmcnt(0)
    v_add_f32 v8, v8, v32
    v_add_f32 v9, v9, v33
    v_add_f32 v10, v10, v34
    v_add_f32 v11, v11, v35
    v_add_f32 v12, v12, v36
    v_add_f32 v13, v13, v37
    v_add_f32 v14, v14, v38
    v_add_f32 v15, v15, v39
    v_add_f32 v16, v16, v40
    v_add_f32 v17, v17, v41
    v_add_f32 v18, v18, v42
    v_add_f32 v19, v19, v43
    v_add_f32 v20, v20, v44
    v_add_f32 v21, v21, v45
    v_add_f32 v22, v22, v46
    v_add_f32 v23, v23, v47
    v_add_f32 v24, v24, v48
    v_add_f32 v25, v25, v49
    v_add_f32 v26, v26, v50
    v_add_f32 v27, v27, v51
    v_add_f32 v28, v28, v52
    v_add_f32 v29, v29, v53
    v_add_f32 v30, v30, v54
    v_add_f32 v31, v31, v55
    v_cvt_pk_bf16_f32 v56, v8, v9
    v_cvt_pk_bf16_f32 v57, v10, v11
    v_cvt_pk_bf16_f32 v58, v12, v13
    v_cvt_pk_bf16_f32 v59, v14, v15
    v_cvt_pk_bf16_f32 v60, v16, v17
    v_cvt_pk_bf16_f32 v61, v18, v19
    v_cvt_pk_bf16_f32 v62, v20, v21
    v_cvt_pk_bf16_f32 v63, v22, v23
    v_cvt_pk_bf16_f32 v64, v24, v25
    v_cvt_pk_bf16_f32 v65, v26, v27
    v_cvt_pk_bf16_f32 v66, v28, v29
    v_cvt_pk_bf16_f32 v67, v30, v31
    v_mfma_f32_16x16x32_bf16 v[8:11], v[56:59], v[124:127], 0
    v_mfma_f32_16x16x32_bf16 v[12:15], v[60:63], v[124:127], 0
    v_mfma_f32_16x16x32_bf16 v[16:19], v[64:67], v[124:127], 0
    v_mfma_f32_16x16x32_bf16 v[20:23], v[56:59], v[128:131], 0
    v_mfma_f32_16x16x32_bf16 v[24:27], v[60:63], v[128:131], 0
    v_mfma_f32_16x16x32_bf16 v[28:31], v[64:67], v[128:131], 0
    v_mfma_f32_16x16x32_bf16 v[32:35], v[56:59], v[132:135], 0
    v_mfma_f32_16x16x32_bf16 v[36:39], v[60:63], v[132:135], 0
    v_mfma_f32_16x16x32_bf16 v[40:43], v[64:67], v[132:135], 0
    v_mfma_f32_16x16x32_bf16 v[44:47], v[56:59], v[136:139], 0
    v_mfma_f32_16x16x32_bf16 v[48:51], v[60:63], v[136:139], 0
    v_mfma_f32_16x16x32_bf16 v[52:55], v[64:67], v[136:139], 0
    s_add_u32 s16, s64, 0xf00000
    s_addc_u32 s17, s65, 0
    s_mov_b32 s18, 0x400000
    s_mov_b32 s19, 0x20000
    v_bfe_u32 v169, v1, 4, 1
    v_lshlrev_b32 v169, 5, v169
    v_bfe_u32 v2, v1, 5, 1
    v_lshl_add_u32 v169, v2, 4, v169
    v_and_b32 v2, 15, v1
    s_mov_b32 s68, 2048
    v_mad_u32_u24 v169, v2, s68, v169
    s_lshl_b32 s37, s4, 7
    s_lshl_b32 s38, s6, 6
    s_add_u32 s37, s37, s38
    s_mul_i32 s37, s37, 2048
    s_lshl_b32 s38, s5, 7
    s_add_u32 s37, s37, s38
    s_lshl_b32 s38, s7, 6
    s_add_u32 s37, s37, s38
    v_add_f32 v16, 0x358637bd, v16
    v_rcp_f32 v16, v16
    s_nop 0
    v_mul_f32 v8, v8, v16
    v_mul_f32 v9, v9, v16
    v_mul_f32 v10, v10, v16
    v_mul_f32 v11, v11, v16
    v_mul_f32 v12, v12, v16
    v_mul_f32 v13, v13, v16
    v_mul_f32 v14, v14, v16
    v_mul_f32 v15, v15, v16
    v_cvt_pk_bf16_f32 v172, v8, v9
    v_cvt_pk_bf16_f32 v173, v10, v11
    v_cvt_pk_bf16_f32 v174, v12, v13
    v_cvt_pk_bf16_f32 v175, v14, v15
    s_nop 0
    v_permlane16_swap_b32 v172, v174
    v_permlane16_swap_b32 v173, v175
    s_add_u32 s38, s37, 0
    buffer_store_dwordx4 v[172:175], v169, s[16:19], s38 offen sc1
    v_add_f32 v28, 0x358637bd, v28
    v_rcp_f32 v28, v28
    s_nop 0
    v_mul_f32 v20, v20, v28
    v_mul_f32 v21, v21, v28
    v_mul_f32 v22, v22, v28
    v_mul_f32 v23, v23, v28
    v_mul_f32 v24, v24, v28
    v_mul_f32 v25, v25, v28
    v_mul_f32 v26, v26, v28
    v_mul_f32 v27, v27, v28
    v_cvt_pk_bf16_f32 v176, v20, v21
    v_cvt_pk_bf16_f32 v177, v22, v23
    v_cvt_pk_bf16_f32 v178, v24, v25
    v_cvt_pk_bf16_f32 v179, v26, v27
    s_nop 0
    v_permlane16_swap_b32 v176, v178
    v_permlane16_swap_b32 v177, v179
    s_add_u32 s38, s37, 32768
    buffer_store_dwordx4 v[176:179], v169, s[16:19], s38 offen sc1
    v_add_f32 v40, 0x358637bd, v40
    v_rcp_f32 v40, v40
    s_nop 0
    v_mul_f32 v32, v32, v40
    v_mul_f32 v33, v33, v40
    v_mul_f32 v34, v34, v40
    v_mul_f32 v35, v35, v40
    v_mul_f32 v36, v36, v40
    v_mul_f32 v37, v37, v40
    v_mul_f32 v38, v38, v40
    v_mul_f32 v39, v39, v40
    v_cvt_pk_bf16_f32 v180, v32, v33
    v_cvt_pk_bf16_f32 v181, v34, v35
    v_cvt_pk_bf16_f32 v182, v36, v37
    v_cvt_pk_bf16_f32 v183, v38, v39
    s_nop 0
    v_permlane16_swap_b32 v180, v182
    v_permlane16_swap_b32 v181, v183
    s_add_u32 s38, s37, 65536
    buffer_store_dwordx4 v[180:183], v169, s[16:19], s38 offen sc1
    v_add_f32 v52, 0x358637bd, v52
    v_rcp_f32 v52, v52
    s_nop 0
    v_mul_f32 v44, v44, v52
    v_mul_f32 v45, v45, v52
    v_mul_f32 v46, v46, v52
    v_mul_f32 v47, v47, v52
    v_mul_f32 v48, v48, v52
    v_mul_f32 v49, v49, v52
    v_mul_f32 v50, v50, v52
    v_mul_f32 v51, v51, v52
    v_cvt_pk_bf16_f32 v184, v44, v45
    v_cvt_pk_bf16_f32 v185, v46, v47
    v_cvt_pk_bf16_f32 v186, v48, v49
    v_cvt_pk_bf16_f32 v187, v50, v51
    s_nop 0
    v_permlane16_swap_b32 v184, v186
    v_permlane16_swap_b32 v185, v187
    s_add_u32 s38, s37, 98304
    buffer_store_dwordx4 v[184:187], v169, s[16:19], s38 offen sc1
    s_waitcnt vmcnt(0)
    v_mov_b32 v2, 1
    v_mov_b32 v3, 155648
    s_mov_b64 exec, 1
    ds_add_rtn_u32 v3, v3, v2
    s_waitcnt lgkmcnt(0)
    v_readfirstlane_b32 s68, v3
    s_nop 0
    s_and_b32 s68, s68, 3
    s_cmp_eq_u32 s68, 3
    s_cbranch_scc0 L_nf_11
    s_lshl_b32 s67, s4, 12
    s_add_u32 s67, s67, 65536
    s_lshl_b32 s68, s5, 7
    s_add_u32 s67, s67, s68
    v_mov_b32 v3, 0
    buffer_store_dword v2, v3, s[88:91], s67 offen sc1
L_nf_11:
    s_mov_b64 exec, -1
    s_and_b32 s37, s2, 3
    s_lshl_b32 s37, s37, 2
    s_bfe_u32 s38, s2, 0x20003
    s_add_u32 s4, s37, s38
    s_bfe_u32 s37, s2, 0x10002
    s_lshl_b32 s37, s37, 3
    s_lshr_b32 s38, s2, 5
    s_add_u32 s5, s37, s38
    v_and_b32 v1, 63, v0
    s_mov_b32 s6, s3
    s_mov_b32 s7, 0
    s_mul_i32 s39, s6, 4096
    v_and_b32 v2, 15, v1
    v_lshrrev_b32 v3, 1, v2
    v_lshlrev_b32 v2, 7, v2
    v_add_u32 v2, s39, v2
    v_lshrrev_b32 v4, 4, v1
    v_xor_b32 v3, v3, v4
    v_lshl_add_u32 v4, v3, 4, v2
    v_xor_b32 v5, 64, v4
    v_lshrrev_b32 v2, 4, v1
    v_lshlrev_b32 v2, 3, v2
    v_bfe_u32 v3, v1, 2, 2
    v_add_u32 v44, v2, v3
    v_bfe_u32 v45, v1, 3, 1
    v_lshlrev_b32 v45, 1, v45
    v_bfe_u32 v3, v1, 4, 1
    v_lshl_add_u32 v45, v3, 2, v45
    v_bfe_u32 v3, v1, 1, 1
    v_xor_b32 v3, v3, v45
    v_lshlrev_b32 v3, 4, v3
    v_lshl_add_u32 v3, v44, 7, v3
    v_and_b32 v2, 1, v1
    v_lshl_add_u32 v3, v2, 3, v3
    v_add_u32 v6, 16384, v3
    v_bfe_u32 v3, v1, 1, 1
    v_add_u32 v3, 2, v3
    v_xor_b32 v3, v3, v45
    v_lshlrev_b32 v3, 4, v3
    v_lshl_add_u32 v3, v44, 7, v3
    v_and_b32 v2, 1, v1
    v_lshl_add_u32 v3, v2, 3, v3
    v_add_u32 v7, 16384, v3
    v_bfe_u32 v3, v1, 1, 1
    v_add_u32 v3, 4, v3
    v_xor_b32 v3, v3, v45
    v_lshlrev_b32 v3, 4, v3
    v_lshl_add_u32 v3, v44, 7, v3
    v_and_b32 v2, 1, v1
    v_lshl_add_u32 v3, v2, 3, v3
    v_add_u32 v8, 16384, v3
    v_bfe_u32 v3, v1, 1, 1
    v_add_u32 v3, 6, v3
    v_xor_b32 v3, v3, v45
    v_lshlrev_b32 v3, 4, v3
    v_lshl_add_u32 v3, v44, 7, v3
    v_and_b32 v2, 1, v1
    v_lshl_add_u32 v3, v2, 3, v3
    v_add_u32 v9, 16384, v3
    v_mov_b32 v12, 0
    v_mov_b32 v13, 0
    v_mov_b32 v14, 0
    v_mov_b32 v15, 0
    v_mov_b32 v16, 0
    v_mov_b32 v17, 0
    v_mov_b32 v18, 0
    v_mov_b32 v19, 0
    v_mov_b32 v20, 0
    v_mov_b32 v21, 0
    v_mov_b32 v22, 0
    v_mov_b32 v23, 0
    v_mov_b32 v24, 0
    v_mov_b32 v25, 0
    v_mov_b32 v26, 0
    v_mov_b32 v27, 0
    v_mov_b32 v28, 0
    v_mov_b32 v29, 0
    v_mov_b32 v30, 0
    v_mov_b32 v31, 0
    v_mov_b32 v32, 0
    v_mov_b32 v33, 0
    v_mov_b32 v34, 0
    v_mov_b32 v35, 0
    v_mov_b32 v36, 0
    v_mov_b32 v37, 0
    v_mov_b32 v38, 0
    v_mov_b32 v39, 0
    v_mov_b32 v40, 0
    v_mov_b32 v41, 0
    v_mov_b32 v42, 0
    v_mov_b32 v43, 0
    s_waitcnt lgkmcnt(0)
    s_barrier
    s_mov_b32 s34, 0
    s_mov_b32 s46, -98304
    s_mov_b32 s47, 24576
    s_setprio 2
    s_barrier
    ds_read_b128 v[44:47], v4 offset:0
    ds_read_b64_tr_b16 v[76:77], v6 offset:0
    ds_read_b64_tr_b16 v[78:79], v6 offset:512
    ds_read_b128 v[48:51], v4 offset:2048
    ds_read_b64_tr_b16 v[80:81], v7 offset:0
    ds_read_b64_tr_b16 v[82:83], v7 offset:512
    ds_read_b64_tr_b16 v[84:85], v8 offset:0
    ds_read_b64_tr_b16 v[86:87], v8 offset:512
    ds_read_b64_tr_b16 v[88:89], v9 offset:0
    ds_read_b64_tr_b16 v[90:91], v9 offset:512
    ds_read_b128 v[52:55], v5 offset:0
    ds_read_b64_tr_b16 v[92:93], v6 offset:4096
    ds_read_b64_tr_b16 v[94:95], v6 offset:4608
    ds_read_b128 v[56:59], v5 offset:2048
    ds_read_b64_tr_b16 v[96:97], v7 offset:4096
    ds_read_b64_tr_b16 v[98:99], v7 offset:4608
    ds_read_b64_tr_b16 v[100:101], v8 offset:4096
    ds_read_b64_tr_b16 v[102:103], v8 offset:4608
    ds_read_b64_tr_b16 v[104:105], v9 offset:4096
    ds_read_b64_tr_b16 v[106:107], v9 offset:4608
    s_add_u32 s34, s34, 24576
    s_cmp_eq_u32 s34, 122880
    s_cselect_b32 s36, s46, s47
    s_cselect_b32 s34, 0, s34
    v_add_u32 v4, s36, v4
    v_add_u32 v5, s36, v5
    v_add_u32 v6, s36, v6
    v_add_u32 v7, s36, v7
    v_add_u32 v8, s36, v8
    v_add_u32 v9, s36, v9
    s_waitcnt lgkmcnt(0)
    s_barrier
    s_mov_b32 s35, 7
.p2align 6
L_cl_12:
    v_mfma_f32_16x16x32_bf16 v[12:15], v[76:79], v[44:47], v[12:15]
    ds_read_b128 v[60:63], v4 offset:0
    ds_read_b64_tr_b16 v[108:109], v6 offset:0
    v_mfma_f32_16x16x32_bf16 v[16:19], v[76:79], v[48:51], v[16:19]
    ds_read_b64_tr_b16 v[110:111], v6 offset:512
    ds_read_b128 v[64:67], v4 offset:2048
    v_mfma_f32_16x16x32_bf16 v[20:23], v[80:83], v[44:47], v[20:23]
    ds_read_b64_tr_b16 v[112:113], v7 offset:0
    ds_read_b64_tr_b16 v[114:115], v7 offset:512
    v_mfma_f32_16x16x32_bf16 v[24:27], v[80:83], v[48:51], v[24:27]
    ds_read_b64_tr_b16 v[116:117], v8 offset:0
    ds_read_b64_tr_b16 v[118:119], v8 offset:512
    v_mfma_f32_16x16x32_bf16 v[28:31], v[84:87], v[44:47], v[28:31]
    ds_read_b64_tr_b16 v[120:121], v9 offset:0
    ds_read_b64_tr_b16 v[122:123], v9 offset:512
    v_mfma_f32_16x16x32_bf16 v[32:35], v[84:87], v[48:51], v[32:35]
    ds_read_b128 v[68:71], v5 offset:0
    ds_read_b64_tr_b16 v[124:125], v6 offset:4096
    v_mfma_f32_16x16x32_bf16 v[36:39], v[88:91], v[44:47], v[36:39]
    ds_read_b64_tr_b16 v[126:127], v6 offset:4608
    ds_read_b128 v[72:75], v5 offset:2048
    v_mfma_f32_16x16x32_bf16 v[40:43], v[88:91], v[48:51], v[40:43]
    ds_read_b64_tr_b16 v[128:129], v7 offset:4096
    ds_read_b64_tr_b16 v[130:131], v7 offset:4608
    v_mfma_f32_16x16x32_bf16 v[12:15], v[92:95], v[52:55], v[12:15]
    ds_read_b64_tr_b16 v[132:133], v8 offset:4096
    ds_read_b64_tr_b16 v[134:135], v8 offset:4608
    v_mfma_f32_16x16x32_bf16 v[16:19], v[92:95], v[56:59], v[16:19]
    ds_read_b64_tr_b16 v[136:137], v9 offset:4096
    ds_read_b64_tr_b16 v[138:139], v9 offset:4608
    v_mfma_f32_16x16x32_bf16 v[20:23], v[96:99], v[52:55], v[20:23]
    s_add_u32 s34, s34, 24576
    s_cmp_eq_u32 s34, 122880
    v_mfma_f32_16x16x32_bf16 v[24:27], v[96:99], v[56:59], v[24:27]
    s_cselect_b32 s36, s46, s47
    s_cselect_b32 s34, 0, s34
    v_mfma_f32_16x16x32_bf16 v[28:31], v[100:103], v[52:55], v[28:31]
    v_add_u32 v4, s36, v4
    v_add_u32 v5, s36, v5
    v_mfma_f32_16x16x32_bf16 v[32:35], v[100:103], v[56:59], v[32:35]
    v_add_u32 v6, s36, v6
    v_add_u32 v7, s36, v7
    v_mfma_f32_16x16x32_bf16 v[36:39], v[104:107], v[52:55], v[36:39]
    v_add_u32 v8, s36, v8
    v_add_u32 v9, s36, v9
    v_mfma_f32_16x16x32_bf16 v[40:43], v[104:107], v[56:59], v[40:43]
    s_waitcnt lgkmcnt(0)
    s_barrier
    v_mfma_f32_16x16x32_bf16 v[12:15], v[108:111], v[60:63], v[12:15]
    ds_read_b128 v[44:47], v4 offset:0
    ds_read_b64_tr_b16 v[76:77], v6 offset:0
    v_mfma_f32_16x16x32_bf16 v[16:19], v[108:111], v[64:67], v[16:19]
    ds_read_b64_tr_b16 v[78:79], v6 offset:512
    ds_read_b128 v[48:51], v4 offset:2048
    v_mfma_f32_16x16x32_bf16 v[20:23], v[112:115], v[60:63], v[20:23]
    ds_read_b64_tr_b16 v[80:81], v7 offset:0
    ds_read_b64_tr_b16 v[82:83], v7 offset:512
    v_mfma_f32_16x16x32_bf16 v[24:27], v[112:115], v[64:67], v[24:27]
    ds_read_b64_tr_b16 v[84:85], v8 offset:0
    ds_read_b64_tr_b16 v[86:87], v8 offset:512
    v_mfma_f32_16x16x32_bf16 v[28:31], v[116:119], v[60:63], v[28:31]
    ds_read_b64_tr_b16 v[88:89], v9 offset:0
    ds_read_b64_tr_b16 v[90:91], v9 offset:512
    v_mfma_f32_16x16x32_bf16 v[32:35], v[116:119], v[64:67], v[32:35]
    ds_read_b128 v[52:55], v5 offset:0
    ds_read_b64_tr_b16 v[92:93], v6 offset:4096
    v_mfma_f32_16x16x32_bf16 v[36:39], v[120:123], v[60:63], v[36:39]
    ds_read_b64_tr_b16 v[94:95], v6 offset:4608
    ds_read_b128 v[56:59], v5 offset:2048
    v_mfma_f32_16x16x32_bf16 v[40:43], v[120:123], v[64:67], v[40:43]
    ds_read_b64_tr_b16 v[96:97], v7 offset:4096
    ds_read_b64_tr_b16 v[98:99], v7 offset:4608
    v_mfma_f32_16x16x32_bf16 v[12:15], v[124:127], v[68:71], v[12:15]
    ds_read_b64_tr_b16 v[100:101], v8 offset:4096
    ds_read_b64_tr_b16 v[102:103], v8 offset:4608
    v_mfma_f32_16x16x32_bf16 v[16:19], v[124:127], v[72:75], v[16:19]
    ds_read_b64_tr_b16 v[104:105], v9 offset:4096
    ds_read_b64_tr_b16 v[106:107], v9 offset:4608
    v_mfma_f32_16x16x32_bf16 v[20:23], v[128:131], v[68:71], v[20:23]
    s_add_u32 s34, s34, 24576
    s_cmp_eq_u32 s34, 122880
    v_mfma_f32_16x16x32_bf16 v[24:27], v[128:131], v[72:75], v[24:27]
    s_cselect_b32 s36, s46, s47
    s_cselect_b32 s34, 0, s34
    v_mfma_f32_16x16x32_bf16 v[28:31], v[132:135], v[68:71], v[28:31]
    v_add_u32 v4, s36, v4
    v_add_u32 v5, s36, v5
    v_mfma_f32_16x16x32_bf16 v[32:35], v[132:135], v[72:75], v[32:35]
    v_add_u32 v6, s36, v6
    v_add_u32 v7, s36, v7
    v_mfma_f32_16x16x32_bf16 v[36:39], v[136:139], v[68:71], v[36:39]
    v_add_u32 v8, s36, v8
    v_add_u32 v9, s36, v9
    v_mfma_f32_16x16x32_bf16 v[40:43], v[136:139], v[72:75], v[40:43]
    s_sub_u32 s35, s35, 1
    s_cmp_lg_u32 s35, 0
    s_waitcnt lgkmcnt(0)
    s_barrier
    s_cbranch_scc1 L_cl_12
    v_mfma_f32_16x16x32_bf16 v[12:15], v[76:79], v[44:47], v[12:15]
    ds_read_b128 v[60:63], v4 offset:0
    ds_read_b64_tr_b16 v[108:109], v6 offset:0
    v_mfma_f32_16x16x32_bf16 v[16:19], v[76:79], v[48:51], v[16:19]
    ds_read_b64_tr_b16 v[110:111], v6 offset:512
    ds_read_b128 v[64:67], v4 offset:2048
    v_mfma_f32_16x16x32_bf16 v[20:23], v[80:83], v[44:47], v[20:23]
    ds_read_b64_tr_b16 v[112:113], v7 offset:0
    ds_read_b64_tr_b16 v[114:115], v7 offset:512
    v_mfma_f32_16x16x32_bf16 v[24:27], v[80:83], v[48:51], v[24:27]
    ds_read_b64_tr_b16 v[116:117], v8 offset:0
    ds_read_b64_tr_b16 v[118:119], v8 offset:512
    v_mfma_f32_16x16x32_bf16 v[28:31], v[84:87], v[44:47], v[28:31]
    ds_read_b64_tr_b16 v[120:121], v9 offset:0
    ds_read_b64_tr_b16 v[122:123], v9 offset:512
    v_mfma_f32_16x16x32_bf16 v[32:35], v[84:87], v[48:51], v[32:35]
    ds_read_b128 v[68:71], v5 offset:0
    ds_read_b64_tr_b16 v[124:125], v6 offset:4096
    v_mfma_f32_16x16x32_bf16 v[36:39], v[88:91], v[44:47], v[36:39]
    ds_read_b64_tr_b16 v[126:127], v6 offset:4608
    ds_read_b128 v[72:75], v5 offset:2048
    v_mfma_f32_16x16x32_bf16 v[40:43], v[88:91], v[48:51], v[40:43]
    ds_read_b64_tr_b16 v[128:129], v7 offset:4096
    ds_read_b64_tr_b16 v[130:131], v7 offset:4608
    v_mfma_f32_16x16x32_bf16 v[12:15], v[92:95], v[52:55], v[12:15]
    ds_read_b64_tr_b16 v[132:133], v8 offset:4096
    ds_read_b64_tr_b16 v[134:135], v8 offset:4608
    v_mfma_f32_16x16x32_bf16 v[16:19], v[92:95], v[56:59], v[16:19]
    ds_read_b64_tr_b16 v[136:137], v9 offset:4096
    ds_read_b64_tr_b16 v[138:139], v9 offset:4608
    v_mfma_f32_16x16x32_bf16 v[20:23], v[96:99], v[52:55], v[20:23]
    v_mfma_f32_16x16x32_bf16 v[24:27], v[96:99], v[56:59], v[24:27]
    v_mfma_f32_16x16x32_bf16 v[28:31], v[100:103], v[52:55], v[28:31]
    v_mfma_f32_16x16x32_bf16 v[32:35], v[100:103], v[56:59], v[32:35]
    v_mfma_f32_16x16x32_bf16 v[36:39], v[104:107], v[52:55], v[36:39]
    v_mfma_f32_16x16x32_bf16 v[40:43], v[104:107], v[56:59], v[40:43]
    s_waitcnt lgkmcnt(0)
    s_barrier
    v_mfma_f32_16x16x32_bf16 v[12:15], v[108:111], v[60:63], v[12:15]
    v_mfma_f32_16x16x32_bf16 v[16:19], v[108:111], v[64:67], v[16:19]
    v_mfma_f32_16x16x32_bf16 v[20:23], v[112:115], v[60:63], v[20:23]
    v_mfma_f32_16x16x32_bf16 v[24:27], v[112:115], v[64:67], v[24:27]
    v_mfma_f32_16x16x32_bf16 v[28:31], v[116:119], v[60:63], v[28:31]
    v_mfma_f32_16x16x32_bf16 v[32:35], v[116:119], v[64:67], v[32:35]
    v_mfma_f32_16x16x32_bf16 v[36:39], v[120:123], v[60:63], v[36:39]
    v_mfma_f32_16x16x32_bf16 v[40:43], v[120:123], v[64:67], v[40:43]
    v_mfma_f32_16x16x32_bf16 v[12:15], v[124:127], v[68:71], v[12:15]
    v_mfma_f32_16x16x32_bf16 v[16:19], v[124:127], v[72:75], v[16:19]
    v_mfma_f32_16x16x32_bf16 v[20:23], v[128:131], v[68:71], v[20:23]
    v_mfma_f32_16x16x32_bf16 v[24:27], v[128:131], v[72:75], v[24:27]
    v_mfma_f32_16x16x32_bf16 v[28:31], v[132:135], v[68:71], v[28:31]
    v_mfma_f32_16x16x32_bf16 v[32:35], v[132:135], v[72:75], v[32:35]
    v_mfma_f32_16x16x32_bf16 v[36:39], v[136:139], v[68:71], v[36:39]
    v_mfma_f32_16x16x32_bf16 v[40:43], v[136:139], v[72:75], v[40:43]
    s_setprio 0
    v_and_b32 v2, 15, v1
    v_lshrrev_b32 v3, 1, v2
    v_lshlrev_b32 v2, 7, v2
    s_lshl_b32 s37, s6, 12
    s_add_u32 s37, s37, 135168
    v_add_u32 v2, s37, v2
    v_bfe_u32 v64, v1, 4, 1
    v_lshl_add_u32 v2, v64, 3, v2
    v_bfe_u32 v64, v1, 5, 1
    v_add_u32 v65, 0, v64
    v_xor_b32 v65, v65, v3
    v_lshl_add_u32 v60, v65, 4, v2
    v_add_u32 v65, 2, v64
    v_xor_b32 v65, v65, v3
    v_lshl_add_u32 v61, v65, 4, v2
    v_add_u32 v65, 4, v64
    v_xor_b32 v65, v65, v3
    v_lshl_add_u32 v62, v65, 4, v2
    v_add_u32 v65, 6, v64
    v_xor_b32 v65, v65, v3
    v_lshl_add_u32 v63, v65, 4, v2
    ds_read_b64 v[44:45], v60 offset:0
    ds_read_b64 v[46:47], v61 offset:0
    ds_read_b64 v[48:49], v62 offset:0
    ds_read_b64 v[50:51], v63 offset:0
    ds_read_b64 v[52:53], v60 offset:2048
    ds_read_b64 v[54:55], v61 offset:2048
    ds_read_b64 v[56:57], v62 offset:2048
    ds_read_b64 v[58:59], v63 offset:2048
    s_mov_b32 s16, s64
    s_mov_b32 s17, s65
    s_mov_b32 s18, 0x400000
    s_mov_b32 s19, 0x20000
    s_add_u32 s24, s64, 0x3c40000
    s_addc_u32 s25, s65, 0
    s_mov_b32 s26, 0x40000
    s_mov_b32 s27, 0x20000
    v_bfe_u32 v64, v1, 4, 1
    v_lshlrev_b32 v64, 5, v64
    v_bfe_u32 v2, v1, 5, 1
    v_lshl_add_u32 v64, v2, 4, v64
    v_and_b32 v2, 15, v1
    s_mov_b32 s68, 2048
    v_mad_u32_u24 v64, v2, s68, v64
    s_lshl_b32 s37, s4, 7
    s_lshl_b32 s38, s6, 5
    s_add_u32 s69, s37, s38
    s_mul_i32 s37, s69, 2048
    s_lshl_b32 s38, s5, 7
    s_add_u32 s37, s37, s38
    v_mov_b32 v96, 0xffff0000
    s_waitcnt lgkmcnt(0)
    v_lshlrev_b32 v76, 16, v44
    v_and_b32 v77, v96, v44
    v_lshlrev_b32 v78, 16, v45
    v_and_b32 v79, v96, v45
    v_add_f32 v12, v12, v76
    v_add_f32 v13, v13, v77
    v_add_f32 v14, v14, v78
    v_add_f32 v15, v15, v79
    v_cvt_pk_bf16_f32 v80, v12, v13
    v_cvt_pk_bf16_f32 v81, v14, v15
    v_mov_b32 v70, v12
    v_mul_f32 v72, v12, v12
    v_mov_b32 v71, v13
    v_mul_f32 v73, v13, v13
    v_add_f32 v70, v70, v14
    v_fmac_f32 v72, v14, v14
    v_add_f32 v71, v71, v15
    v_fmac_f32 v73, v15, v15
    v_lshlrev_b32 v76, 16, v46
    v_and_b32 v77, v96, v46
    v_lshlrev_b32 v78, 16, v47
    v_and_b32 v79, v96, v47
    v_add_f32 v20, v20, v76
    v_add_f32 v21, v21, v77
    v_add_f32 v22, v22, v78
    v_add_f32 v23, v23, v79
    v_cvt_pk_bf16_f32 v82, v20, v21
    v_cvt_pk_bf16_f32 v83, v22, v23
    v_add_f32 v70, v70, v20
    v_fmac_f32 v72, v20, v20
    v_add_f32 v71, v71, v21
    v_fmac_f32 v73, v21, v21
    v_add_f32 v70, v70, v22
    v_fmac_f32 v72, v22, v22
    v_add_f32 v71, v71, v23
    v_fmac_f32 v73, v23, v23
    v_lshlrev_b32 v76, 16, v48
    v_and_b32 v77, v96, v48
    v_lshlrev_b32 v78, 16, v49
    v_and_b32 v79, v96, v49
    v_add_f32 v28, v28, v76
    v_add_f32 v29, v29, v77
    v_add_f32 v30, v30, v78
    v_add_f32 v31, v31, v79
    v_cvt_pk_bf16_f32 v84, v28, v29
    v_cvt_pk_bf16_f32 v85, v30, v31
    v_add_f32 v70, v70, v28
    v_fmac_f32 v72, v28, v28
    v_add_f32 v71, v71, v29
    v_fmac_f32 v73, v29, v29
    v_add_f32 v70, v70, v30
    v_fmac_f32 v72, v30, v30
    v_add_f32 v71, v71, v31
    v_fmac_f32 v73, v31, v31
    v_lshlrev_b32 v76, 16, v50
    v_and_b32 v77, v96, v50
    v_lshlrev_b32 v78, 16, v51
    v_and_b32 v79, v96, v51
    v_add_f32 v36, v36, v76
    v_add_f32 v37, v37, v77
    v_add_f32 v38, v38, v78
    v_add_f32 v39, v39, v79
    v_cvt_pk_bf16_f32 v86, v36, v37
    v_cvt_pk_bf16_f32 v87, v38, v39
    v_add_f32 v70, v70, v36
    v_fmac_f32 v72, v36, v36
    v_add_f32 v71, v71, v37
    v_fmac_f32 v73, v37, v37
    v_add_f32 v70, v70, v38
    v_fmac_f32 v72, v38, v38
    v_add_f32 v71, v71, v39
    v_fmac_f32 v73, v39, v39
    v_add_f32 v66, v70, v71
    v_add_f32 v67, v72, v73
    v_permlane16_swap_b32 v80, v82
    v_permlane16_swap_b32 v81, v83
    s_add_u32 s38, s37, 0
    buffer_store_dwordx4 v[80:83], v64, s[16:19], s38 offen offset:0 sc1
    v_permlane16_swap_b32 v84, v86
    v_permlane16_swap_b32 v85, v87
    s_add_u32 s38, s37, 0
    buffer_store_dwordx4 v[84:87], v64, s[16:19], s38 offen offset:64 sc1
    v_lshlrev_b32 v76, 16, v52
    v_and_b32 v77, v96, v52
    v_lshlrev_b32 v78, 16, v53
    v_and_b32 v79, v96, v53
    v_add_f32 v16, v16, v76
    v_add_f32 v17, v17, v77
    v_add_f32 v18, v18, v78
    v_add_f32 v19, v19, v79
    v_cvt_pk_bf16_f32 v88, v16, v17
    v_cvt_pk_bf16_f32 v89, v18, v19
    v_mov_b32 v70, v16
    v_mul_f32 v72, v16, v16
    v_mov_b32 v71, v17
    v_mul_f32 v73, v17, v17
    v_add_f32 v70, v70, v18
    v_fmac_f32 v72, v18, v18
    v_add_f32 v71, v71, v19
    v_fmac_f32 v73, v19, v19
    v_lshlrev_b32 v76, 16, v54
    v_and_b32 v77, v96, v54
    v_lshlrev_b32 v78, 16, v55
    v_and_b32 v79, v96, v55
    v_add_f32 v24, v24, v76
    v_add_f32 v25, v25, v77
    v_add_f32 v26, v26, v78
    v_add_f32 v27, v27, v79
    v_cvt_pk_bf16_f32 v90, v24, v25
    v_cvt_pk_bf16_f32 v91, v26, v27
    v_add_f32 v70, v70, v24
    v_fmac_f32 v72, v24, v24
    v_add_f32 v71, v71, v25
    v_fmac_f32 v73, v25, v25
    v_add_f32 v70, v70, v26
    v_fmac_f32 v72, v26, v26
    v_add_f32 v71, v71, v27
    v_fmac_f32 v73, v27, v27
    v_lshlrev_b32 v76, 16, v56
    v_and_b32 v77, v96, v56
    v_lshlrev_b32 v78, 16, v57
    v_and_b32 v79, v96, v57
    v_add_f32 v32, v32, v76
    v_add_f32 v33, v33, v77
    v_add_f32 v34, v34, v78
    v_add_f32 v35, v35, v79
    v_cvt_pk_bf16_f32 v92, v32, v33
    v_cvt_pk_bf16_f32 v93, v34, v35
    v_add_f32 v70, v70, v32
    v_fmac_f32 v72, v32, v32
    v_add_f32 v71, v71, v33
    v_fmac_f32 v73, v33, v33
    v_add_f32 v70, v70, v34
    v_fmac_f32 v72, v34, v34
    v_add_f32 v71, v71, v35
    v_fmac_f32 v73, v35, v35
    v_lshlrev_b32 v76, 16, v58
    v_and_b32 v77, v96, v58
    v_lshlrev_b32 v78, 16, v59
    v_and_b32 v79, v96, v59
    v_add_f32 v40, v40, v76
    v_add_f32 v41, v41, v77
    v_add_f32 v42, v42, v78
    v_add_f32 v43, v43, v79
    v_cvt_pk_bf16_f32 v94, v40, v41
    v_cvt_pk_bf16_f32 v95, v42, v43
    v_add_f32 v70, v70, v40
    v_fmac_f32 v72, v40, v40
    v_add_f32 v71, v71, v41
    v_fmac_f32 v73, v41, v41
    v_add_f32 v70, v70, v42
    v_fmac_f32 v72, v42, v42
    v_add_f32 v71, v71, v43
    v_fmac_f32 v73, v43, v43
    v_add_f32 v68, v70, v71
    v_add_f32 v69, v72, v73
    v_permlane16_swap_b32 v88, v90
    v_permlane16_swap_b32 v89, v91
    s_add_u32 s38, s37, 32768
    buffer_store_dwordx4 v[88:91], v64, s[16:19], s38 offen offset:0 sc1
    v_permlane16_swap_b32 v92, v94
    v_permlane16_swap_b32 v93, v95
    s_add_u32 s38, s37, 32768
    buffer_store_dwordx4 v[92:95], v64, s[16:19], s38 offen offset:64 sc1
    v_mov_b32 v76, v66
    v_mov_b32 v77, v67
    v_mov_b32 v78, v68
    v_mov_b32 v79, v69
    v_permlane16_swap_b32 v76, v66
    v_permlane16_swap_b32 v77, v67
    v_permlane16_swap_b32 v78, v68
    v_permlane16_swap_b32 v79, v69
    v_add_f32 v66, v66, v76
    v_add_f32 v67, v67, v77
    v_add_f32 v68, v68, v78
    v_add_f32 v69, v69, v79
    v_mov_b32 v76, v66
    v_mov_b32 v77, v67
    v_mov_b32 v78, v68
    v_mov_b32 v79, v69
    v_permlane32_swap_b32 v76, v66
    v_permlane32_swap_b32 v77, v67
    v_permlane32_swap_b32 v78, v68
    v_permlane32_swap_b32 v79, v69
    v_add_f32 v66, v66, v76
    v_add_f32 v67, v67, v77
    v_add_f32 v68, v68, v78
    v_add_f32 v69, v69, v79
    v_cmp_le_u32 vcc, 16, v1
    s_nop 1
    v_cndmask_b32 v66, v66, v68, vcc
    v_cndmask_b32 v67, v67, v69, vcc
    v_lshlrev_b32 v2, 3, v1
    s_lshl_b32 s37, s69, 3
    s_lshl_b32 s38, s5, 14
    s_add_u32 s37, s37, s38
    s_mov_b32 exec_hi, 0
    buffer_store_dwordx2 v[66:67], v2, s[24:27], s37 offen sc1
    s_mov_b64 exec, -1
    s_barrier
    s_waitcnt vmcnt(0)
    v_mov_b32 v2, 1
    v_mov_b32 v3, 155648
    s_mov_b64 exec, 1
    ds_add_rtn_u32 v3, v3, v2
    s_waitcnt lgkmcnt(0)
    v_readfirstlane_b32 s68, v3
    s_nop 0
    s_and_b32 s68, s68, 3
    s_cmp_eq_u32 s68, 3
    s_cbranch_scc0 L_nf_13
    s_lshl_b32 s67, s4, 12
    s_add_u32 s67, s67, 131072
    s_lshl_b32 s68, s5, 7
    s_add_u32 s67, s67, s68
    v_mov_b32 v3, 0
    buffer_store_dword v2, v3, s[88:91], s67 offen sc1
L_nf_13:
    s_mov_b64 exec, -1
    s_and_b32 s37, s2, 1
    s_lshl_b32 s37, s37, 3
    s_bfe_u32 s38, s2, 0x30003
    s_add_u32 s4, s37, s38
    s_bfe_u32 s37, s2, 0x20001
    s_lshl_b32 s37, s37, 2
    s_lshr_b32 s38, s2, 6
    s_add_u32 s5, s37, s38
    v_and_b32 v1, 63, v0
    s_lshr_b32 s6, s3, 1
    s_and_b32 s7, s3, 1
    s_mul_i32 s39, s6, 8192
    v_and_b32 v2, 15, v1
    v_lshrrev_b32 v3, 1, v2
    v_lshlrev_b32 v2, 7, v2
    v_add_u32 v2, s39, v2
    v_lshrrev_b32 v4, 4, v1
    v_xor_b32 v3, v3, v4
    v_lshl_add_u32 v4, v3, 4, v2
    v_xor_b32 v5, 64, v4
    v_lshrrev_b32 v2, 4, v1
    v_lshlrev_b32 v2, 3, v2
    v_bfe_u32 v3, v1, 2, 2
    v_add_u32 v124, v2, v3
    v_bfe_u32 v125, v1, 3, 1
    v_lshlrev_b32 v125, 1, v125
    v_bfe_u32 v3, v1, 4, 1
    v_lshl_add_u32 v125, v3, 2, v125
    v_bfe_u32 v3, v1, 1, 1
    s_lshl_b32 s39, s7, 2
    s_add_u32 s39, s39, 0
    v_add_u32 v3, s39, v3
    v_xor_b32 v3, v3, v125
    v_lshlrev_b32 v3, 4, v3
    v_lshl_add_u32 v3, v124, 7, v3
    v_and_b32 v2, 1, v1
    v_lshl_add_u32 v3, v2, 3, v3
    v_add_u32 v6, 16384, v3
    v_bfe_u32 v3, v1, 1, 1
    s_lshl_b32 s39, s7, 2
    s_add_u32 s39, s39, 2
    v_add_u32 v3, s39, v3
    v_xor_b32 v3, v3, v125
    v_lshlrev_b32 v3, 4, v3
    v_lshl_add_u32 v3, v124, 7, v3
    v_and_b32 v2, 1, v1
    v_lshl_add_u32 v3, v2, 3, v3
    v_add_u32 v7, 16384, v3
    v_bfe_u32 v3, v1, 1, 1
    s_lshl_b32 s39, s7, 1
    v_add_u32 v3, s39, v3
    v_bfe_u32 v2, v1, 4, 1
    v_lshlrev_b32 v2, 1, v2
    v_xor_b32 v3, v3, v2
    v_lshlrev_b32 v3, 4, v3
    v_lshl_add_u32 v3, v124, 6, v3
    v_and_b32 v2, 1, v1
    v_lshl_add_u32 v3, v2, 3, v3
    v_add_u32 v8, 40960, v3
    v_mov_b32 v12, 0
    v_mov_b32 v13, 0
    v_mov_b32 v14, 0
    v_mov_b32 v15, 0
    v_mov_b32 v16, 0
    v_mov_b32 v17, 0
    v_mov_b32 v18, 0
    v_mov_b32 v19, 0
    v_mov_b32 v20, 0
    v_mov_b32 v21, 0
    v_mov_b32 v22, 0
    v_mov_b32 v23, 0
    v_mov_b32 v24, 0
    v_mov_b32 v25, 0
    v_mov_b32 v26, 0
    v_mov_b32 v27, 0
    v_mov_b32 v28, 0
    v_mov_b32 v29, 0
    v_mov_b32 v30, 0
    v_mov_b32 v31, 0
    v_mov_b32 v32, 0
    v_mov_b32 v33, 0
    v_mov_b32 v34, 0
    v_mov_b32 v35, 0
    v_mov_b32 v36, 0
    v_mov_b32 v37, 0
    v_mov_b32 v38, 0
    v_mov_b32 v39, 0
    v_mov_b32 v40, 0
    v_mov_b32 v41, 0
    v_mov_b32 v42, 0
    v_mov_b32 v43, 0
    v_mov_b32 v44, 0
    v_mov_b32 v45, 0
    v_mov_b32 v46, 0
    v_mov_b32 v47, 0
    v_mov_b32 v48, 0
    v_mov_b32 v49, 0
    v_mov_b32 v50, 0
    v_mov_b32 v51, 0
    v_mov_b32 v52, 0
    v_mov_b32 v53, 0
    v_mov_b32 v54, 0
    v_mov_b32 v55, 0
    v_mov_b32 v56, 0
    v_mov_b32 v57, 0
    v_mov_b32 v58, 0
    v_mov_b32 v59, 0
    v_mov_b32 v60, 0
    v_mov_b32 v61, 0
    v_mov_b32 v62, 0
    v_mov_b32 v63, 0
    v_mov_b32 v64, 0
    v_mov_b32 v65, 0
    v_mov_b32 v66, 0
    v_mov_b32 v67, 0
    v_mov_b32 v68, 0
    v_mov_b32 v69, 0
    v_mov_b32 v70, 0
    v_mov_b32 v71, 0
    v_mov_b32 v72, 0
    v_mov_b32 v73, 0
    v_mov_b32 v74, 0
    v_mov_b32 v75, 0
    v_mov_b32 v76, 0
    v_mov_b32 v77, 0
    v_mov_b32 v78, 0
    v_mov_b32 v79, 0
    v_mov_b32 v80, 0
    v_mov_b32 v81, 0
    v_mov_b32 v82, 0
    v_mov_b32 v83, 0
    v_mov_b32 v84, 0
    v_mov_b32 v85, 0
    v_mov_b32 v86, 0
    v_mov_b32 v87, 0
    v_mov_b32 v88, 0
    v_mov_b32 v89, 0
    v_mov_b32 v90, 0
    v_mov_b32 v91, 0
    v_mov_b32 v92, 0
    v_mov_b32 v93, 0
    v_mov_b32 v94, 0
    v_mov_b32 v95, 0
    v_mov_b32 v96, 0
    v_mov_b32 v97, 0
    v_mov_b32 v98, 0
    v_mov_b32 v99, 0
    v_mov_b32 v100, 0
    v_mov_b32 v101, 0
    v_mov_b32 v102, 0
    v_mov_b32 v103, 0
    v_mov_b32 v104, 0
    v_mov_b32 v105, 0
    v_mov_b32 v106, 0
    v_mov_b32 v107, 0
    v_mov_b32 v108, 0
    v_mov_b32 v109, 0
    v_mov_b32 v110, 0
    v_mov_b32 v111, 0
    v_mov_b32 v112, 0
    v_mov_b32 v113, 0
    v_mov_b32 v114, 0
    v_mov_b32 v115, 0
    v_mov_b32 v116, 0
    v_mov_b32 v117, 0
    v_mov_b32 v118, 0
    v_mov_b32 v119, 0
    v_mov_b32 v120, 0
    v_mov_b32 v121, 0
    v_mov_b32 v122, 0
    v_mov_b32 v123, 0
    s_waitcnt lgkmcnt(0)
    s_barrier
    s_mov_b32 s34, 0
    s_mov_b32 s46, -90112
    s_mov_b32 s47, 45056
    s_setprio 2
    s_barrier
    ds_read_b128 v[124:127], v4 offset:0
    ds_read_b64_tr_b16 v[156:157], v6 offset:0
    ds_read_b64_tr_b16 v[158:159], v6 offset:512
    ds_read_b128 v[128:131], v4 offset:2048
    ds_read_b128 v[132:135], v4 offset:4096
    ds_read_b128 v[136:139], v4 offset:6144
    ds_read_b64_tr_b16 v[160:161], v7 offset:0
    ds_read_b64_tr_b16 v[162:163], v7 offset:512
    ds_read_b64_tr_b16 v[164:165], v6 offset:8192
    ds_read_b64_tr_b16 v[166:167], v6 offset:8704
    ds_read_b64_tr_b16 v[168:169], v7 offset:8192
    ds_read_b64_tr_b16 v[170:171], v7 offset:8704
    ds_read_b64_tr_b16 v[172:173], v6 offset:16384
    ds_read_b64_tr_b16 v[174:175], v6 offset:16896
    ds_read_b64_tr_b16 v[176:177], v7 offset:16384
    ds_read_b64_tr_b16 v[178:179], v7 offset:16896
    ds_read_b64_tr_b16 v[180:181], v8 offset:0
    ds_read_b64_tr_b16 v[182:183], v8 offset:256
    v_mov_b32 v212, 0x3f803f80
    v_mov_b32 v213, 0x3f803f80
    v_mov_b32 v214, 0x3f803f80
    v_mov_b32 v215, 0x3f803f80
    s_waitcnt lgkmcnt(0)
    v_mfma_f32_16x16x32_bf16 v[12:15], v[156:159], v[124:127], v[12:15]
    ds_read_b128 v[140:143], v5 offset:0
    v_mfma_f32_16x16x32_bf16 v[16:19], v[156:159], v[128:131], v[16:19]
    ds_read_b64_tr_b16 v[184:185], v6 offset:4096
    v_mfma_f32_16x16x32_bf16 v[20:23], v[156:159], v[132:135], v[20:23]
    ds_read_b64_tr_b16 v[186:187], v6 offset:4608
    v_mfma_f32_16x16x32_bf16 v[24:27], v[156:159], v[136:139], v[24:27]
    ds_read_b128 v[144:147], v5 offset:2048
    v_mfma_f32_16x16x32_bf16 v[28:31], v[160:163], v[124:127], v[28:31]
    ds_read_b128 v[148:151], v5 offset:4096
    v_mfma_f32_16x16x32_bf16 v[32:35], v[160:163], v[128:131], v[32:35]
    ds_read_b128 v[152:155], v5 offset:6144
    v_mfma_f32_16x16x32_bf16 v[36:39], v[160:163], v[132:135], v[36:39]
    ds_read_b64_tr_b16 v[188:189], v7 offset:4096
    v_mfma_f32_16x16x32_bf16 v[40:43], v[160:163], v[136:139], v[40:43]
    ds_read_b64_tr_b16 v[190:191], v7 offset:4608
    v_mfma_f32_16x16x32_bf16 v[44:47], v[164:167], v[124:127], v[44:47]
    ds_read_b64_tr_b16 v[192:193], v6 offset:12288
    v_mfma_f32_16x16x32_bf16 v[48:51], v[164:167], v[128:131], v[48:51]
    ds_read_b64_tr_b16 v[194:195], v6 offset:12800
    v_mfma_f32_16x16x32_bf16 v[52:55], v[164:167], v[132:135], v[52:55]
    ds_read_b64_tr_b16 v[196:197], v7 offset:12288
    v_mfma_f32_16x16x32_bf16 v[56:59], v[164:167], v[136:139], v[56:59]
    ds_read_b64_tr_b16 v[198:199], v7 offset:12800
    v_mfma_f32_16x16x32_bf16 v[60:63], v[168:171], v[124:127], v[60:63]
    ds_read_b64_tr_b16 v[200:201], v6 offset:20480
    v_mfma_f32_16x16x32_bf16 v[64:67], v[168:171], v[128:131], v[64:67]
    ds_read_b64_tr_b16 v[202:203], v6 offset:20992
    v_mfma_f32_16x16x32_bf16 v[68:71], v[168:171], v[132:135], v[68:71]
    ds_read_b64_tr_b16 v[204:205], v7 offset:20480
    v_mfma_f32_16x16x32_bf16 v[72:75], v[168:171], v[136:139], v[72:75]
    ds_read_b64_tr_b16 v[206:207], v7 offset:20992
    v_mfma_f32_16x16x32_bf16 v[76:79], v[172:175], v[124:127], v[76:79]
    ds_read_b64_tr_b16 v[208:209], v8 offset:2048
    v_mfma_f32_16x16x32_bf16 v[80:83], v[172:175], v[128:131], v[80:83]
    ds_read_b64_tr_b16 v[210:211], v8 offset:2304
    v_mfma_f32_16x16x32_bf16 v[84:87], v[172:175], v[132:135], v[84:87]
    s_add_u32 s34, s34, 45056
    v_mfma_f32_16x16x32_bf16 v[88:91], v[172:175], v[136:139], v[88:91]
    s_cmp_eq_u32 s34, 135168
    v_mfma_f32_16x16x32_bf16 v[92:95], v[176:179], v[124:127], v[92:95]
    s_cselect_b32 s36, s46, s47
    v_mfma_f32_16x16x32_bf16 v[96:99], v[176:179], v[128:131], v[96:99]
    s_cselect_b32 s34, 0, s34
    v_mfma_f32_16x16x32_bf16 v[100:103], v[176:179], v[132:135], v[100:103]
    v_add_u32 v4, s36, v4
    v_mfma_f32_16x16x32_bf16 v[104:107], v[176:179], v[136:139], v[104:107]
    v_add_u32 v5, s36, v5
    v_mfma_f32_16x16x32_bf16 v[108:111], v[180:183], v[124:127], v[108:111]
    v_add_u32 v6, s36, v6
    v_mfma_f32_16x16x32_bf16 v[112:115], v[180:183], v[128:131], v[112:115]
    v_add_u32 v7, s36, v7
    v_mfma_f32_16x16x32_bf16 v[116:119], v[180:183], v[132:135], v[116:119]
    v_add_u32 v8, s36, v8
    v_mfma_f32_16x16x32_bf16 v[120:123], v[180:183], v[136:139], v[120:123]
    v_mfma_f32_16x16x32_bf16 v[216:219], v[212:215], v[156:159], 0
    v_mfma_f32_16x16x32_bf16 v[220:223], v[212:215], v[160:163], 0
    v_mfma_f32_16x16x32_bf16 v[224:227], v[212:215], v[164:167], 0
    v_mfma_f32_16x16x32_bf16 v[228:231], v[212:215], v[168:171], 0
    v_mfma_f32_16x16x32_bf16 v[232:235], v[212:215], v[172:175], 0
    v_mfma_f32_16x16x32_bf16 v[236:239], v[212:215], v[176:179], 0
    v_mfma_f32_16x16x32_bf16 v[240:243], v[212:215], v[180:183], 0
    s_waitcnt lgkmcnt(0)
    s_barrier
    v_mfma_f32_16x16x32_bf16 v[12:15], v[184:187], v[140:143], v[12:15]
    ds_read_b128 v[124:127], v4 offset:0
    v_mfma_f32_16x16x32_bf16 v[16:19], v[184:187], v[144:147], v[16:19]
    ds_read_b64_tr_b16 v[156:157], v6 offset:0
    v_mfma_f32_16x16x32_bf16 v[20:23], v[184:187], v[148:151], v[20:23]
    ds_read_b64_tr_b16 v[158:159], v6 offset:512
    v_mfma_f32_16x16x32_bf16 v[24:27], v[184:187], v[152:155], v[24:27]
    ds_read_b128 v[128:131], v4 offset:2048
    v_mfma_f32_16x16x32_bf16 v[28:31], v[188:191], v[140:143], v[28:31]
    ds_read_b128 v[132:135], v4 offset:4096
    v_mfma_f32_16x16x32_bf16 v[32:35], v[188:191], v[144:147], v[32:35]
    ds_read_b128 v[136:139], v4 offset:6144
    v_mfma_f32_16x16x32_bf16 v[36:39], v[188:191], v[148:151], v[36:39]
    ds_read_b64_tr_b16 v[160:161], v7 offset:0
    v_mfma_f32_16x16x32_bf16 v[40:43], v[188:191], v[152:155], v[40:43]
    ds_read_b64_tr_b16 v[162:163], v7 offset:512
    v_mfma_f32_16x16x32_bf16 v[44:47], v[192:195], v[140:143], v[44:47]
    ds_read_b64_tr_b16 v[164:165], v6 offset:8192
    v_mfma_f32_16x16x32_bf16 v[48:51], v[192:195], v[144:147], v[48:51]
    ds_read_b64_tr_b16 v[166:167], v6 offset:8704
    v_mfma_f32_16x16x32_bf16 v[52:55], v[192:195], v[148:151], v[52:55]
    ds_read_b64_tr_b16 v[168:169], v7 offset:8192
    v_mfma_f32_16x16x32_bf16 v[56:59], v[192:195], v[152:155], v[56:59]
    ds_read_b64_tr_b16 v[170:171], v7 offset:8704
    v_mfma_f32_16x16x32_bf16 v[60:63], v[196:199], v[140:143], v[60:63]
    ds_read_b64_tr_b16 v[172:173], v6 offset:16384
    v_mfma_f32_16x16x32_bf16 v[64:67], v[196:199], v[144:147], v[64:67]
    ds_read_b64_tr_b16 v[174:175], v6 offset:16896
    v_mfma_f32_16x16x32_bf16 v[68:71], v[196:199], v[148:151], v[68:71]
    ds_read_b64_tr_b16 v[176:177], v7 offset:16384
    v_mfma_f32_16x16x32_bf16 v[72:75], v[196:199], v[152:155], v[72:75]
    ds_read_b64_tr_b16 v[178:179], v7 offset:16896
    v_mfma_f32_16x16x32_bf16 v[76:79], v[200:203], v[140:143], v[76:79]
    ds_read_b64_tr_b16 v[180:181], v8 offset:0
    v_mfma_f32_16x16x32_bf16 v[80:83], v[200:203], v[144:147], v[80:83]
    ds_read_b64_tr_b16 v[182:183], v8 offset:256
    v_mfma_f32_16x16x32_bf16 v[84:87], v[200:203], v[148:151], v[84:87]
    v_mfma_f32_16x16x32_bf16 v[88:91], v[200:203], v[152:155], v[88:91]
    v_mfma_f32_16x16x32_bf16 v[92:95], v[204:207], v[140:143], v[92:95]
    v_mfma_f32_16x16x32_bf16 v[96:99], v[204:207], v[144:147], v[96:99]
    v_mfma_f32_16x16x32_bf16 v[100:103], v[204:207], v[148:151], v[100:103]
    v_mfma_f32_16x16x32_bf16 v[104:107], v[204:207], v[152:155], v[104:107]
    v_mfma_f32_16x16x32_bf16 v[108:111], v[208:211], v[140:143], v[108:111]
    v_mfma_f32_16x16x32_bf16 v[112:115], v[208:211], v[144:147], v[112:115]
    v_mfma_f32_16x16x32_bf16 v[116:119], v[208:211], v[148:151], v[116:119]
    v_mfma_f32_16x16x32_bf16 v[120:123], v[208:211], v[152:155], v[120:123]
    v_mfma_f32_16x16x32_bf16 v[216:219], v[212:215], v[184:187], v[216:219]
    v_mfma_f32_16x16x32_bf16 v[220:223], v[212:215], v[188:191], v[220:223]
    v_mfma_f32_16x16x32_bf16 v[224:227], v[212:215], v[192:195], v[224:227]
    v_mfma_f32_16x16x32_bf16 v[228:231], v[212:215], v[196:199], v[228:231]
    v_mfma_f32_16x16x32_bf16 v[232:235], v[212:215], v[200:203], v[232:235]
    v_mfma_f32_16x16x32_bf16 v[236:239], v[212:215], v[204:207], v[236:239]
    v_mfma_f32_16x16x32_bf16 v[240:243], v[212:215], v[208:211], v[240:243]
    s_add_u32 s69, s4, s5
    s_and_b32 s69, s69, 15
    s_cmp_lg_u32 s6, 0
    s_cbranch_scc1 L_nocs_15
    s_add_u32 s16, s64, 0x3e40000
    s_addc_u32 s17, s65, 0
    s_mov_b32 s18, 0x38000
    s_mov_b32 s19, 0x20000
    s_mul_i32 s37, s69, 14336
    s_lshr_b32 s39, s5, 1
    s_mul_i32 s39, s39, 896
    s_and_b32 s66, s5, 1
    s_lshl_b32 s66, s66, 9
    s_add_u32 s39, s39, s66
    s_and_b32 s66, s5, 1
    s_mul_i32 s66, s66, -448
    s_add_u32 s66, s66, 384
    s_lshl_b32 s38, s39, 1
    s_add_u32 s37, s37, s38
    s_lshl_b32 s38, s7, 7
    s_add_u32 s68, s37, s38
    v_lshlrev_b32 v2, 2, v1
    v_cmp_le_u32 vcc, 16, v1
    s_nop 1
    v_cndmask_b32 v216, v216, v220, vcc
    v_cndmask_b32 v224, v224, v228, vcc
    v_cndmask_b32 v232, v232, v236, vcc
    s_mov_b32 exec_hi, 0
    s_add_u32 s38, s68, 0
    buffer_store_dword v216, v2, s[16:19], s38 offen sc1
    s_add_u32 s38, s68, 256
    buffer_store_dword v224, v2, s[16:19], s38 offen sc1
    s_add_u32 s38, s68, 512
    buffer_store_dword v232, v2, s[16:19], s38 offen sc1
    s_lshl_b32 s38, s66, 1
    s_add_u32 s38, s38, s37
    s_lshl_b32 s67, s7, 6
    s_add_u32 s38, s38, s67
    s_mov_b32 exec_lo, 0xffff
    buffer_store_dword v240, v2, s[16:19], s38 offen sc1
    s_mov_b64 exec, -1
L_nocs_15:
    s_mov_b32 s35, 14
    s_waitcnt lgkmcnt(0)
.p2align 6
L_cl_14:
    s_cmp_lg_u32 s35, 13
    s_cbranch_scc1 L_vm_16
    s_waitcnt vmcnt(0)
L_vm_16:
    v_mfma_f32_16x16x32_bf16 v[12:15], v[156:159], v[124:127], v[12:15]
    ds_read_b128 v[140:143], v5 offset:0
    v_mfma_f32_16x16x32_bf16 v[16:19], v[156:159], v[128:131], v[16:19]
    ds_read_b64_tr_b16 v[184:185], v6 offset:4096
    v_mfma_f32_16x16x32_bf16 v[20:23], v[156:159], v[132:135], v[20:23]
    ds_read_b64_tr_b16 v[186:187], v6 offset:4608
    v_mfma_f32_16x16x32_bf16 v[24:27], v[156:159], v[136:139], v[24:27]
    ds_read_b128 v[144:147], v5 offset:2048
    v_mfma_f32_16x16x32_bf16 v[28:31], v[160:163], v[124:127], v[28:31]
    ds_read_b128 v[148:151], v5 offset:4096
    v_mfma_f32_16x16x32_bf16 v[32:35], v[160:163], v[128:131], v[32:35]
    ds_read_b128 v[152:155], v5 offset:6144
    v_mfma_f32_16x16x32_bf16 v[36:39], v[160:163], v[132:135], v[36:39]
    ds_read_b64_tr_b16 v[188:189], v7 offset:4096
    v_mfma_f32_16x16x32_bf16 v[40:43], v[160:163], v[136:139], v[40:43]
    ds_read_b64_tr_b16 v[190:191], v7 offset:4608
    v_mfma_f32_16x16x32_bf16 v[44:47], v[164:167], v[124:127], v[44:47]
    ds_read_b64_tr_b16 v[192:193], v6 offset:12288
    v_mfma_f32_16x16x32_bf16 v[48:51], v[164:167], v[128:131], v[48:51]
    ds_read_b64_tr_b16 v[194:195], v6 offset:12800
    v_mfma_f32_16x16x32_bf16 v[52:55], v[164:167], v[132:135], v[52:55]
    ds_read_b64_tr_b16 v[196:197], v7 offset:12288
    v_mfma_f32_16x16x32_bf16 v[56:59], v[164:167], v[136:139], v[56:59]
    ds_read_b64_tr_b16 v[198:199], v7 offset:12800
    v_mfma_f32_16x16x32_bf16 v[60:63], v[168:171], v[124:127], v[60:63]
    ds_read_b64_tr_b16 v[200:201], v6 offset:20480
    v_mfma_f32_16x16x32_bf16 v[64:67], v[168:171], v[128:131], v[64:67]
    ds_read_b64_tr_b16 v[202:203], v6 offset:20992
    v_mfma_f32_16x16x32_bf16 v[68:71], v[168:171], v[132:135], v[68:71]
    ds_read_b64_tr_b16 v[204:205], v7 offset:20480
    v_mfma_f32_16x16x32_bf16 v[72:75], v[168:171], v[136:139], v[72:75]
    ds_read_b64_tr_b16 v[206:207], v7 offset:20992
    v_mfma_f32_16x16x32_bf16 v[76:79], v[172:175], v[124:127], v[76:79]
    ds_read_b64_tr_b16 v[208:209], v8 offset:2048
    v_mfma_f32_16x16x32_bf16 v[80:83], v[172:175], v[128:131], v[80:83]
    ds_read_b64_tr_b16 v[210:211], v8 offset:2304
    v_mfma_f32_16x16x32_bf16 v[84:87], v[172:175], v[132:135], v[84:87]
    s_add_u32 s34, s34, 45056
    v_mfma_f32_16x16x32_bf16 v[88:91], v[172:175], v[136:139], v[88:91]
    s_cmp_eq_u32 s34, 135168
    v_mfma_f32_16x16x32_bf16 v[92:95], v[176:179], v[124:127], v[92:95]
    s_cselect_b32 s36, s46, s47
    v_mfma_f32_16x16x32_bf16 v[96:99], v[176:179], v[128:131], v[96:99]
    s_cselect_b32 s34, 0, s34
    v_mfma_f32_16x16x32_bf16 v[100:103], v[176:179], v[132:135], v[100:103]
    v_add_u32 v4, s36, v4
    v_mfma_f32_16x16x32_bf16 v[104:107], v[176:179], v[136:139], v[104:107]
    v_add_u32 v5, s36, v5
    v_mfma_f32_16x16x32_bf16 v[108:111], v[180:183], v[124:127], v[108:111]
    v_add_u32 v6, s36, v6
    v_mfma_f32_16x16x32_bf16 v[112:115], v[180:183], v[128:131], v[112:115]
    v_add_u32 v7, s36, v7
    v_mfma_f32_16x16x32_bf16 v[116:119], v[180:183], v[132:135], v[116:119]
    v_add_u32 v8, s36, v8
    v_mfma_f32_16x16x32_bf16 v[120:123], v[180:183], v[136:139], v[120:123]
    s_waitcnt lgkmcnt(0)
    s_barrier
    v_mfma_f32_16x16x32_bf16 v[12:15], v[184:187], v[140:143], v[12:15]
    ds_read_b128 v[124:127], v4 offset:0
    v_mfma_f32_16x16x32_bf16 v[16:19], v[184:187], v[144:147], v[16:19]
    ds_read_b64_tr_b16 v[156:157], v6 offset:0
    v_mfma_f32_16x16x32_bf16 v[20:23], v[184:187], v[148:151], v[20:23]
    ds_read_b64_tr_b16 v[158:159], v6 offset:512
    v_mfma_f32_16x16x32_bf16 v[24:27], v[184:187], v[152:155], v[24:27]
    ds_read_b128 v[128:131], v4 offset:2048
    v_mfma_f32_16x16x32_bf16 v[28:31], v[188:191], v[140:143], v[28:31]
    ds_read_b128 v[132:135], v4 offset:4096
    v_mfma_f32_16x16x32_bf16 v[32:35], v[188:191], v[144:147], v[32:35]
    ds_read_b128 v[136:139], v4 offset:6144
    v_mfma_f32_16x16x32_bf16 v[36:39], v[188:191], v[148:151], v[36:39]
    ds_read_b64_tr_b16 v[160:161], v7 offset:0
    v_mfma_f32_16x16x32_bf16 v[40:43], v[188:191], v[152:155], v[40:43]
    ds_read_b64_tr_b16 v[162:163], v7 offset:512
    v_mfma_f32_16x16x32_bf16 v[44:47], v[192:195], v[140:143], v[44:47]
    ds_read_b64_tr_b16 v[164:165], v6 offset:8192
    v_mfma_f32_16x16x32_bf16 v[48:51], v[192:195], v[144:147], v[48:51]
    ds_read_b64_tr_b16 v[166:167], v6 offset:8704
    v_mfma_f32_16x16x32_bf16 v[52:55], v[192:195], v[148:151], v[52:55]
    ds_read_b64_tr_b16 v[168:169], v7 offset:8192
    v_mfma_f32_16x16x32_bf16 v[56:59], v[192:195], v[152:155], v[56:59]
    ds_read_b64_tr_b16 v[170:171], v7 offset:8704
    v_mfma_f32_16x16x32_bf16 v[60:63], v[196:199], v[140:143], v[60:63]
    ds_read_b64_tr_b16 v[172:173], v6 offset:16384
    v_mfma_f32_16x16x32_bf16 v[64:67], v[196:199], v[144:147], v[64:67]
    ds_read_b64_tr_b16 v[174:175], v6 offset:16896
    v_mfma_f32_16x16x32_bf16 v[68:71], v[196:199], v[148:151], v[68:71]
    ds_read_b64_tr_b16 v[176:177], v7 offset:16384
    v_mfma_f32_16x16x32_bf16 v[72:75], v[196:199], v[152:155], v[72:75]
    ds_read_b64_tr_b16 v[178:179], v7 offset:16896
    v_mfma_f32_16x16x32_bf16 v[76:79], v[200:203], v[140:143], v[76:79]
    ds_read_b64_tr_b16 v[180:181], v8 offset:0
    v_mfma_f32_16x16x32_bf16 v[80:83], v[200:203], v[144:147], v[80:83]
    ds_read_b64_tr_b16 v[182:183], v8 offset:256
    v_mfma_f32_16x16x32_bf16 v[84:87], v[200:203], v[148:151], v[84:87]
    v_mfma_f32_16x16x32_bf16 v[88:91], v[200:203], v[152:155], v[88:91]
    v_mfma_f32_16x16x32_bf16 v[92:95], v[204:207], v[140:143], v[92:95]
    v_mfma_f32_16x16x32_bf16 v[96:99], v[204:207], v[144:147], v[96:99]
    v_mfma_f32_16x16x32_bf16 v[100:103], v[204:207], v[148:151], v[100:103]
    v_mfma_f32_16x16x32_bf16 v[104:107], v[204:207], v[152:155], v[104:107]
    v_mfma_f32_16x16x32_bf16 v[108:111], v[208:211], v[140:143], v[108:111]
    v_mfma_f32_16x16x32_bf16 v[112:115], v[208:211], v[144:147], v[112:115]
    v_mfma_f32_16x16x32_bf16 v[116:119], v[208:211], v[148:151], v[116:119]
    v_mfma_f32_16x16x32_bf16 v[120:123], v[208:211], v[152:155], v[120:123]
    s_sub_u32 s35, s35, 1
    s_cmp_lg_u32 s35, 0
    s_waitcnt lgkmcnt(0)
    s_cbranch_scc1 L_cl_14
    v_mfma_f32_16x16x32_bf16 v[12:15], v[156:159], v[124:127], v[12:15]
    ds_read_b128 v[140:143], v5 offset:0
    v_mfma_f32_16x16x32_bf16 v[16:19], v[156:159], v[128:131], v[16:19]
    ds_read_b64_tr_b16 v[184:185], v6 offset:4096
    v_mfma_f32_16x16x32_bf16 v[20:23], v[156:159], v[132:135], v[20:23]
    ds_read_b64_tr_b16 v[186:187], v6 offset:4608
    v_mfma_f32_16x16x32_bf16 v[24:27], v[156:159], v[136:139], v[24:27]
    ds_read_b128 v[144:147], v5 offset:2048
    v_mfma_f32_16x16x32_bf16 v[28:31], v[160:163], v[124:127], v[28:31]
    ds_read_b128 v[148:151], v5 offset:4096
    v_mfma_f32_16x16x32_bf16 v[32:35], v[160:163], v[128:131], v[32:35]
    ds_read_b128 v[152:155], v5 offset:6144
    v_mfma_f32_16x16x32_bf16 v[36:39], v[160:163], v[132:135], v[36:39]
    ds_read_b64_tr_b16 v[188:189], v7 offset:4096
    v_mfma_f32_16x16x32_bf16 v[40:43], v[160:163], v[136:139], v[40:43]
    ds_read_b64_tr_b16 v[190:191], v7 offset:4608
    v_mfma_f32_16x16x32_bf16 v[44:47], v[164:167], v[124:127], v[44:47]
    ds_read_b64_tr_b16 v[192:193], v6 offset:12288
    v_mfma_f32_16x16x32_bf16 v[48:51], v[164:167], v[128:131], v[48:51]
    ds_read_b64_tr_b16 v[194:195], v6 offset:12800
    v_mfma_f32_16x16x32_bf16 v[52:55], v[164:167], v[132:135], v[52:55]
    ds_read_b64_tr_b16 v[196:197], v7 offset:12288
    v_mfma_f32_16x16x32_bf16 v[56:59], v[164:167], v[136:139], v[56:59]
    ds_read_b64_tr_b16 v[198:199], v7 offset:12800
    v_mfma_f32_16x16x32_bf16 v[60:63], v[168:171], v[124:127], v[60:63]
    ds_read_b64_tr_b16 v[200:201], v6 offset:20480
    v_mfma_f32_16x16x32_bf16 v[64:67], v[168:171], v[128:131], v[64:67]
    ds_read_b64_tr_b16 v[202:203], v6 offset:20992
    v_mfma_f32_16x16x32_bf16 v[68:71], v[168:171], v[132:135], v[68:71]
    ds_read_b64_tr_b16 v[204:205], v7 offset:20480
    v_mfma_f32_16x16x32_bf16 v[72:75], v[168:171], v[136:139], v[72:75]
    ds_read_b64_tr_b16 v[206:207], v7 offset:20992
    v_mfma_f32_16x16x32_bf16 v[76:79], v[172:175], v[124:127], v[76:79]
    ds_read_b64_tr_b16 v[208:209], v8 offset:2048
    v_mfma_f32_16x16x32_bf16 v[80:83], v[172:175], v[128:131], v[80:83]
    ds_read_b64_tr_b16 v[210:211], v8 offset:2304
    v_mfma_f32_16x16x32_bf16 v[84:87], v[172:175], v[132:135], v[84:87]
    v_mfma_f32_16x16x32_bf16 v[88:91], v[172:175], v[136:139], v[88:91]
    v_mfma_f32_16x16x32_bf16 v[92:95], v[176:179], v[124:127], v[92:95]
    v_mfma_f32_16x16x32_bf16 v[96:99], v[176:179], v[128:131], v[96:99]
    v_mfma_f32_16x16x32_bf16 v[100:103], v[176:179], v[132:135], v[100:103]
    v_mfma_f32_16x16x32_bf16 v[104:107], v[176:179], v[136:139], v[104:107]
    v_mfma_f32_16x16x32_bf16 v[108:111], v[180:183], v[124:127], v[108:111]
    v_mfma_f32_16x16x32_bf16 v[112:115], v[180:183], v[128:131], v[112:115]
    v_mfma_f32_16x16x32_bf16 v[116:119], v[180:183], v[132:135], v[116:119]
    v_mfma_f32_16x16x32_bf16 v[120:123], v[180:183], v[136:139], v[120:123]
    s_waitcnt lgkmcnt(0)
    s_barrier
    v_mfma_f32_16x16x32_bf16 v[12:15], v[184:187], v[140:143], v[12:15]
    v_mfma_f32_16x16x32_bf16 v[16:19], v[184:187], v[144:147], v[16:19]
    v_mfma_f32_16x16x32_bf16 v[20:23], v[184:187], v[148:151], v[20:23]
    v_mfma_f32_16x16x32_bf16 v[24:27], v[184:187], v[152:155], v[24:27]
    v_mfma_f32_16x16x32_bf16 v[28:31], v[188:191], v[140:143], v[28:31]
    v_mfma_f32_16x16x32_bf16 v[32:35], v[188:191], v[144:147], v[32:35]
    v_mfma_f32_16x16x32_bf16 v[36:39], v[188:191], v[148:151], v[36:39]
    v_mfma_f32_16x16x32_bf16 v[40:43], v[188:191], v[152:155], v[40:43]
    v_mfma_f32_16x16x32_bf16 v[44:47], v[192:195], v[140:143], v[44:47]
    v_mfma_f32_16x16x32_bf16 v[48:51], v[192:195], v[144:147], v[48:51]
    v_mfma_f32_16x16x32_bf16 v[52:55], v[192:195], v[148:151], v[52:55]
    v_mfma_f32_16x16x32_bf16 v[56:59], v[192:195], v[152:155], v[56:59]
    v_mfma_f32_16x16x32_bf16 v[60:63], v[196:199], v[140:143], v[60:63]
    v_mfma_f32_16x16x32_bf16 v[64:67], v[196:199], v[144:147], v[64:67]
    v_mfma_f32_16x16x32_bf16 v[68:71], v[196:199], v[148:151], v[68:71]
    v_mfma_f32_16x16x32_bf16 v[72:75], v[196:199], v[152:155], v[72:75]
    v_mfma_f32_16x16x32_bf16 v[76:79], v[200:203], v[140:143], v[76:79]
    v_mfma_f32_16x16x32_bf16 v[80:83], v[200:203], v[144:147], v[80:83]
    v_mfma_f32_16x16x32_bf16 v[84:87], v[200:203], v[148:151], v[84:87]
    v_mfma_f32_16x16x32_bf16 v[88:91], v[200:203], v[152:155], v[88:91]
    v_mfma_f32_16x16x32_bf16 v[92:95], v[204:207], v[140:143], v[92:95]
    v_mfma_f32_16x16x32_bf16 v[96:99], v[204:207], v[144:147], v[96:99]
    v_mfma_f32_16x16x32_bf16 v[100:103], v[204:207], v[148:151], v[100:103]
    v_mfma_f32_16x16x32_bf16 v[104:107], v[204:207], v[152:155], v[104:107]
    v_mfma_f32_16x16x32_bf16 v[108:111], v[208:211], v[140:143], v[108:111]
    v_mfma_f32_16x16x32_bf16 v[112:115], v[208:211], v[144:147], v[112:115]
    v_mfma_f32_16x16x32_bf16 v[116:119], v[208:211], v[148:151], v[116:119]
    v_mfma_f32_16x16x32_bf16 v[120:123], v[208:211], v[152:155], v[120:123]
    s_setprio 0
    s_lshl_b32 s69, s6, 8
    s_add_u32 s69, s69, 151552
    v_and_b32 v188, 15, v1
    v_lshlrev_b32 v188, 2, v188
    v_add_u32 v188, s69, v188
    ds_read_b32 v124, v188 offset:0
    ds_read_b32 v128, v188 offset:512
    ds_read_b32 v132, v188 offset:1024
    ds_read_b32 v125, v188 offset:64
    ds_read_b32 v129, v188 offset:576
    ds_read_b32 v133, v188 offset:1088
    ds_read_b32 v126, v188 offset:128
    ds_read_b32 v130, v188 offset:640
    ds_read_b32 v134, v188 offset:1152
    ds_read_b32 v127, v188 offset:192
    ds_read_b32 v131, v188 offset:704
    ds_read_b32 v135, v188 offset:1216
    v_lshrrev_b32 v189, 4, v1
    v_lshlrev_b32 v189, 4, v189
    v_add_u32 v189, 154624, v189
    s_lshl_b32 s37, s7, 6
    v_add_u32 v191, s37, v189
    s_lshl_b32 s37, s7, 7
    v_add_u32 v189, s37, v189
    s_waitcnt lgkmcnt(0)
    ds_read_b128 v[136:139], v189 offset:0
    ds_read_b128 v[140:143], v189 offset:64
    ds_read_b128 v[144:147], v189 offset:256
    ds_read_b128 v[148:151], v189 offset:320
    ds_read_b128 v[152:155], v189 offset:512
    ds_read_b128 v[156:159], v189 offset:576
    ds_read_b128 v[160:163], v191 offset:768
    s_add_u32 s16, s64, 0x4200000
    s_addc_u32 s17, s65, 0
    s_mov_b32 s18, 0xe00000
    s_mov_b32 s19, 0x20000
    s_lshr_b32 s39, s5, 1
    s_mul_i32 s39, s39, 896
    s_and_b32 s66, s5, 1
    s_lshl_b32 s66, s66, 9
    s_add_u32 s39, s39, s66
    s_and_b32 s66, s5, 1
    s_mul_i32 s66, s66, -448
    s_add_u32 s66, s66, 384
    v_bfe_u32 v190, v1, 4, 1
    v_lshlrev_b32 v190, 5, v190
    v_bfe_u32 v2, v1, 5, 1
    v_lshl_add_u32 v190, v2, 4, v190
    v_and_b32 v2, 15, v1
    v_mul_u32_u24 v2, 7168, v2
    v_add_u32 v190, v190, v2
    s_lshl_b32 s37, s7, 6
    v_add_u32 v190, s37, v190
    v_lshrrev_b32 v191, 4, v1
    v_lshl_add_u32 v191, v191, 3, v2
    s_lshl_b32 s37, s7, 5
    s_add_u32 s37, s37, s66
    s_add_u32 s37, s37, s39
    v_add_u32 v191, s37, v191
    v_add_u32 v190, s39, v190
    s_lshl_b32 s37, s4, 7
    s_lshl_b32 s38, s6, 6
    s_add_u32 s37, s37, s38
    s_mul_i32 s37, s37, 7168
    s_waitcnt lgkmcnt(0)
    v_fmac_f32 v108, v124, v160
    v_fmac_f32 v109, v124, v161
    v_fmac_f32 v110, v124, v162
    v_fmac_f32 v111, v124, v163
    v_mul_f32 v164, v108, v128
    v_mul_f32 v165, v109, v128
    v_mul_f32 v166, v110, v128
    v_mul_f32 v167, v111, v128
    v_exp_f32 v164, v164
    v_exp_f32 v165, v165
    v_exp_f32 v166, v166
    v_exp_f32 v167, v167
    v_fma_f32 v164, v164, v132, v132
    v_fma_f32 v165, v165, v132, v132
    v_fma_f32 v166, v166, v132, v132
    v_fma_f32 v167, v167, v132, v132
    v_rcp_f32 v164, v164
    v_rcp_f32 v165, v165
    v_rcp_f32 v166, v166
    v_rcp_f32 v167, v167
    v_mul_f32 v108, v108, v164
    v_mul_f32 v109, v109, v165
    v_mul_f32 v110, v110, v166
    v_mul_f32 v111, v111, v167
    v_cvt_pk_bf16_f32 v192, v108, v109
    v_cvt_pk_bf16_f32 v193, v110, v111
    v_fmac_f32 v112, v125, v160
    v_fmac_f32 v113, v125, v161
    v_fmac_f32 v114, v125, v162
    v_fmac_f32 v115, v125, v163
    v_mul_f32 v168, v112, v129
    v_mul_f32 v169, v113, v129
    v_mul_f32 v170, v114, v129
    v_mul_f32 v171, v115, v129
    v_exp_f32 v168, v168
    v_exp_f32 v169, v169
    v_exp_f32 v170, v170
    v_exp_f32 v171, v171
    v_fma_f32 v168, v168, v133, v133
    v_fma_f32 v169, v169, v133, v133
    v_fma_f32 v170, v170, v133, v133
    v_fma_f32 v171, v171, v133, v133
    v_rcp_f32 v168, v168
    v_rcp_f32 v169, v169
    v_rcp_f32 v170, v170
    v_rcp_f32 v171, v171
    v_mul_f32 v112, v112, v168
    v_mul_f32 v113, v113, v169
    v_mul_f32 v114, v114, v170
    v_mul_f32 v115, v115, v171
    v_cvt_pk_bf16_f32 v194, v112, v113
    v_cvt_pk_bf16_f32 v195, v114, v115
    v_fmac_f32 v116, v126, v160
    v_fmac_f32 v117, v126, v161
    v_fmac_f32 v118, v126, v162
    v_fmac_f32 v119, v126, v163
    v_mul_f32 v208, v116, v130
    v_mul_f32 v209, v117, v130
    v_mul_f32 v210, v118, v130
    v_mul_f32 v211, v119, v130
    v_exp_f32 v208, v208
    v_exp_f32 v209, v209
    v_exp_f32 v210, v210
    v_exp_f32 v211, v211
    v_fma_f32 v208, v208, v134, v134
    v_fma_f32 v209, v209, v134, v134
    v_fma_f32 v210, v210, v134, v134
    v_fma_f32 v211, v211, v134, v134
    v_rcp_f32 v208, v208
    v_rcp_f32 v209, v209
    v_rcp_f32 v210, v210
    v_rcp_f32 v211, v211
    v_mul_f32 v116, v116, v208
    v_mul_f32 v117, v117, v209
    v_mul_f32 v118, v118, v210
    v_mul_f32 v119, v119, v211
    v_cvt_pk_bf16_f32 v196, v116, v117
    v_cvt_pk_bf16_f32 v197, v118, v119
    v_fmac_f32 v120, v127, v160
    v_fmac_f32 v121, v127, v161
    v_fmac_f32 v122, v127, v162
    v_fmac_f32 v123, v127, v163
    v_mul_f32 v164, v120, v131
    v_mul_f32 v165, v121, v131
    v_mul_f32 v166, v122, v131
    v_mul_f32 v167, v123, v131
    v_exp_f32 v164, v164
    v_exp_f32 v165, v165
    v_exp_f32 v166, v166
    v_exp_f32 v167, v167
    v_fma_f32 v164, v164, v135, v135
    v_fma_f32 v165, v165, v135, v135
    v_fma_f32 v166, v166, v135, v135
    v_fma_f32 v167, v167, v135, v135
    v_rcp_f32 v164, v164
    v_rcp_f32 v165, v165
    v_rcp_f32 v166, v166
    v_rcp_f32 v167, v167
    v_mul_f32 v120, v120, v164
    v_mul_f32 v121, v121, v165
    v_mul_f32 v122, v122, v166
    v_mul_f32 v123, v123, v167
    v_cvt_pk_bf16_f32 v198, v120, v121
    v_cvt_pk_bf16_f32 v199, v122, v123
    v_lshlrev_b32 v204, 4, v1
    s_lshl_b32 s38, s3, 10
    s_add_u32 s38, s38, 131072
    v_add_u32 v204, s38, v204
    s_cmp_eq_u32 s7, 0
    s_cbranch_scc0 L_g7a_17
    ds_write_b128 v204, v[196:199]
    s_branch L_g7b_18
L_g7a_17:
    ds_write_b128 v204, v[192:195]
L_g7b_18:
    v_fmac_f32 v12, v124, v136
    v_fmac_f32 v13, v124, v137
    v_fmac_f32 v14, v124, v138
    v_fmac_f32 v15, v124, v139
    v_fmac_f32 v28, v124, v140
    v_fmac_f32 v29, v124, v141
    v_fmac_f32 v30, v124, v142
    v_fmac_f32 v31, v124, v143
    v_mul_f32 v164, v12, v128
    v_mul_f32 v165, v13, v128
    v_mul_f32 v166, v14, v128
    v_mul_f32 v167, v15, v128
    v_mul_f32 v168, v28, v128
    v_mul_f32 v169, v29, v128
    v_mul_f32 v170, v30, v128
    v_mul_f32 v171, v31, v128
    v_exp_f32 v164, v164
    v_exp_f32 v165, v165
    v_exp_f32 v166, v166
    v_exp_f32 v167, v167
    v_exp_f32 v168, v168
    v_exp_f32 v169, v169
    v_exp_f32 v170, v170
    v_exp_f32 v171, v171
    v_fma_f32 v164, v164, v132, v132
    v_fma_f32 v165, v165, v132, v132
    v_fma_f32 v166, v166, v132, v132
    v_fma_f32 v167, v167, v132, v132
    v_fma_f32 v168, v168, v132, v132
    v_fma_f32 v169, v169, v132, v132
    v_fma_f32 v170, v170, v132, v132
    v_fma_f32 v171, v171, v132, v132
    v_rcp_f32 v164, v164
    v_rcp_f32 v165, v165
    v_rcp_f32 v166, v166
    v_rcp_f32 v167, v167
    v_rcp_f32 v168, v168
    v_rcp_f32 v169, v169
    v_rcp_f32 v170, v170
    v_rcp_f32 v171, v171
    v_mul_f32 v12, v12, v164
    v_mul_f32 v13, v13, v165
    v_mul_f32 v14, v14, v166
    v_mul_f32 v15, v15, v167
    v_mul_f32 v28, v28, v168
    v_mul_f32 v29, v29, v169
    v_mul_f32 v30, v30, v170
    v_mul_f32 v31, v31, v171
    v_cvt_pk_bf16_f32 v172, v12, v13
    v_cvt_pk_bf16_f32 v173, v14, v15
    v_cvt_pk_bf16_f32 v174, v28, v29
    v_cvt_pk_bf16_f32 v175, v30, v31
    s_nop 0
    v_permlane16_swap_b32 v172, v174
    v_permlane16_swap_b32 v173, v175
    s_add_u32 s38, s37, 0
    buffer_store_dwordx4 v[172:175], v190, s[16:19], s38 offen offset:0 sc1
    v_fmac_f32 v44, v124, v144
    v_fmac_f32 v45, v124, v145
    v_fmac_f32 v46, v124, v146
    v_fmac_f32 v47, v124, v147
    v_fmac_f32 v60, v124, v148
    v_fmac_f32 v61, v124, v149
    v_fmac_f32 v62, v124, v150
    v_fmac_f32 v63, v124, v151
    v_mul_f32 v212, v44, v128
    v_mul_f32 v213, v45, v128
    v_mul_f32 v214, v46, v128
    v_mul_f32 v215, v47, v128
    v_mul_f32 v216, v60, v128
    v_mul_f32 v217, v61, v128
    v_mul_f32 v218, v62, v128
    v_mul_f32 v219, v63, v128
    v_exp_f32 v212, v212
    v_exp_f32 v213, v213
    v_exp_f32 v214, v214
    v_exp_f32 v215, v215
    v_exp_f32 v216, v216
    v_exp_f32 v217, v217
    v_exp_f32 v218, v218
    v_exp_f32 v219, v219
    v_fma_f32 v212, v212, v132, v132
    v_fma_f32 v213, v213, v132, v132
    v_fma_f32 v214, v214, v132, v132
    v_fma_f32 v215, v215, v132, v132
    v_fma_f32 v216, v216, v132, v132
    v_fma_f32 v217, v217, v132, v132
    v_fma_f32 v218, v218, v132, v132
    v_fma_f32 v219, v219, v132, v132
    v_rcp_f32 v212, v212
    v_rcp_f32 v213, v213
    v_rcp_f32 v214, v214
    v_rcp_f32 v215, v215
    v_rcp_f32 v216, v216
    v_rcp_f32 v217, v217
    v_rcp_f32 v218, v218
    v_rcp_f32 v219, v219
    v_mul_f32 v44, v44, v212
    v_mul_f32 v45, v45, v213
    v_mul_f32 v46, v46, v214
    v_mul_f32 v47, v47, v215
    v_mul_f32 v60, v60, v216
    v_mul_f32 v61, v61, v217
    v_mul_f32 v62, v62, v218
    v_mul_f32 v63, v63, v219
    v_cvt_pk_bf16_f32 v176, v44, v45
    v_cvt_pk_bf16_f32 v177, v46, v47
    v_cvt_pk_bf16_f32 v178, v60, v61
    v_cvt_pk_bf16_f32 v179, v62, v63
    s_nop 0
    v_permlane16_swap_b32 v176, v178
    v_permlane16_swap_b32 v177, v179
    buffer_store_dwordx4 v[176:179], v190, s[16:19], s38 offen offset:128 sc1
    v_fmac_f32 v76, v124, v152
    v_fmac_f32 v77, v124, v153
    v_fmac_f32 v78, v124, v154
    v_fmac_f32 v79, v124, v155
    v_fmac_f32 v92, v124, v156
    v_fmac_f32 v93, v124, v157
    v_fmac_f32 v94, v124, v158
    v_fmac_f32 v95, v124, v159
    v_mul_f32 v164, v76, v128
    v_mul_f32 v165, v77, v128
    v_mul_f32 v166, v78, v128
    v_mul_f32 v167, v79, v128
    v_mul_f32 v168, v92, v128
    v_mul_f32 v169, v93, v128
    v_mul_f32 v170, v94, v128
    v_mul_f32 v171, v95, v128
    v_exp_f32 v164, v164
    v_exp_f32 v165, v165
    v_exp_f32 v166, v166
    v_exp_f32 v167, v167
    v_exp_f32 v168, v168
    v_exp_f32 v169, v169
    v_exp_f32 v170, v170
    v_exp_f32 v171, v171
    v_fma_f32 v164, v164, v132, v132
    v_fma_f32 v165, v165, v132, v132
    v_fma_f32 v166, v166, v132, v132
    v_fma_f32 v167, v167, v132, v132
    v_fma_f32 v168, v168, v132, v132
    v_fma_f32 v169, v169, v132, v132
    v_fma_f32 v170, v170, v132, v132
    v_fma_f32 v171, v171, v132, v132
    v_rcp_f32 v164, v164
    v_rcp_f32 v165, v165
    v_rcp_f32 v166, v166
    v_rcp_f32 v167, v167
    v_rcp_f32 v168, v168
    v_rcp_f32 v169, v169
    v_rcp_f32 v170, v170
    v_rcp_f32 v171, v171
    v_mul_f32 v76, v76, v164
    v_mul_f32 v77, v77, v165
    v_mul_f32 v78, v78, v166
    v_mul_f32 v79, v79, v167
    v_mul_f32 v92, v92, v168
    v_mul_f32 v93, v93, v169
    v_mul_f32 v94, v94, v170
    v_mul_f32 v95, v95, v171
    v_cvt_pk_bf16_f32 v180, v76, v77
    v_cvt_pk_bf16_f32 v181, v78, v79
    v_cvt_pk_bf16_f32 v182, v92, v93
    v_cvt_pk_bf16_f32 v183, v94, v95
    s_nop 0
    v_permlane16_swap_b32 v180, v182
    v_permlane16_swap_b32 v181, v183
    buffer_store_dwordx4 v[180:183], v190, s[16:19], s38 offen offset:256 sc1
    v_fmac_f32 v16, v125, v136
    v_fmac_f32 v17, v125, v137
    v_fmac_f32 v18, v125, v138
    v_fmac_f32 v19, v125, v139
    v_fmac_f32 v32, v125, v140
    v_fmac_f32 v33, v125, v141
    v_fmac_f32 v34, v125, v142
    v_fmac_f32 v35, v125, v143
    v_mul_f32 v212, v16, v129
    v_mul_f32 v213, v17, v129
    v_mul_f32 v214, v18, v129
    v_mul_f32 v215, v19, v129
    v_mul_f32 v216, v32, v129
    v_mul_f32 v217, v33, v129
    v_mul_f32 v218, v34, v129
    v_mul_f32 v219, v35, v129
    v_exp_f32 v212, v212
    v_exp_f32 v213, v213
    v_exp_f32 v214, v214
    v_exp_f32 v215, v215
    v_exp_f32 v216, v216
    v_exp_f32 v217, v217
    v_exp_f32 v218, v218
    v_exp_f32 v219, v219
    v_fma_f32 v212, v212, v133, v133
    v_fma_f32 v213, v213, v133, v133
    v_fma_f32 v214, v214, v133, v133
    v_fma_f32 v215, v215, v133, v133
    v_fma_f32 v216, v216, v133, v133
    v_fma_f32 v217, v217, v133, v133
    v_fma_f32 v218, v218, v133, v133
    v_fma_f32 v219, v219, v133, v133
    v_rcp_f32 v212, v212
    v_rcp_f32 v213, v213
    v_rcp_f32 v214, v214
    v_rcp_f32 v215, v215
    v_rcp_f32 v216, v216
    v_rcp_f32 v217, v217
    v_rcp_f32 v218, v218
    v_rcp_f32 v219, v219
    v_mul_f32 v16, v16, v212
    v_mul_f32 v17, v17, v213
    v_mul_f32 v18, v18, v214
    v_mul_f32 v19, v19, v215
    v_mul_f32 v32, v32, v216
    v_mul_f32 v33, v33, v217
    v_mul_f32 v34, v34, v218
    v_mul_f32 v35, v35, v219
    v_cvt_pk_bf16_f32 v184, v16, v17
    v_cvt_pk_bf16_f32 v185, v18, v19
    v_cvt_pk_bf16_f32 v186, v32, v33
    v_cvt_pk_bf16_f32 v187, v34, v35
    s_nop 0
    v_permlane16_swap_b32 v184, v186
    v_permlane16_swap_b32 v185, v187
    s_add_u32 s38, s37, 114688
    buffer_store_dwordx4 v[184:187], v190, s[16:19], s38 offen offset:0 sc1
    v_fmac_f32 v48, v125, v144
    v_fmac_f32 v49, v125, v145
    v_fmac_f32 v50, v125, v146
    v_fmac_f32 v51, v125, v147
    v_fmac_f32 v64, v125, v148
    v_fmac_f32 v65, v125, v149
    v_fmac_f32 v66, v125, v150
    v_fmac_f32 v67, v125, v151
    v_mul_f32 v164, v48, v129
    v_mul_f32 v165, v49, v129
    v_mul_f32 v166, v50, v129
    v_mul_f32 v167, v51, v129
    v_mul_f32 v168, v64, v129
    v_mul_f32 v169, v65, v129
    v_mul_f32 v170, v66, v129
    v_mul_f32 v171, v67, v129
    v_exp_f32 v164, v164
    v_exp_f32 v165, v165
    v_exp_f32 v166, v166
    v_exp_f32 v167, v167
    v_exp_f32 v168, v168
    v_exp_f32 v169, v169
    v_exp_f32 v170, v170
    v_exp_f32 v171, v171
    v_fma_f32 v164, v164, v133, v133
    v_fma_f32 v165, v165, v133, v133
    v_fma_f32 v166, v166, v133, v133
    v_fma_f32 v167, v167, v133, v133
    v_fma_f32 v168, v168, v133, v133
    v_fma_f32 v169, v169, v133, v133
    v_fma_f32 v170, v170, v133, v133
    v_fma_f32 v171, v171, v133, v133
    v_rcp_f32 v164, v164
    v_rcp_f32 v165, v165
    v_rcp_f32 v166, v166
    v_rcp_f32 v167, v167
    v_rcp_f32 v168, v168
    v_rcp_f32 v169, v169
    v_rcp_f32 v170, v170
    v_rcp_f32 v171, v171
    v_mul_f32 v48, v48, v164
    v_mul_f32 v49, v49, v165
    v_mul_f32 v50, v50, v166
    v_mul_f32 v51, v51, v167
    v_mul_f32 v64, v64, v168
    v_mul_f32 v65, v65, v169
    v_mul_f32 v66, v66, v170
    v_mul_f32 v67, v67, v171
    v_cvt_pk_bf16_f32 v172, v48, v49
    v_cvt_pk_bf16_f32 v173, v50, v51
    v_cvt_pk_bf16_f32 v174, v64, v65
    v_cvt_pk_bf16_f32 v175, v66, v67
    s_nop 0
    v_permlane16_swap_b32 v172, v174
    v_permlane16_swap_b32 v173, v175
    buffer_store_dwordx4 v[172:175], v190, s[16:19], s38 offen offset:128 sc1
    v_fmac_f32 v80, v125, v152
    v_fmac_f32 v81, v125, v153
    v_fmac_f32 v82, v125, v154
    v_fmac_f32 v83, v125, v155
    v_fmac_f32 v96, v125, v156
    v_fmac_f32 v97, v125, v157
    v_fmac_f32 v98, v125, v158
    v_fmac_f32 v99, v125, v159
    v_mul_f32 v212, v80, v129
    v_mul_f32 v213, v81, v129
    v_mul_f32 v214, v82, v129
    v_mul_f32 v215, v83, v129
    v_mul_f32 v216, v96, v129
    v_mul_f32 v217, v97, v129
    v_mul_f32 v218, v98, v129
    v_mul_f32 v219, v99, v129
    v_exp_f32 v212, v212
    v_exp_f32 v213, v213
    v_exp_f32 v214, v214
    v_exp_f32 v215, v215
    v_exp_f32 v216, v216
    v_exp_f32 v217, v217
    v_exp_f32 v218, v218
    v_exp_f32 v219, v219
    v_fma_f32 v212, v212, v133, v133
    v_fma_f32 v213, v213, v133, v133
    v_fma_f32 v214, v214, v133, v133
    v_fma_f32 v215, v215, v133, v133
    v_fma_f32 v216, v216, v133, v133
    v_fma_f32 v217, v217, v133, v133
    v_fma_f32 v218, v218, v133, v133
    v_fma_f32 v219, v219, v133, v133
    v_rcp_f32 v212, v212
    v_rcp_f32 v213, v213
    v_rcp_f32 v214, v214
    v_rcp_f32 v215, v215
    v_rcp_f32 v216, v216
    v_rcp_f32 v217, v217
    v_rcp_f32 v218, v218
    v_rcp_f32 v219, v219
    v_mul_f32 v80, v80, v212
    v_mul_f32 v81, v81, v213
    v_mul_f32 v82, v82, v214
    v_mul_f32 v83, v83, v215
    v_mul_f32 v96, v96, v216
    v_mul_f32 v97, v97, v217
    v_mul_f32 v98, v98, v218
    v_mul_f32 v99, v99, v219
    v_cvt_pk_bf16_f32 v176, v80, v81
    v_cvt_pk_bf16_f32 v177, v82, v83
    v_cvt_pk_bf16_f32 v178, v96, v97
    v_cvt_pk_bf16_f32 v179, v98, v99
    s_nop 0
    v_permlane16_swap_b32 v176, v178
    v_permlane16_swap_b32 v177, v179
    buffer_store_dwordx4 v[176:179], v190, s[16:19], s38 offen offset:256 sc1
    v_fmac_f32 v20, v126, v136
    v_fmac_f32 v21, v126, v137
    v_fmac_f32 v22, v126, v138
    v_fmac_f32 v23, v126, v139
    v_fmac_f32 v36, v126, v140
    v_fmac_f32 v37, v126, v141
    v_fmac_f32 v38, v126, v142
    v_fmac_f32 v39, v126, v143
    v_mul_f32 v164, v20, v130
    v_mul_f32 v165, v21, v130
    v_mul_f32 v166, v22, v130
    v_mul_f32 v167, v23, v130
    v_mul_f32 v168, v36, v130
    v_mul_f32 v169, v37, v130
    v_mul_f32 v170, v38, v130
    v_mul_f32 v171, v39, v130
    v_exp_f32 v164, v164
    v_exp_f32 v165, v165
    v_exp_f32 v166, v166
    v_exp_f32 v167, v167
    v_exp_f32 v168, v168
    v_exp_f32 v169, v169
    v_exp_f32 v170, v170
    v_exp_f32 v171, v171
    v_fma_f32 v164, v164, v134, v134
    v_fma_f32 v165, v165, v134, v134
    v_fma_f32 v166, v166, v134, v134
    v_fma_f32 v167, v167, v134, v134
    v_fma_f32 v168, v168, v134, v134
    v_fma_f32 v169, v169, v134, v134
    v_fma_f32 v170, v170, v134, v134
    v_fma_f32 v171, v171, v134, v134
    v_rcp_f32 v164, v164
    v_rcp_f32 v165, v165
    v_rcp_f32 v166, v166
    v_rcp_f32 v167, v167
    v_rcp_f32 v168, v168
    v_rcp_f32 v169, v169
    v_rcp_f32 v170, v170
    v_rcp_f32 v171, v171
    v_mul_f32 v20, v20, v164
    v_mul_f32 v21, v21, v165
    v_mul_f32 v22, v22, v166
    v_mul_f32 v23, v23, v167
    v_mul_f32 v36, v36, v168
    v_mul_f32 v37, v37, v169
    v_mul_f32 v38, v38, v170
    v_mul_f32 v39, v39, v171
    v_cvt_pk_bf16_f32 v180, v20, v21
    v_cvt_pk_bf16_f32 v181, v22, v23
    v_cvt_pk_bf16_f32 v182, v36, v37
    v_cvt_pk_bf16_f32 v183, v38, v39
    s_nop 0
    v_permlane16_swap_b32 v180, v182
    v_permlane16_swap_b32 v181, v183
    s_add_u32 s38, s37, 229376
    buffer_store_dwordx4 v[180:183], v190, s[16:19], s38 offen offset:0 sc1
    v_fmac_f32 v52, v126, v144
    v_fmac_f32 v53, v126, v145
    v_fmac_f32 v54, v126, v146
    v_fmac_f32 v55, v126, v147
    v_fmac_f32 v68, v126, v148
    v_fmac_f32 v69, v126, v149
    v_fmac_f32 v70, v126, v150
    v_fmac_f32 v71, v126, v151
    v_mul_f32 v212, v52, v130
    v_mul_f32 v213, v53, v130
    v_mul_f32 v214, v54, v130
    v_mul_f32 v215, v55, v130
    v_mul_f32 v216, v68, v130
    v_mul_f32 v217, v69, v130
    v_mul_f32 v218, v70, v130
    v_mul_f32 v219, v71, v130
    v_exp_f32 v212, v212
    v_exp_f32 v213, v213
    v_exp_f32 v214, v214
    v_exp_f32 v215, v215
    v_exp_f32 v216, v216
    v_exp_f32 v217, v217
    v_exp_f32 v218, v218
    v_exp_f32 v219, v219
    v_fma_f32 v212, v212, v134, v134
    v_fma_f32 v213, v213, v134, v134
    v_fma_f32 v214, v214, v134, v134
    v_fma_f32 v215, v215, v134, v134
    v_fma_f32 v216, v216, v134, v134
    v_fma_f32 v217, v217, v134, v134
    v_fma_f32 v218, v218, v134, v134
    v_fma_f32 v219, v219, v134, v134
    v_rcp_f32 v212, v212
    v_rcp_f32 v213, v213
    v_rcp_f32 v214, v214
    v_rcp_f32 v215, v215
    v_rcp_f32 v216, v216
    v_rcp_f32 v217, v217
    v_rcp_f32 v218, v218
    v_rcp_f32 v219, v219
    v_mul_f32 v52, v52, v212
    v_mul_f32 v53, v53, v213
    v_mul_f32 v54, v54, v214
    v_mul_f32 v55, v55, v215
    v_mul_f32 v68, v68, v216
    v_mul_f32 v69, v69, v217
    v_mul_f32 v70, v70, v218
    v_mul_f32 v71, v71, v219
    v_cvt_pk_bf16_f32 v184, v52, v53
    v_cvt_pk_bf16_f32 v185, v54, v55
    v_cvt_pk_bf16_f32 v186, v68, v69
    v_cvt_pk_bf16_f32 v187, v70, v71
    s_nop 0
    v_permlane16_swap_b32 v184, v186
    v_permlane16_swap_b32 v185, v187
    buffer_store_dwordx4 v[184:187], v190, s[16:19], s38 offen offset:128 sc1
    v_fmac_f32 v84, v126, v152
    v_fmac_f32 v85, v126, v153
    v_fmac_f32 v86, v126, v154
    v_fmac_f32 v87, v126, v155
    v_fmac_f32 v100, v126, v156
    v_fmac_f32 v101, v126, v157
    v_fmac_f32 v102, v126, v158
    v_fmac_f32 v103, v126, v159
    v_mul_f32 v164, v84, v130
    v_mul_f32 v165, v85, v130
    v_mul_f32 v166, v86, v130
    v_mul_f32 v167, v87, v130
    v_mul_f32 v168, v100, v130
    v_mul_f32 v169, v101, v130
    v_mul_f32 v170, v102, v130
    v_mul_f32 v171, v103, v130
    v_exp_f32 v164, v164
    v_exp_f32 v165, v165
    v_exp_f32 v166, v166
    v_exp_f32 v167, v167
    v_exp_f32 v168, v168
    v_exp_f32 v169, v169
    v_exp_f32 v170, v170
    v_exp_f32 v171, v171
    v_fma_f32 v164, v164, v134, v134
    v_fma_f32 v165, v165, v134, v134
    v_fma_f32 v166, v166, v134, v134
    v_fma_f32 v167, v167, v134, v134
    v_fma_f32 v168, v168, v134, v134
    v_fma_f32 v169, v169, v134, v134
    v_fma_f32 v170, v170, v134, v134
    v_fma_f32 v171, v171, v134, v134
    v_rcp_f32 v164, v164
    v_rcp_f32 v165, v165
    v_rcp_f32 v166, v166
    v_rcp_f32 v167, v167
    v_rcp_f32 v168, v168
    v_rcp_f32 v169, v169
    v_rcp_f32 v170, v170
    v_rcp_f32 v171, v171
    v_mul_f32 v84, v84, v164
    v_mul_f32 v85, v85, v165
    v_mul_f32 v86, v86, v166
    v_mul_f32 v87, v87, v167
    v_mul_f32 v100, v100, v168
    v_mul_f32 v101, v101, v169
    v_mul_f32 v102, v102, v170
    v_mul_f32 v103, v103, v171
    v_cvt_pk_bf16_f32 v172, v84, v85
    v_cvt_pk_bf16_f32 v173, v86, v87
    v_cvt_pk_bf16_f32 v174, v100, v101
    v_cvt_pk_bf16_f32 v175, v102, v103
    s_nop 0
    v_permlane16_swap_b32 v172, v174
    v_permlane16_swap_b32 v173, v175
    buffer_store_dwordx4 v[172:175], v190, s[16:19], s38 offen offset:256 sc1
    v_fmac_f32 v24, v127, v136
    v_fmac_f32 v25, v127, v137
    v_fmac_f32 v26, v127, v138
    v_fmac_f32 v27, v127, v139
    v_fmac_f32 v40, v127, v140
    v_fmac_f32 v41, v127, v141
    v_fmac_f32 v42, v127, v142
    v_fmac_f32 v43, v127, v143
    v_mul_f32 v212, v24, v131
    v_mul_f32 v213, v25, v131
    v_mul_f32 v214, v26, v131
    v_mul_f32 v215, v27, v131
    v_mul_f32 v216, v40, v131
    v_mul_f32 v217, v41, v131
    v_mul_f32 v218, v42, v131
    v_mul_f32 v219, v43, v131
    v_exp_f32 v212, v212
    v_exp_f32 v213, v213
    v_exp_f32 v214, v214
    v_exp_f32 v215, v215
    v_exp_f32 v216, v216
    v_exp_f32 v217, v217
    v_exp_f32 v218, v218
    v_exp_f32 v219, v219
    v_fma_f32 v212, v212, v135, v135
    v_fma_f32 v213, v213, v135, v135
    v_fma_f32 v214, v214, v135, v135
    v_fma_f32 v215, v215, v135, v135
    v_fma_f32 v216, v216, v135, v135
    v_fma_f32 v217, v217, v135, v135
    v_fma_f32 v218, v218, v135, v135
    v_fma_f32 v219, v219, v135, v135
    v_rcp_f32 v212, v212
    v_rcp_f32 v213, v213
    v_rcp_f32 v214, v214
    v_rcp_f32 v215, v215
    v_rcp_f32 v216, v216
    v_rcp_f32 v217, v217
    v_rcp_f32 v218, v218
    v_rcp_f32 v219, v219
    v_mul_f32 v24, v24, v212
    v_mul_f32 v25, v25, v213
    v_mul_f32 v26, v26, v214
    v_mul_f32 v27, v27, v215
    v_mul_f32 v40, v40, v216
    v_mul_f32 v41, v41, v217
    v_mul_f32 v42, v42, v218
    v_mul_f32 v43, v43, v219
    v_cvt_pk_bf16_f32 v176, v24, v25
    v_cvt_pk_bf16_f32 v177, v26, v27
    v_cvt_pk_bf16_f32 v178, v40, v41
    v_cvt_pk_bf16_f32 v179, v42, v43
    s_nop 0
    v_permlane16_swap_b32 v176, v178
    v_permlane16_swap_b32 v177, v179
    s_add_u32 s38, s37, 344064
    buffer_store_dwordx4 v[176:179], v190, s[16:19], s38 offen offset:0 sc1
    v_fmac_f32 v56, v127, v144
    v_fmac_f32 v57, v127, v145
    v_fmac_f32 v58, v127, v146
    v_fmac_f32 v59, v127, v147
    v_fmac_f32 v72, v127, v148
    v_fmac_f32 v73, v127, v149
    v_fmac_f32 v74, v127, v150
    v_fmac_f32 v75, v127, v151
    v_mul_f32 v164, v56, v131
    v_mul_f32 v165, v57, v131
    v_mul_f32 v166, v58, v131
    v_mul_f32 v167, v59, v131
    v_mul_f32 v168, v72, v131
    v_mul_f32 v169, v73, v131
    v_mul_f32 v170, v74, v131
    v_mul_f32 v171, v75, v131
    v_exp_f32 v164, v164
    v_exp_f32 v165, v165
    v_exp_f32 v166, v166
    v_exp_f32 v167, v167
    v_exp_f32 v168, v168
    v_exp_f32 v169, v169
    v_exp_f32 v170, v170
    v_exp_f32 v171, v171
    v_fma_f32 v164, v164, v135, v135
    v_fma_f32 v165, v165, v135, v135
    v_fma_f32 v166, v166, v135, v135
    v_fma_f32 v167, v167, v135, v135
    v_fma_f32 v168, v168, v135, v135
    v_fma_f32 v169, v169, v135, v135
    v_fma_f32 v170, v170, v135, v135
    v_fma_f32 v171, v171, v135, v135
    v_rcp_f32 v164, v164
    v_rcp_f32 v165, v165
    v_rcp_f32 v166, v166
    v_rcp_f32 v167, v167
    v_rcp_f32 v168, v168
    v_rcp_f32 v169, v169
    v_rcp_f32 v170, v170
    v_rcp_f32 v171, v171
    v_mul_f32 v56, v56, v164
    v_mul_f32 v57, v57, v165
    v_mul_f32 v58, v58, v166
    v_mul_f32 v59, v59, v167
    v_mul_f32 v72, v72, v168
    v_mul_f32 v73, v73, v169
    v_mul_f32 v74, v74, v170
    v_mul_f32 v75, v75, v171
    v_cvt_pk_bf16_f32 v180, v56, v57
    v_cvt_pk_bf16_f32 v181, v58, v59
    v_cvt_pk_bf16_f32 v182, v72, v73
    v_cvt_pk_bf16_f32 v183, v74, v75
    s_nop 0
    v_permlane16_swap_b32 v180, v182
    v_permlane16_swap_b32 v181, v183
    buffer_store_dwordx4 v[180:183], v190, s[16:19], s38 offen offset:128 sc1
    v_fmac_f32 v88, v127, v152
    v_fmac_f32 v89, v127, v153
    v_fmac_f32 v90, v127, v154
    v_fmac_f32 v91, v127, v155
    v_fmac_f32 v104, v127, v156
    v_fmac_f32 v105, v127, v157
    v_fmac_f32 v106, v127, v158
    v_fmac_f32 v107, v127, v159
    v_mul_f32 v212, v88, v131
    v_mul_f32 v213, v89, v131
    v_mul_f32 v214, v90, v131
    v_mul_f32 v215, v91, v131
    v_mul_f32 v216, v104, v131
    v_mul_f32 v217, v105, v131
    v_mul_f32 v218, v106, v131
    v_mul_f32 v219, v107, v131
    v_exp_f32 v212, v212
    v_exp_f32 v213, v213
    v_exp_f32 v214, v214
    v_exp_f32 v215, v215
    v_exp_f32 v216, v216
    v_exp_f32 v217, v217
    v_exp_f32 v218, v218
    v_exp_f32 v219, v219
    v_fma_f32 v212, v212, v135, v135
    v_fma_f32 v213, v213, v135, v135
    v_fma_f32 v214, v214, v135, v135
    v_fma_f32 v215, v215, v135, v135
    v_fma_f32 v216, v216, v135, v135
    v_fma_f32 v217, v217, v135, v135
    v_fma_f32 v218, v218, v135, v135
    v_fma_f32 v219, v219, v135, v135
    v_rcp_f32 v212, v212
    v_rcp_f32 v213, v213
    v_rcp_f32 v214, v214
    v_rcp_f32 v215, v215
    v_rcp_f32 v216, v216
    v_rcp_f32 v217, v217
    v_rcp_f32 v218, v218
    v_rcp_f32 v219, v219
    v_mul_f32 v88, v88, v212
    v_mul_f32 v89, v89, v213
    v_mul_f32 v90, v90, v214
    v_mul_f32 v91, v91, v215
    v_mul_f32 v104, v104, v216
    v_mul_f32 v105, v105, v217
    v_mul_f32 v106, v106, v218
    v_mul_f32 v107, v107, v219
    v_cvt_pk_bf16_f32 v184, v88, v89
    v_cvt_pk_bf16_f32 v185, v90, v91
    v_cvt_pk_bf16_f32 v186, v104, v105
    v_cvt_pk_bf16_f32 v187, v106, v107
    s_nop 0
    v_permlane16_swap_b32 v184, v186
    v_permlane16_swap_b32 v185, v187
    buffer_store_dwordx4 v[184:187], v190, s[16:19], s38 offen offset:256 sc1
    s_waitcnt lgkmcnt(0)
    s_barrier
    v_xor_b32 v204, 1024, v204
    ds_read_b128 v[200:203], v204
    v_bfe_u32 v191, v1, 4, 1
    v_lshlrev_b32 v191, 5, v191
    v_bfe_u32 v2, v1, 5, 1
    v_lshl_add_u32 v191, v2, 4, v191
    v_and_b32 v2, 15, v1
    v_mul_u32_u24 v2, 7168, v2
    v_add_u32 v191, v191, v2
    s_add_u32 s38, s66, s39
    v_add_u32 v191, s38, v191
    s_waitcnt lgkmcnt(0)
    s_cmp_eq_u32 s7, 0
    s_cbranch_scc0 L_g7c_19
    v_mov_b32 v172, v192
    v_mov_b32 v174, v200
    v_mov_b32 v173, v193
    v_mov_b32 v175, v201
    v_mov_b32 v176, v194
    v_mov_b32 v178, v202
    v_mov_b32 v177, v195
    v_mov_b32 v179, v203
    s_mov_b32 s68, 0
    s_branch L_g7d_20
L_g7c_19:
    v_mov_b32 v172, v200
    v_mov_b32 v174, v196
    v_mov_b32 v173, v201
    v_mov_b32 v175, v197
    v_mov_b32 v176, v202
    v_mov_b32 v178, v198
    v_mov_b32 v177, v203
    v_mov_b32 v179, v199
    s_mov_b32 s68, 229376
L_g7d_20:
    s_add_u32 s68, s68, s37
    v_permlane16_swap_b32 v172, v174
    v_permlane16_swap_b32 v173, v175
    s_add_u32 s38, s68, 0
    buffer_store_dwordx4 v[172:175], v191, s[16:19], s38 offen sc1
    v_permlane16_swap_b32 v176, v178
    v_permlane16_swap_b32 v177, v179
    s_add_u32 s38, s68, 114688
    buffer_store_dwordx4 v[176:179], v191, s[16:19], s38 offen sc1
    s_waitcnt vmcnt(0)
    v_mov_b32 v2, 1
    v_mov_b32 v3, 155648
    s_mov_b64 exec, 1
    ds_add_rtn_u32 v3, v3, v2
    s_waitcnt lgkmcnt(0)
    v_readfirstlane_b32 s68, v3
    s_nop 0
    s_and_b32 s68, s68, 3
    s_cmp_eq_u32 s68, 3
    s_cbranch_scc0 L_nf_21
    s_lshl_b32 s67, s4, 12
    s_add_u32 s67, s67, 196608
    s_lshl_b32 s68, s5, 7
    s_add_u32 s67, s67, s68
    v_mov_b32 v3, 0
    buffer_store_dword v2, v3, s[88:91], s67 offen sc1
L_nf_21:
    s_mov_b64 exec, -1
    s_and_b32 s86, s2, 1
    s_bfe_u32 s37, s2, 0x10001
    s_lshl_b32 s37, s37, 3
    s_bfe_u32 s38, s2, 0x30003
    s_add_u32 s4, s37, s38
    s_bfe_u32 s37, s2, 0x10002
    s_lshl_b32 s37, s37, 2
    s_lshr_b32 s38, s2, 6
    s_add_u32 s5, s37, s38
    v_and_b32 v1, 63, v0
    s_lshr_b32 s6, s3, 1
    s_and_b32 s7, s3, 1
    s_mul_i32 s39, s6, 8192
    v_and_b32 v2, 15, v1
    v_lshrrev_b32 v3, 1, v2
    v_lshlrev_b32 v2, 7, v2
    v_add_u32 v2, s39, v2
    v_lshrrev_b32 v4, 4, v1
    v_xor_b32 v3, v3, v4
    v_lshl_add_u32 v4, v3, 4, v2
    v_xor_b32 v5, 64, v4
    s_lshl_b32 s37, s86, 12
    s_xor_b32 s38, s37, 4096
    v_add_u32 v6, s38, v4
    v_add_u32 v4, s37, v4
    v_add_u32 v7, s38, v5
    v_add_u32 v5, s37, v5
    v_lshrrev_b32 v2, 4, v1
    v_lshlrev_b32 v2, 3, v2
    v_bfe_u32 v3, v1, 2, 2
    v_add_u32 v76, v2, v3
    v_bfe_u32 v77, v1, 3, 1
    v_lshlrev_b32 v77, 1, v77
    v_bfe_u32 v3, v1, 4, 1
    v_lshl_add_u32 v77, v3, 2, v77
    v_bfe_u32 v3, v1, 1, 1
    s_lshl_b32 s39, s7, 2
    s_add_u32 s39, s39, 0
    v_add_u32 v3, s39, v3
    v_xor_b32 v3, v3, v77
    v_lshlrev_b32 v3, 4, v3
    v_lshl_add_u32 v3, v76, 7, v3
    v_and_b32 v2, 1, v1
    v_lshl_add_u32 v3, v2, 3, v3
    v_add_u32 v8, 16384, v3
    v_bfe_u32 v3, v1, 1, 1
    s_lshl_b32 s39, s7, 2
    s_add_u32 s39, s39, 2
    v_add_u32 v3, s39, v3
    v_xor_b32 v3, v3, v77
    v_lshlrev_b32 v3, 4, v3
    v_lshl_add_u32 v3, v76, 7, v3
    v_and_b32 v2, 1, v1
    v_lshl_add_u32 v3, v2, 3, v3
    v_add_u32 v9, 16384, v3
    v_mov_b32 v12, 0
    v_mov_b32 v13, 0
    v_mov_b32 v14, 0
    v_mov_b32 v15, 0
    v_mov_b32 v16, 0
    v_mov_b32 v17, 0
    v_mov_b32 v18, 0
    v_mov_b32 v19, 0
    v_mov_b32 v20, 0
    v_mov_b32 v21, 0
    v_mov_b32 v22, 0
    v_mov_b32 v23, 0
    v_mov_b32 v24, 0
    v_mov_b32 v25, 0
    v_mov_b32 v26, 0
    v_mov_b32 v27, 0
    v_mov_b32 v28, 0
    v_mov_b32 v29, 0
    v_mov_b32 v30, 0
    v_mov_b32 v31, 0
    v_mov_b32 v32, 0
    v_mov_b32 v33, 0
    v_mov_b32 v34, 0
    v_mov_b32 v35, 0
    v_mov_b32 v36, 0
    v_mov_b32 v37, 0
    v_mov_b32 v38, 0
    v_mov_b32 v39, 0
    v_mov_b32 v40, 0
    v_mov_b32 v41, 0
    v_mov_b32 v42, 0
    v_mov_b32 v43, 0
    v_mov_b32 v44, 0
    v_mov_b32 v45, 0
    v_mov_b32 v46, 0
    v_mov_b32 v47, 0
    v_mov_b32 v48, 0
    v_mov_b32 v49, 0
    v_mov_b32 v50, 0
    v_mov_b32 v51, 0
    v_mov_b32 v52, 0
    v_mov_b32 v53, 0
    v_mov_b32 v54, 0
    v_mov_b32 v55, 0
    v_mov_b32 v56, 0
    v_mov_b32 v57, 0
    v_mov_b32 v58, 0
    v_mov_b32 v59, 0
    v_mov_b32 v60, 0
    v_mov_b32 v61, 0
    v_mov_b32 v62, 0
    v_mov_b32 v63, 0
    v_mov_b32 v64, 0
    v_mov_b32 v65, 0
    v_mov_b32 v66, 0
    v_mov_b32 v67, 0
    v_mov_b32 v68, 0
    v_mov_b32 v69, 0
    v_mov_b32 v70, 0
    v_mov_b32 v71, 0
    v_mov_b32 v72, 0
    v_mov_b32 v73, 0
    v_mov_b32 v74, 0
    v_mov_b32 v75, 0
    s_waitcnt lgkmcnt(0)
    s_barrier
    s_mov_b32 s34, 0
    s_mov_b32 s46, -65536
    s_mov_b32 s47, 32768
    s_setprio 2
    s_barrier
    ds_read_b128 v[76:79], v4 offset:0
    ds_read_b64_tr_b16 v[108:109], v8 offset:0
    ds_read_b64_tr_b16 v[110:111], v8 offset:512
    ds_read_b128 v[80:83], v4 offset:2048
    ds_read_b128 v[84:87], v6 offset:0
    ds_read_b128 v[88:91], v6 offset:2048
    ds_read_b64_tr_b16 v[112:113], v9 offset:0
    ds_read_b64_tr_b16 v[114:115], v9 offset:512
    ds_read_b64_tr_b16 v[116:117], v8 offset:8192
    ds_read_b64_tr_b16 v[118:119], v8 offset:8704
    ds_read_b64_tr_b16 v[120:121], v9 offset:8192
    ds_read_b64_tr_b16 v[122:123], v9 offset:8704
    s_mov_b32 s35, 27
    s_waitcnt lgkmcnt(0)
.p2align 6
L_cl_22:
    v_mfma_f32_16x16x32_bf16 v[12:15], v[108:111], v[76:79], v[12:15]
    ds_read_b128 v[92:95], v5 offset:0
    v_mfma_f32_16x16x32_bf16 v[16:19], v[108:111], v[80:83], v[16:19]
    ds_read_b64_tr_b16 v[124:125], v8 offset:4096
    v_mfma_f32_16x16x32_bf16 v[20:23], v[108:111], v[84:87], v[20:23]
    ds_read_b64_tr_b16 v[126:127], v8 offset:4608
    v_mfma_f32_16x16x32_bf16 v[24:27], v[108:111], v[88:91], v[24:27]
    ds_read_b128 v[96:99], v5 offset:2048
    v_mfma_f32_16x16x32_bf16 v[28:31], v[112:115], v[76:79], v[28:31]
    ds_read_b128 v[100:103], v7 offset:0
    v_mfma_f32_16x16x32_bf16 v[32:35], v[112:115], v[80:83], v[32:35]
    ds_read_b128 v[104:107], v7 offset:2048
    v_mfma_f32_16x16x32_bf16 v[36:39], v[112:115], v[84:87], v[36:39]
    ds_read_b64_tr_b16 v[128:129], v9 offset:4096
    v_mfma_f32_16x16x32_bf16 v[40:43], v[112:115], v[88:91], v[40:43]
    ds_read_b64_tr_b16 v[130:131], v9 offset:4608
    v_mfma_f32_16x16x32_bf16 v[44:47], v[116:119], v[76:79], v[44:47]
    ds_read_b64_tr_b16 v[132:133], v8 offset:12288
    v_mfma_f32_16x16x32_bf16 v[48:51], v[116:119], v[80:83], v[48:51]
    ds_read_b64_tr_b16 v[134:135], v8 offset:12800
    v_mfma_f32_16x16x32_bf16 v[52:55], v[116:119], v[84:87], v[52:55]
    ds_read_b64_tr_b16 v[136:137], v9 offset:12288
    v_mfma_f32_16x16x32_bf16 v[56:59], v[116:119], v[88:91], v[56:59]
    ds_read_b64_tr_b16 v[138:139], v9 offset:12800
    v_mfma_f32_16x16x32_bf16 v[60:63], v[120:123], v[76:79], v[60:63]
    s_add_u32 s34, s34, 32768
    v_mfma_f32_16x16x32_bf16 v[64:67], v[120:123], v[80:83], v[64:67]
    s_cmp_eq_u32 s34, 98304
    v_mfma_f32_16x16x32_bf16 v[68:71], v[120:123], v[84:87], v[68:71]
    s_cselect_b32 s36, s46, s47
    v_mfma_f32_16x16x32_bf16 v[72:75], v[120:123], v[88:91], v[72:75]
    s_cselect_b32 s34, 0, s34
    v_add_u32 v4, s36, v4
    v_add_u32 v5, s36, v5
    v_add_u32 v6, s36, v6
    v_add_u32 v7, s36, v7
    v_add_u32 v8, s36, v8
    v_add_u32 v9, s36, v9
    s_waitcnt lgkmcnt(0)
    s_barrier
    v_mfma_f32_16x16x32_bf16 v[12:15], v[124:127], v[92:95], v[12:15]
    ds_read_b128 v[76:79], v4 offset:0
    v_mfma_f32_16x16x32_bf16 v[16:19], v[124:127], v[96:99], v[16:19]
    ds_read_b64_tr_b16 v[108:109], v8 offset:0
    v_mfma_f32_16x16x32_bf16 v[20:23], v[124:127], v[100:103], v[20:23]
    ds_read_b64_tr_b16 v[110:111], v8 offset:512
    v_mfma_f32_16x16x32_bf16 v[24:27], v[124:127], v[104:107], v[24:27]
    ds_read_b128 v[80:83], v4 offset:2048
    v_mfma_f32_16x16x32_bf16 v[28:31], v[128:131], v[92:95], v[28:31]
    ds_read_b128 v[84:87], v6 offset:0
    v_mfma_f32_16x16x32_bf16 v[32:35], v[128:131], v[96:99], v[32:35]
    ds_read_b128 v[88:91], v6 offset:2048
    v_mfma_f32_16x16x32_bf16 v[36:39], v[128:131], v[100:103], v[36:39]
    ds_read_b64_tr_b16 v[112:113], v9 offset:0
    v_mfma_f32_16x16x32_bf16 v[40:43], v[128:131], v[104:107], v[40:43]
    ds_read_b64_tr_b16 v[114:115], v9 offset:512
    v_mfma_f32_16x16x32_bf16 v[44:47], v[132:135], v[92:95], v[44:47]
    ds_read_b64_tr_b16 v[116:117], v8 offset:8192
    v_mfma_f32_16x16x32_bf16 v[48:51], v[132:135], v[96:99], v[48:51]
    ds_read_b64_tr_b16 v[118:119], v8 offset:8704
    v_mfma_f32_16x16x32_bf16 v[52:55], v[132:135], v[100:103], v[52:55]
    ds_read_b64_tr_b16 v[120:121], v9 offset:8192
    v_mfma_f32_16x16x32_bf16 v[56:59], v[132:135], v[104:107], v[56:59]
    ds_read_b64_tr_b16 v[122:123], v9 offset:8704
    v_mfma_f32_16x16x32_bf16 v[60:63], v[136:139], v[92:95], v[60:63]
    v_mfma_f32_16x16x32_bf16 v[64:67], v[136:139], v[96:99], v[64:67]
    v_mfma_f32_16x16x32_bf16 v[68:71], v[136:139], v[100:103], v[68:71]
    v_mfma_f32_16x16x32_bf16 v[72:75], v[136:139], v[104:107], v[72:75]
    s_sub_u32 s35, s35, 1
    s_cmp_lg_u32 s35, 0
    s_waitcnt lgkmcnt(0)
    s_cbranch_scc1 L_cl_22
    v_mfma_f32_16x16x32_bf16 v[12:15], v[108:111], v[76:79], v[12:15]
    ds_read_b128 v[92:95], v5 offset:0
    v_mfma_f32_16x16x32_bf16 v[16:19], v[108:111], v[80:83], v[16:19]
    ds_read_b64_tr_b16 v[124:125], v8 offset:4096
    v_mfma_f32_16x16x32_bf16 v[20:23], v[108:111], v[84:87], v[20:23]
    ds_read_b64_tr_b16 v[126:127], v8 offset:4608
    v_mfma_f32_16x16x32_bf16 v[24:27], v[108:111], v[88:91], v[24:27]
    ds_read_b128 v[96:99], v5 offset:2048
    v_mfma_f32_16x16x32_bf16 v[28:31], v[112:115], v[76:79], v[28:31]
    ds_read_b128 v[100:103], v7 offset:0
    v_mfma_f32_16x16x32_bf16 v[32:35], v[112:115], v[80:83], v[32:35]
    ds_read_b128 v[104:107], v7 offset:2048
    v_mfma_f32_16x16x32_bf16 v[36:39], v[112:115], v[84:87], v[36:39]
    ds_read_b64_tr_b16 v[128:129], v9 offset:4096
    v_mfma_f32_16x16x32_bf16 v[40:43], v[112:115], v[88:91], v[40:43]
    ds_read_b64_tr_b16 v[130:131], v9 offset:4608
    v_mfma_f32_16x16x32_bf16 v[44:47], v[116:119], v[76:79], v[44:47]
    ds_read_b64_tr_b16 v[132:133], v8 offset:12288
    v_mfma_f32_16x16x32_bf16 v[48:51], v[116:119], v[80:83], v[48:51]
    ds_read_b64_tr_b16 v[134:135], v8 offset:12800
    v_mfma_f32_16x16x32_bf16 v[52:55], v[116:119], v[84:87], v[52:55]
    ds_read_b64_tr_b16 v[136:137], v9 offset:12288
    v_mfma_f32_16x16x32_bf16 v[56:59], v[116:119], v[88:91], v[56:59]
    ds_read_b64_tr_b16 v[138:139], v9 offset:12800
    v_mfma_f32_16x16x32_bf16 v[60:63], v[120:123], v[76:79], v[60:63]
    v_mfma_f32_16x16x32_bf16 v[64:67], v[120:123], v[80:83], v[64:67]
    v_mfma_f32_16x16x32_bf16 v[68:71], v[120:123], v[84:87], v[68:71]
    v_mfma_f32_16x16x32_bf16 v[72:75], v[120:123], v[88:91], v[72:75]
    s_waitcnt lgkmcnt(0)
    s_barrier
    v_mfma_f32_16x16x32_bf16 v[12:15], v[124:127], v[92:95], v[12:15]
    v_mfma_f32_16x16x32_bf16 v[16:19], v[124:127], v[96:99], v[16:19]
    v_mfma_f32_16x16x32_bf16 v[20:23], v[124:127], v[100:103], v[20:23]
    v_mfma_f32_16x16x32_bf16 v[24:27], v[124:127], v[104:107], v[24:27]
    v_mfma_f32_16x16x32_bf16 v[28:31], v[128:131], v[92:95], v[28:31]
    v_mfma_f32_16x16x32_bf16 v[32:35], v[128:131], v[96:99], v[32:35]
    v_mfma_f32_16x16x32_bf16 v[36:39], v[128:131], v[100:103], v[36:39]
    v_mfma_f32_16x16x32_bf16 v[40:43], v[128:131], v[104:107], v[40:43]
    v_mfma_f32_16x16x32_bf16 v[44:47], v[132:135], v[92:95], v[44:47]
    v_mfma_f32_16x16x32_bf16 v[48:51], v[132:135], v[96:99], v[48:51]
    v_mfma_f32_16x16x32_bf16 v[52:55], v[132:135], v[100:103], v[52:55]
    v_mfma_f32_16x16x32_bf16 v[56:59], v[132:135], v[104:107], v[56:59]
    v_mfma_f32_16x16x32_bf16 v[60:63], v[136:139], v[92:95], v[60:63]
    v_mfma_f32_16x16x32_bf16 v[64:67], v[136:139], v[96:99], v[64:67]
    v_mfma_f32_16x16x32_bf16 v[68:71], v[136:139], v[100:103], v[68:71]
    v_mfma_f32_16x16x32_bf16 v[72:75], v[136:139], v[104:107], v[72:75]
    s_setprio 0
    s_add_u32 s24, s64, 0x6400000
    s_addc_u32 s25, s65, 0
    s_mov_b32 s26, 0x800000
    s_mov_b32 s27, 0x20000
    v_lshlrev_b32 v76, 4, v1
    s_lshl_b32 s37, s2, 2
    s_add_u32 s37, s37, s3
    s_lshl_b32 s37, s37, 13
    s_add_u32 s38, s37, 0
    buffer_store_dwordx4 v[20:23], v76, s[24:27], s38 offen offset:0 sc1
    buffer_store_dwordx4 v[24:27], v76, s[24:27], s38 offen offset:1024 sc1
    buffer_store_dwordx4 v[36:39], v76, s[24:27], s38 offen offset:2048 sc1
    buffer_store_dwordx4 v[40:43], v76, s[24:27], s38 offen offset:3072 sc1
    s_add_u32 s38, s37, 4096
    buffer_store_dwordx4 v[52:55], v76, s[24:27], s38 offen offset:0 sc1
    buffer_store_dwordx4 v[56:59], v76, s[24:27], s38 offen offset:1024 sc1
    buffer_store_dwordx4 v[68:71], v76, s[24:27], s38 offen offset:2048 sc1
    buffer_store_dwordx4 v[72:75], v76, s[24:27], s38 offen offset:3072 sc1
    s_barrier
    v_and_b32 v2, 15, v1
    v_lshrrev_b32 v3, 1, v2
    v_lshlrev_b32 v2, 7, v2
    s_lshl_b32 s38, s6, 12
    s_add_u32 s38, s38, 135168
    v_add_u32 v2, s38, v2
    v_bfe_u32 v100, v1, 4, 1
    v_lshl_add_u32 v2, v100, 3, v2
    v_bfe_u32 v100, v1, 5, 1
    s_lshl_b32 s38, s7, 2
    v_add_u32 v100, s38, v100
    v_add_u32 v101, 0, v100
    v_xor_b32 v101, v101, v3
    v_lshl_add_u32 v96, v101, 4, v2
    v_add_u32 v101, 2, v100
    v_xor_b32 v101, v101, v3
    v_lshl_add_u32 v97, v101, 4, v2
    ds_read_b64 v[80:81], v96 offset:0
    ds_read_b64 v[82:83], v97 offset:0
    ds_read_b64 v[84:85], v96 offset:8192
    ds_read_b64 v[86:87], v97 offset:8192
    ds_read_b64 v[88:89], v96 offset:2048
    ds_read_b64 v[90:91], v97 offset:2048
    ds_read_b64 v[92:93], v96 offset:10240
    ds_read_b64 v[94:95], v97 offset:10240
    s_lshl_b32 s67, s2, 2
    s_add_u32 s67, s67, s3
    s_lshl_b32 s67, s67, 7
    s_add_u32 s67, s67, 720896
    s_waitcnt vmcnt(0)
    v_mov_b32 v2, 1
    v_mov_b32 v3, 0
    s_mov_b64 exec, 1
    buffer_store_dword v2, v3, s[88:91], s67 offen sc1
    s_mov_b64 exec, -1
    s_xor_b32 s67, s2, 1
    s_lshl_b32 s67, s67, 2
    s_add_u32 s67, s67, s3
    s_lshl_b32 s67, s67, 7
    s_add_u32 s67, s67, 720896
    v_and_b32 v112, 0, v1
    v_lshlrev_b32 v112, 7, v112
    s_mov_b32 s68, 400000
L_poll_23:
    buffer_load_dword v113, v112, s[88:91], s67 offen sc1
    s_waitcnt vmcnt(0)
    v_cmp_ne_u32 vcc, 0, v113
    s_nop 0
    s_cmp_eq_u64 vcc, -1
    s_cbranch_scc1 L_polld_24
    s_sleep 1
    s_sub_u32 s68, s68, 1
    s_cmp_lg_u32 s68, 0
    s_cbranch_scc1 L_poll_23
    s_mov_b32 s92, s62
    s_mov_b32 s93, s63
    s_mov_b32 s94, 256
    s_mov_b32 s95, 0x20000
    v_mov_b32 v113, 1024
    v_mov_b32 v112, 0
    buffer_store_dword v113, v112, s[92:95], 0 offen
L_polld_24:
    s_xor_b32 s37, s2, 1
    s_lshl_b32 s37, s37, 2
    s_add_u32 s37, s37, s3
    s_lshl_b32 s37, s37, 13
    s_add_u32 s38, s37, 0
    buffer_load_dwordx4 v[136:139], v76, s[24:27], s38 offen offset:0 sc1
    buffer_load_dwordx4 v[140:143], v76, s[24:27], s38 offen offset:1024 sc1
    buffer_load_dwordx4 v[144:147], v76, s[24:27], s38 offen offset:2048 sc1
    buffer_load_dwordx4 v[148:151], v76, s[24:27], s38 offen offset:3072 sc1
    s_add_u32 s38, s37, 4096
    buffer_load_dwordx4 v[152:155], v76, s[24:27], s38 offen offset:0 sc1
    buffer_load_dwordx4 v[156:159], v76, s[24:27], s38 offen offset:1024 sc1
    buffer_load_dwordx4 v[160:163], v76, s[24:27], s38 offen offset:2048 sc1
    buffer_load_dwordx4 v[164:167], v76, s[24:27], s38 offen offset:3072 sc1
    s_add_u32 s16, s64, 0x500000
    s_addc_u32 s17, s65, 0
    s_mov_b32 s18, 0x400000
    s_mov_b32 s19, 0x20000
    v_bfe_u32 v100, v1, 4, 1
    v_lshlrev_b32 v100, 5, v100
    v_bfe_u32 v2, v1, 5, 1
    v_lshl_add_u32 v100, v2, 4, v100
    v_and_b32 v2, 15, v1
    s_mov_b32 s68, 2048
    v_mad_u32_u24 v100, v2, s68, v100
    s_lshl_b32 s37, s4, 7
    s_lshl_b32 s38, s6, 6
    s_add_u32 s37, s37, s38
    s_lshl_b32 s38, s86, 5
    s_add_u32 s69, s37, s38
    s_mul_i32 s37, s69, 2048
    s_lshl_b32 s38, s5, 8
    s_add_u32 s37, s37, s38
    s_lshl_b32 s38, s7, 6
    s_add_u32 s37, s37, s38
    v_mov_b32 v132, 0xffff0000
    s_waitcnt lgkmcnt(0)
    v_lshlrev_b32 v112, 16, v80
    v_and_b32 v113, v132, v80
    v_lshlrev_b32 v114, 16, v81
    v_and_b32 v115, v132, v81
    v_add_f32 v12, v12, v112
    v_add_f32 v13, v13, v113
    v_add_f32 v14, v14, v114
    v_add_f32 v15, v15, v115
    v_lshlrev_b32 v112, 16, v82
    v_and_b32 v113, v132, v82
    v_lshlrev_b32 v114, 16, v83
    v_and_b32 v115, v132, v83
    v_add_f32 v28, v28, v112
    v_add_f32 v29, v29, v113
    v_add_f32 v30, v30, v114
    v_add_f32 v31, v31, v115
    v_lshlrev_b32 v112, 16, v84
    v_and_b32 v113, v132, v84
    v_lshlrev_b32 v114, 16, v85
    v_and_b32 v115, v132, v85
    v_add_f32 v44, v44, v112
    v_add_f32 v45, v45, v113
    v_add_f32 v46, v46, v114
    v_add_f32 v47, v47, v115
    v_lshlrev_b32 v112, 16, v86
    v_and_b32 v113, v132, v86
    v_lshlrev_b32 v114, 16, v87
    v_and_b32 v115, v132, v87
    v_add_f32 v60, v60, v112
    v_add_f32 v61, v61, v113
    v_add_f32 v62, v62, v114
    v_add_f32 v63, v63, v115
    v_lshlrev_b32 v112, 16, v88
    v_and_b32 v113, v132, v88
    v_lshlrev_b32 v114, 16, v89
    v_and_b32 v115, v132, v89
    v_add_f32 v16, v16, v112
    v_add_f32 v17, v17, v113
    v_add_f32 v18, v18, v114
    v_add_f32 v19, v19, v115
    v_lshlrev_b32 v112, 16, v90
    v_and_b32 v113, v132, v90
    v_lshlrev_b32 v114, 16, v91
    v_and_b32 v115, v132, v91
    v_add_f32 v32, v32, v112
    v_add_f32 v33, v33, v113
    v_add_f32 v34, v34, v114
    v_add_f32 v35, v35, v115
    v_lshlrev_b32 v112, 16, v92
    v_and_b32 v113, v132, v92
    v_lshlrev_b32 v114, 16, v93
    v_and_b32 v115, v132, v93
    v_add_f32 v48, v48, v112
    v_add_f32 v49, v49, v113
    v_add_f32 v50, v50, v114
    v_add_f32 v51, v51, v115
    v_lshlrev_b32 v112, 16, v94
    v_and_b32 v113, v132, v94
    v_lshlrev_b32 v114, 16, v95
    v_and_b32 v115, v132, v95
    v_add_f32 v64, v64, v112
    v_add_f32 v65, v65, v113
    v_add_f32 v66, v66, v114
    v_add_f32 v67, v67, v115
    s_waitcnt vmcnt(0)
    v_add_f32 v12, v12, v136
    v_add_f32 v13, v13, v137
    v_add_f32 v14, v14, v138
    v_add_f32 v15, v15, v139
    v_cvt_pk_bf16_f32 v116, v12, v13
    v_cvt_pk_bf16_f32 v117, v14, v15
    v_mov_b32 v106, v12
    v_mul_f32 v108, v12, v12
    v_mov_b32 v107, v13
    v_mul_f32 v109, v13, v13
    v_add_f32 v106, v106, v14
    v_fmac_f32 v108, v14, v14
    v_add_f32 v107, v107, v15
    v_fmac_f32 v109, v15, v15
    v_add_f32 v28, v28, v144
    v_add_f32 v29, v29, v145
    v_add_f32 v30, v30, v146
    v_add_f32 v31, v31, v147
    v_cvt_pk_bf16_f32 v118, v28, v29
    v_cvt_pk_bf16_f32 v119, v30, v31
    v_add_f32 v106, v106, v28
    v_fmac_f32 v108, v28, v28
    v_add_f32 v107, v107, v29
    v_fmac_f32 v109, v29, v29
    v_add_f32 v106, v106, v30
    v_fmac_f32 v108, v30, v30
    v_add_f32 v107, v107, v31
    v_fmac_f32 v109, v31, v31
    v_add_f32 v44, v44, v152
    v_add_f32 v45, v45, v153
    v_add_f32 v46, v46, v154
    v_add_f32 v47, v47, v155
    v_cvt_pk_bf16_f32 v120, v44, v45
    v_cvt_pk_bf16_f32 v121, v46, v47
    v_add_f32 v106, v106, v44
    v_fmac_f32 v108, v44, v44
    v_add_f32 v107, v107, v45
    v_fmac_f32 v109, v45, v45
    v_add_f32 v106, v106, v46
    v_fmac_f32 v108, v46, v46
    v_add_f32 v107, v107, v47
    v_fmac_f32 v109, v47, v47
    v_add_f32 v60, v60, v160
    v_add_f32 v61, v61, v161
    v_add_f32 v62, v62, v162
    v_add_f32 v63, v63, v163
    v_cvt_pk_bf16_f32 v122, v60, v61
    v_cvt_pk_bf16_f32 v123, v62, v63
    v_add_f32 v106, v106, v60
    v_fmac_f32 v108, v60, v60
    v_add_f32 v107, v107, v61
    v_fmac_f32 v109, v61, v61
    v_add_f32 v106, v106, v62
    v_fmac_f32 v108, v62, v62
    v_add_f32 v107, v107, v63
    v_fmac_f32 v109, v63, v63
    v_add_f32 v102, v106, v107
    v_add_f32 v103, v108, v109
    v_permlane16_swap_b32 v116, v118
    v_permlane16_swap_b32 v117, v119
    s_add_u32 s38, s37, 0
    buffer_store_dwordx4 v[116:119], v100, s[16:19], s38 offen offset:0 sc1
    v_permlane16_swap_b32 v120, v122
    v_permlane16_swap_b32 v121, v123
    s_add_u32 s38, s37, 0
    buffer_store_dwordx4 v[120:123], v100, s[16:19], s38 offen offset:128 sc1
    v_add_f32 v16, v16, v140
    v_add_f32 v17, v17, v141
    v_add_f32 v18, v18, v142
    v_add_f32 v19, v19, v143
    v_cvt_pk_bf16_f32 v124, v16, v17
    v_cvt_pk_bf16_f32 v125, v18, v19
    v_mov_b32 v106, v16
    v_mul_f32 v108, v16, v16
    v_mov_b32 v107, v17
    v_mul_f32 v109, v17, v17
    v_add_f32 v106, v106, v18
    v_fmac_f32 v108, v18, v18
    v_add_f32 v107, v107, v19
    v_fmac_f32 v109, v19, v19
    v_add_f32 v32, v32, v148
    v_add_f32 v33, v33, v149
    v_add_f32 v34, v34, v150
    v_add_f32 v35, v35, v151
    v_cvt_pk_bf16_f32 v126, v32, v33
    v_cvt_pk_bf16_f32 v127, v34, v35
    v_add_f32 v106, v106, v32
    v_fmac_f32 v108, v32, v32
    v_add_f32 v107, v107, v33
    v_fmac_f32 v109, v33, v33
    v_add_f32 v106, v106, v34
    v_fmac_f32 v108, v34, v34
    v_add_f32 v107, v107, v35
    v_fmac_f32 v109, v35, v35
    v_add_f32 v48, v48, v156
    v_add_f32 v49, v49, v157
    v_add_f32 v50, v50, v158
    v_add_f32 v51, v51, v159
    v_cvt_pk_bf16_f32 v128, v48, v49
    v_cvt_pk_bf16_f32 v129, v50, v51
    v_add_f32 v106, v106, v48
    v_fmac_f32 v108, v48, v48
    v_add_f32 v107, v107, v49
    v_fmac_f32 v109, v49, v49
    v_add_f32 v106, v106, v50
    v_fmac_f32 v108, v50, v50
    v_add_f32 v107, v107, v51
    v_fmac_f32 v109, v51, v51
    v_add_f32 v64, v64, v164
    v_add_f32 v65, v65, v165
    v_add_f32 v66, v66, v166
    v_add_f32 v67, v67, v167
    v_cvt_pk_bf16_f32 v130, v64, v65
    v_cvt_pk_bf16_f32 v131, v66, v67
    v_add_f32 v106, v106, v64
    v_fmac_f32 v108, v64, v64
    v_add_f32 v107, v107, v65
    v_fmac_f32 v109, v65, v65
    v_add_f32 v106, v106, v66
    v_fmac_f32 v108, v66, v66
    v_add_f32 v107, v107, v67
    v_fmac_f32 v109, v67, v67
    v_add_f32 v104, v106, v107
    v_add_f32 v105, v108, v109
    v_permlane16_swap_b32 v124, v126
    v_permlane16_swap_b32 v125, v127
    s_add_u32 s38, s37, 32768
    buffer_store_dwordx4 v[124:127], v100, s[16:19], s38 offen offset:0 sc1
    v_permlane16_swap_b32 v128, v130
    v_permlane16_swap_b32 v129, v131
    s_add_u32 s38, s37, 32768
    buffer_store_dwordx4 v[128:131], v100, s[16:19], s38 offen offset:128 sc1
    s_add_u32 s24, s64, 0x3c80000
    s_addc_u32 s25, s65, 0
    s_mov_b32 s26, 0x40000
    s_mov_b32 s27, 0x20000
    v_mov_b32 v112, v102
    v_mov_b32 v113, v103
    v_mov_b32 v114, v104
    v_mov_b32 v115, v105
    v_permlane16_swap_b32 v112, v102
    v_permlane16_swap_b32 v113, v103
    v_permlane16_swap_b32 v114, v104
    v_permlane16_swap_b32 v115, v105
    v_add_f32 v102, v102, v112
    v_add_f32 v103, v103, v113
    v_add_f32 v104, v104, v114
    v_add_f32 v105, v105, v115
    v_mov_b32 v112, v102
    v_mov_b32 v113, v103
    v_mov_b32 v114, v104
    v_mov_b32 v115, v105
    v_permlane32_swap_b32 v112, v102
    v_permlane32_swap_b32 v113, v103
    v_permlane32_swap_b32 v114, v104
    v_permlane32_swap_b32 v115, v105
    v_add_f32 v102, v102, v112
    v_add_f32 v103, v103, v113
    v_add_f32 v104, v104, v114
    v_add_f32 v105, v105, v115
    v_cmp_le_u32 vcc, 16, v1
    s_nop 1
    v_cndmask_b32 v102, v102, v104, vcc
    v_cndmask_b32 v103, v103, v105, vcc
    v_lshlrev_b32 v2, 3, v1
    s_lshl_b32 s37, s69, 3
    s_lshl_b32 s38, s5, 1
    s_add_u32 s38, s38, s7
    s_lshl_b32 s38, s38, 14
    s_add_u32 s37, s37, s38
    s_mov_b32 exec_hi, 0
    buffer_store_dwordx2 v[102:103], v2, s[24:27], s37 offen sc1
    s_mov_b64 exec, -1
    s_waitcnt vmcnt(0)
    v_mov_b32 v2, 1
    v_mov_b32 v3, 155648
    s_mov_b64 exec, 1
    ds_add_rtn_u32 v3, v3, v2
    s_waitcnt lgkmcnt(0)
    v_readfirstlane_b32 s68, v3
    s_nop 0
    s_and_b32 s68, s68, 3
    s_cmp_eq_u32 s68, 3
    s_cbranch_scc0 L_nf_25
    s_lshl_b32 s67, s4, 12
    s_add_u32 s67, s67, 589824
    s_lshl_b32 s68, s5, 1
    s_add_u32 s68, s68, s86
    s_lshl_b32 s68, s68, 7
    s_add_u32 s67, s67, s68
    v_mov_b32 v3, 0
    buffer_store_dword v2, v3, s[88:91], s67 offen sc1
L_nf_25:
    s_mov_b64 exec, -1
    s_and_b32 s37, s2, 1
    s_lshl_b32 s37, s37, 3
    s_bfe_u32 s38, s2, 0x30003
    s_add_u32 s4, s37, s38
    s_bfe_u32 s37, s2, 0x20001
    s_lshl_b32 s37, s37, 2
    s_lshr_b32 s38, s2, 6
    s_add_u32 s5, s37, s38
    v_and_b32 v1, 63, v0
    s_lshr_b32 s6, s3, 1
    s_and_b32 s7, s3, 1
    s_mul_i32 s39, s6, 8192
    v_and_b32 v2, 15, v1
    v_lshrrev_b32 v3, 1, v2
    v_lshlrev_b32 v2, 7, v2
    v_add_u32 v2, s39, v2
    v_lshrrev_b32 v4, 4, v1
    v_xor_b32 v3, v3, v4
    v_lshl_add_u32 v4, v3, 4, v2
    v_xor_b32 v5, 64, v4
    v_lshrrev_b32 v2, 4, v1
    v_lshlrev_b32 v2, 3, v2
    v_bfe_u32 v3, v1, 2, 2
    v_add_u32 v104, v2, v3
    v_bfe_u32 v105, v1, 3, 1
    v_lshlrev_b32 v105, 1, v105
    v_bfe_u32 v3, v1, 4, 1
    v_lshl_add_u32 v105, v3, 2, v105
    v_bfe_u32 v3, v1, 1, 1
    s_lshl_b32 s39, s7, 2
    s_add_u32 s39, s39, 0
    v_add_u32 v3, s39, v3
    v_xor_b32 v3, v3, v105
    v_lshlrev_b32 v3, 4, v3
    v_lshl_add_u32 v3, v104, 7, v3
    v_and_b32 v2, 1, v1
    v_lshl_add_u32 v3, v2, 3, v3
    v_add_u32 v6, 16384, v3
    v_bfe_u32 v3, v1, 1, 1
    s_lshl_b32 s39, s7, 2
    s_add_u32 s39, s39, 2
    v_add_u32 v3, s39, v3
    v_xor_b32 v3, v3, v105
    v_lshlrev_b32 v3, 4, v3
    v_lshl_add_u32 v3, v104, 7, v3
    v_and_b32 v2, 1, v1
    v_lshl_add_u32 v3, v2, 3, v3
    v_add_u32 v7, 16384, v3
    v_mov_b32 v8, 0
    v_mov_b32 v9, 0
    v_mov_b32 v10, 0
    v_mov_b32 v11, 0
    v_mov_b32 v12, 0
    v_mov_b32 v13, 0
    v_mov_b32 v14, 0
    v_mov_b32 v15, 0
    v_mov_b32 v16, 0
    v_mov_b32 v17, 0
    v_mov_b32 v18, 0
    v_mov_b32 v19, 0
    v_mov_b32 v20, 0
    v_mov_b32 v21, 0
    v_mov_b32 v22, 0
    v_mov_b32 v23, 0
    v_mov_b32 v24, 0
    v_mov_b32 v25, 0
    v_mov_b32 v26, 0
    v_mov_b32 v27, 0
    v_mov_b32 v28, 0
    v_mov_b32 v29, 0
    v_mov_b32 v30, 0
    v_mov_b32 v31, 0
    v_mov_b32 v32, 0
    v_mov_b32 v33, 0
    v_mov_b32 v34, 0
    v_mov_b32 v35, 0
    v_mov_b32 v36, 0
    v_mov_b32 v37, 0
    v_mov_b32 v38, 0
    v_mov_b32 v39, 0
    v_mov_b32 v40, 0
    v_mov_b32 v41, 0
    v_mov_b32 v42, 0
    v_mov_b32 v43, 0
    v_mov_b32 v44, 0
    v_mov_b32 v45, 0
    v_mov_b32 v46, 0
    v_mov_b32 v47, 0
    v_mov_b32 v48, 0
    v_mov_b32 v49, 0
    v_mov_b32 v50, 0
    v_mov_b32 v51, 0
    v_mov_b32 v52, 0
    v_mov_b32 v53, 0
    v_mov_b32 v54, 0
    v_mov_b32 v55, 0
    v_mov_b32 v56, 0
    v_mov_b32 v57, 0
    v_mov_b32 v58, 0
    v_mov_b32 v59, 0
    v_mov_b32 v60, 0
    v_mov_b32 v61, 0
    v_mov_b32 v62, 0
    v_mov_b32 v63, 0
    v_mov_b32 v64, 0
    v_mov_b32 v65, 0
    v_mov_b32 v66, 0
    v_mov_b32 v67, 0
    v_mov_b32 v68, 0
    v_mov_b32 v69, 0
    v_mov_b32 v70, 0
    v_mov_b32 v71, 0
    v_mov_b32 v72, 0
    v_mov_b32 v73, 0
    v_mov_b32 v74, 0
    v_mov_b32 v75, 0
    v_mov_b32 v76, 0
    v_mov_b32 v77, 0
    v_mov_b32 v78, 0
    v_mov_b32 v79, 0
    v_mov_b32 v80, 0
    v_mov_b32 v81, 0
    v_mov_b32 v82, 0
    v_mov_b32 v83, 0
    v_mov_b32 v84, 0
    v_mov_b32 v85, 0
    v_mov_b32 v86, 0
    v_mov_b32 v87, 0
    v_mov_b32 v88, 0
    v_mov_b32 v89, 0
    v_mov_b32 v90, 0
    v_mov_b32 v91, 0
    v_mov_b32 v92, 0
    v_mov_b32 v93, 0
    v_mov_b32 v94, 0
    v_mov_b32 v95, 0
    v_mov_b32 v96, 0
    v_mov_b32 v97, 0
    v_mov_b32 v98, 0
    v_mov_b32 v99, 0
    v_mov_b32 v100, 0
    v_mov_b32 v101, 0
    v_mov_b32 v102, 0
    v_mov_b32 v103, 0
    s_waitcnt lgkmcnt(0)
    s_barrier
    s_mov_b32 s34, 0
    s_mov_b32 s46, -81920
    s_mov_b32 s47, 40960
    s_setprio 2
    s_barrier
    ds_read_b128 v[104:107], v4 offset:0
    ds_read_b64_tr_b16 v[136:137], v6 offset:0
    ds_read_b64_tr_b16 v[138:139], v6 offset:512
    ds_read_b128 v[108:111], v4 offset:2048
    ds_read_b128 v[112:115], v4 offset:4096
    ds_read_b128 v[116:119], v4 offset:6144
    ds_read_b64_tr_b16 v[140:141], v7 offset:0
    ds_read_b64_tr_b16 v[142:143], v7 offset:512
    ds_read_b64_tr_b16 v[144:145], v6 offset:8192
    ds_read_b64_tr_b16 v[146:147], v6 offset:8704
    ds_read_b64_tr_b16 v[148:149], v7 offset:8192
    ds_read_b64_tr_b16 v[150:151], v7 offset:8704
    ds_read_b64_tr_b16 v[152:153], v6 offset:16384
    ds_read_b64_tr_b16 v[154:155], v6 offset:16896
    ds_read_b64_tr_b16 v[156:157], v7 offset:16384
    ds_read_b64_tr_b16 v[158:159], v7 offset:16896
    s_mov_b32 s35, 15
    s_waitcnt lgkmcnt(0)
.p2align 6
L_cl_26:
    v_mfma_f32_16x16x32_bf16 v[8:11], v[136:139], v[104:107], v[8:11]
    ds_read_b128 v[120:123], v5 offset:0
    v_mfma_f32_16x16x32_bf16 v[12:15], v[136:139], v[108:111], v[12:15]
    ds_read_b64_tr_b16 v[160:161], v6 offset:4096
    v_mfma_f32_16x16x32_bf16 v[16:19], v[136:139], v[112:115], v[16:19]
    ds_read_b64_tr_b16 v[162:163], v6 offset:4608
    v_mfma_f32_16x16x32_bf16 v[20:23], v[136:139], v[116:119], v[20:23]
    ds_read_b128 v[124:127], v5 offset:2048
    v_mfma_f32_16x16x32_bf16 v[24:27], v[140:143], v[104:107], v[24:27]
    ds_read_b128 v[128:131], v5 offset:4096
    v_mfma_f32_16x16x32_bf16 v[28:31], v[140:143], v[108:111], v[28:31]
    ds_read_b128 v[132:135], v5 offset:6144
    v_mfma_f32_16x16x32_bf16 v[32:35], v[140:143], v[112:115], v[32:35]
    ds_read_b64_tr_b16 v[164:165], v7 offset:4096
    v_mfma_f32_16x16x32_bf16 v[36:39], v[140:143], v[116:119], v[36:39]
    ds_read_b64_tr_b16 v[166:167], v7 offset:4608
    v_mfma_f32_16x16x32_bf16 v[40:43], v[104:107], v[144:147], v[40:43]
    ds_read_b64_tr_b16 v[168:169], v6 offset:12288
    v_mfma_f32_16x16x32_bf16 v[44:47], v[108:111], v[144:147], v[44:47]
    ds_read_b64_tr_b16 v[170:171], v6 offset:12800
    v_mfma_f32_16x16x32_bf16 v[48:51], v[112:115], v[144:147], v[48:51]
    ds_read_b64_tr_b16 v[172:173], v7 offset:12288
    v_mfma_f32_16x16x32_bf16 v[52:55], v[116:119], v[144:147], v[52:55]
    ds_read_b64_tr_b16 v[174:175], v7 offset:12800
    v_mfma_f32_16x16x32_bf16 v[56:59], v[104:107], v[148:151], v[56:59]
    ds_read_b64_tr_b16 v[176:177], v6 offset:20480
    v_mfma_f32_16x16x32_bf16 v[60:63], v[108:111], v[148:151], v[60:63]
    ds_read_b64_tr_b16 v[178:179], v6 offset:20992
    v_mfma_f32_16x16x32_bf16 v[64:67], v[112:115], v[148:151], v[64:67]
    ds_read_b64_tr_b16 v[180:181], v7 offset:20480
    v_mfma_f32_16x16x32_bf16 v[68:71], v[116:119], v[148:151], v[68:71]
    ds_read_b64_tr_b16 v[182:183], v7 offset:20992
    v_mfma_f32_16x16x32_bf16 v[72:75], v[104:107], v[152:155], v[72:75]
    s_add_u32 s34, s34, 40960
    v_mfma_f32_16x16x32_bf16 v[76:79], v[108:111], v[152:155], v[76:79]
    s_cmp_eq_u32 s34, 122880
    v_mfma_f32_16x16x32_bf16 v[80:83], v[112:115], v[152:155], v[80:83]
    s_cselect_b32 s36, s46, s47
    v_mfma_f32_16x16x32_bf16 v[84:87], v[116:119], v[152:155], v[84:87]
    s_cselect_b32 s34, 0, s34
    v_mfma_f32_16x16x32_bf16 v[88:91], v[104:107], v[156:159], v[88:91]
    v_add_u32 v4, s36, v4
    v_mfma_f32_16x16x32_bf16 v[92:95], v[108:111], v[156:159], v[92:95]
    v_add_u32 v5, s36, v5
    v_mfma_f32_16x16x32_bf16 v[96:99], v[112:115], v[156:159], v[96:99]
    v_add_u32 v6, s36, v6
    v_mfma_f32_16x16x32_bf16 v[100:103], v[116:119], v[156:159], v[100:103]
    v_add_u32 v7, s36, v7
    s_waitcnt lgkmcnt(0)
    s_barrier
    v_mfma_f32_16x16x32_bf16 v[8:11], v[160:163], v[120:123], v[8:11]
    ds_read_b128 v[104:107], v4 offset:0
    v_mfma_f32_16x16x32_bf16 v[12:15], v[160:163], v[124:127], v[12:15]
    ds_read_b64_tr_b16 v[136:137], v6 offset:0
    v_mfma_f32_16x16x32_bf16 v[16:19], v[160:163], v[128:131], v[16:19]
    ds_read_b64_tr_b16 v[138:139], v6 offset:512
    v_mfma_f32_16x16x32_bf16 v[20:23], v[160:163], v[132:135], v[20:23]
    ds_read_b128 v[108:111], v4 offset:2048
    v_mfma_f32_16x16x32_bf16 v[24:27], v[164:167], v[120:123], v[24:27]
    ds_read_b128 v[112:115], v4 offset:4096
    v_mfma_f32_16x16x32_bf16 v[28:31], v[164:167], v[124:127], v[28:31]
    ds_read_b128 v[116:119], v4 offset:6144
    v_mfma_f32_16x16x32_bf16 v[32:35], v[164:167], v[128:131], v[32:35]
    ds_read_b64_tr_b16 v[140:141], v7 offset:0
    v_mfma_f32_16x16x32_bf16 v[36:39], v[164:167], v[132:135], v[36:39]
    ds_read_b64_tr_b16 v[142:143], v7 offset:512
    v_mfma_f32_16x16x32_bf16 v[40:43], v[120:123], v[168:171], v[40:43]
    ds_read_b64_tr_b16 v[144:145], v6 offset:8192
    v_mfma_f32_16x16x32_bf16 v[44:47], v[124:127], v[168:171], v[44:47]
    ds_read_b64_tr_b16 v[146:147], v6 offset:8704
    v_mfma_f32_16x16x32_bf16 v[48:51], v[128:131], v[168:171], v[48:51]
    ds_read_b64_tr_b16 v[148:149], v7 offset:8192
    v_mfma_f32_16x16x32_bf16 v[52:55], v[132:135], v[168:171], v[52:55]
    ds_read_b64_tr_b16 v[150:151], v7 offset:8704
    v_mfma_f32_16x16x32_bf16 v[56:59], v[120:123], v[172:175], v[56:59]
    ds_read_b64_tr_b16 v[152:153], v6 offset:16384
    v_mfma_f32_16x16x32_bf16 v[60:63], v[124:127], v[172:175], v[60:63]
    ds_read_b64_tr_b16 v[154:155], v6 offset:16896
    v_mfma_f32_16x16x32_bf16 v[64:67], v[128:131], v[172:175], v[64:67]
    ds_read_b64_tr_b16 v[156:157], v7 offset:16384
    v_mfma_f32_16x16x32_bf16 v[68:71], v[132:135], v[172:175], v[68:71]
    ds_read_b64_tr_b16 v[158:159], v7 offset:16896
    v_mfma_f32_16x16x32_bf16 v[72:75], v[120:123], v[176:179], v[72:75]
    v_mfma_f32_16x16x32_bf16 v[76:79], v[124:127], v[176:179], v[76:79]
    v_mfma_f32_16x16x32_bf16 v[80:83], v[128:131], v[176:179], v[80:83]
    v_mfma_f32_16x16x32_bf16 v[84:87], v[132:135], v[176:179], v[84:87]
    v_mfma_f32_16x16x32_bf16 v[88:91], v[120:123], v[180:183], v[88:91]
    v_mfma_f32_16x16x32_bf16 v[92:95], v[124:127], v[180:183], v[92:95]
    v_mfma_f32_16x16x32_bf16 v[96:99], v[128:131], v[180:183], v[96:99]
    v_mfma_f32_16x16x32_bf16 v[100:103], v[132:135], v[180:183], v[100:103]
    s_sub_u32 s35, s35, 1
    s_cmp_lg_u32 s35, 0
    s_waitcnt lgkmcnt(0)
    s_cbranch_scc1 L_cl_26
    v_mfma_f32_16x16x32_bf16 v[8:11], v[136:139], v[104:107], v[8:11]
    ds_read_b128 v[120:123], v5 offset:0
    v_mfma_f32_16x16x32_bf16 v[12:15], v[136:139], v[108:111], v[12:15]
    ds_read_b64_tr_b16 v[160:161], v6 offset:4096
    v_mfma_f32_16x16x32_bf16 v[16:19], v[136:139], v[112:115], v[16:19]
    ds_read_b64_tr_b16 v[162:163], v6 offset:4608
    v_mfma_f32_16x16x32_bf16 v[20:23], v[136:139], v[116:119], v[20:23]
    ds_read_b128 v[124:127], v5 offset:2048
    v_mfma_f32_16x16x32_bf16 v[24:27], v[140:143], v[104:107], v[24:27]
    ds_read_b128 v[128:131], v5 offset:4096
    v_mfma_f32_16x16x32_bf16 v[28:31], v[140:143], v[108:111], v[28:31]
    ds_read_b128 v[132:135], v5 offset:6144
    v_mfma_f32_16x16x32_bf16 v[32:35], v[140:143], v[112:115], v[32:35]
    ds_read_b64_tr_b16 v[164:165], v7 offset:4096
    v_mfma_f32_16x16x32_bf16 v[36:39], v[140:143], v[116:119], v[36:39]
    ds_read_b64_tr_b16 v[166:167], v7 offset:4608
    v_mfma_f32_16x16x32_bf16 v[40:43], v[104:107], v[144:147], v[40:43]
    ds_read_b64_tr_b16 v[168:169], v6 offset:12288
    v_mfma_f32_16x16x32_bf16 v[44:47], v[108:111], v[144:147], v[44:47]
    ds_read_b64_tr_b16 v[170:171], v6 offset:12800
    v_mfma_f32_16x16x32_bf16 v[48:51], v[112:115], v[144:147], v[48:51]
    ds_read_b64_tr_b16 v[172:173], v7 offset:12288
    v_mfma_f32_16x16x32_bf16 v[52:55], v[116:119], v[144:147], v[52:55]
    ds_read_b64_tr_b16 v[174:175], v7 offset:12800
    v_mfma_f32_16x16x32_bf16 v[56:59], v[104:107], v[148:151], v[56:59]
    ds_read_b64_tr_b16 v[176:177], v6 offset:20480
    v_mfma_f32_16x16x32_bf16 v[60:63], v[108:111], v[148:151], v[60:63]
    ds_read_b64_tr_b16 v[178:179], v6 offset:20992
    v_mfma_f32_16x16x32_bf16 v[64:67], v[112:115], v[148:151], v[64:67]
    ds_read_b64_tr_b16 v[180:181], v7 offset:20480
    v_mfma_f32_16x16x32_bf16 v[68:71], v[116:119], v[148:151], v[68:71]
    ds_read_b64_tr_b16 v[182:183], v7 offset:20992
    v_mfma_f32_16x16x32_bf16 v[72:75], v[104:107], v[152:155], v[72:75]
    v_mfma_f32_16x16x32_bf16 v[76:79], v[108:111], v[152:155], v[76:79]
    v_mfma_f32_16x16x32_bf16 v[80:83], v[112:115], v[152:155], v[80:83]
    v_mfma_f32_16x16x32_bf16 v[84:87], v[116:119], v[152:155], v[84:87]
    v_mfma_f32_16x16x32_bf16 v[88:91], v[104:107], v[156:159], v[88:91]
    v_mfma_f32_16x16x32_bf16 v[92:95], v[108:111], v[156:159], v[92:95]
    v_mfma_f32_16x16x32_bf16 v[96:99], v[112:115], v[156:159], v[96:99]
    v_mfma_f32_16x16x32_bf16 v[100:103], v[116:119], v[156:159], v[100:103]
    s_waitcnt lgkmcnt(0)
    s_barrier
    v_mfma_f32_16x16x32_bf16 v[8:11], v[160:163], v[120:123], v[8:11]
    v_mfma_f32_16x16x32_bf16 v[12:15], v[160:163], v[124:127], v[12:15]
    v_mfma_f32_16x16x32_bf16 v[16:19], v[160:163], v[128:131], v[16:19]
    v_mfma_f32_16x16x32_bf16 v[20:23], v[160:163], v[132:135], v[20:23]
    v_mfma_f32_16x16x32_bf16 v[24:27], v[164:167], v[120:123], v[24:27]
    v_mfma_f32_16x16x32_bf16 v[28:31], v[164:167], v[124:127], v[28:31]
    v_mfma_f32_16x16x32_bf16 v[32:35], v[164:167], v[128:131], v[32:35]
    v_mfma_f32_16x16x32_bf16 v[36:39], v[164:167], v[132:135], v[36:39]
    v_mfma_f32_16x16x32_bf16 v[40:43], v[120:123], v[168:171], v[40:43]
    v_mfma_f32_16x16x32_bf16 v[44:47], v[124:127], v[168:171], v[44:47]
    v_mfma_f32_16x16x32_bf16 v[48:51], v[128:131], v[168:171], v[48:51]
    v_mfma_f32_16x16x32_bf16 v[52:55], v[132:135], v[168:171], v[52:55]
    v_mfma_f32_16x16x32_bf16 v[56:59], v[120:123], v[172:175], v[56:59]
    v_mfma_f32_16x16x32_bf16 v[60:63], v[124:127], v[172:175], v[60:63]
    v_mfma_f32_16x16x32_bf16 v[64:67], v[128:131], v[172:175], v[64:67]
    v_mfma_f32_16x16x32_bf16 v[68:71], v[132:135], v[172:175], v[68:71]
    v_mfma_f32_16x16x32_bf16 v[72:75], v[120:123], v[176:179], v[72:75]
    v_mfma_f32_16x16x32_bf16 v[76:79], v[124:127], v[176:179], v[76:79]
    v_mfma_f32_16x16x32_bf16 v[80:83], v[128:131], v[176:179], v[80:83]
    v_mfma_f32_16x16x32_bf16 v[84:87], v[132:135], v[176:179], v[84:87]
    v_mfma_f32_16x16x32_bf16 v[88:91], v[120:123], v[180:183], v[88:91]
    v_mfma_f32_16x16x32_bf16 v[92:95], v[124:127], v[180:183], v[92:95]
    v_mfma_f32_16x16x32_bf16 v[96:99], v[128:131], v[180:183], v[96:99]
    v_mfma_f32_16x16x32_bf16 v[100:103], v[132:135], v[180:183], v[100:103]
    s_setprio 0
    s_mov_b32 s82, 0x3fb8aa3b
    s_mov_b32 s84, 0x358637bd
    s_lshl_b32 s69, s6, 8
    s_add_u32 s69, s69, 151552
    v_lshrrev_b32 v140, 4, v1
    v_lshlrev_b32 v140, 4, v140
    v_add_u32 v140, s69, v140
    ds_read_b128 v[104:107], v140 offset:0
    ds_read_b128 v[120:123], v140 offset:512
    ds_read_b128 v[108:111], v140 offset:64
    ds_read_b128 v[124:127], v140 offset:576
    ds_read_b128 v[112:115], v140 offset:128
    ds_read_b128 v[128:131], v140 offset:640
    ds_read_b128 v[116:119], v140 offset:192
    ds_read_b128 v[132:135], v140 offset:704
    v_and_b32 v141, 15, v1
    v_lshlrev_b32 v141, 2, v141
    s_lshl_b32 s37, s7, 7
    s_add_u32 s37, s37, 154624
    v_add_u32 v141, s37, v141
    ds_read_b32 v136, v141 offset:256
    ds_read_b32 v137, v141 offset:320
    ds_read_b32 v138, v141 offset:512
    ds_read_b32 v139, v141 offset:576
    s_waitcnt lgkmcnt(0)
    v_fmac_f32 v40, v104, v136
    v_fmac_f32 v41, v105, v136
    v_fmac_f32 v42, v106, v136
    v_fmac_f32 v43, v107, v136
    v_fmaak_f32 v40, v40, v120, 0x358637bd
    v_fmaak_f32 v41, v41, v121, 0x358637bd
    v_fmaak_f32 v42, v42, v122, 0x358637bd
    v_fmaak_f32 v43, v43, v123, 0x358637bd
    v_mul_f32 v180, s82, v40
    v_mul_f32 v181, s82, v41
    v_mul_f32 v182, s82, v42
    v_mul_f32 v183, s82, v43
    v_exp_f32 v180, v180 clamp
    v_exp_f32 v181, v181 clamp
    v_exp_f32 v182, v182 clamp
    v_exp_f32 v183, v183 clamp
    v_max_f32 v40, s84, v40
    v_max_f32 v41, s84, v41
    v_max_f32 v42, s84, v42
    v_max_f32 v43, s84, v43
    v_add_f32 v40, v40, v180
    v_add_f32 v41, v41, v181
    v_add_f32 v42, v42, v182
    v_add_f32 v43, v43, v183
    v_cvt_pk_bf16_f32 v148, v40, v41
    v_cvt_pk_bf16_f32 v149, v42, v43
    v_fmac_f32 v72, v104, v138
    v_fmac_f32 v73, v105, v138
    v_fmac_f32 v74, v106, v138
    v_fmac_f32 v75, v107, v138
    v_mul_f32 v72, v72, v120
    v_mul_f32 v73, v73, v121
    v_mul_f32 v74, v74, v122
    v_mul_f32 v75, v75, v123
    v_cvt_pk_bf16_f32 v164, v72, v73
    v_cvt_pk_bf16_f32 v165, v74, v75
    v_fmac_f32 v56, v104, v137
    v_fmac_f32 v57, v105, v137
    v_fmac_f32 v58, v106, v137
    v_fmac_f32 v59, v107, v137
    v_fmaak_f32 v56, v56, v120, 0x358637bd
    v_fmaak_f32 v57, v57, v121, 0x358637bd
    v_fmaak_f32 v58, v58, v122, 0x358637bd
    v_fmaak_f32 v59, v59, v123, 0x358637bd
    v_mul_f32 v144, s82, v56
    v_mul_f32 v145, s82, v57
    v_mul_f32 v146, s82, v58
    v_mul_f32 v147, s82, v59
    v_exp_f32 v144, v144 clamp
    v_exp_f32 v145, v145 clamp
    v_exp_f32 v146, v146 clamp
    v_exp_f32 v147, v147 clamp
    v_max_f32 v56, s84, v56
    v_max_f32 v57, s84, v57
    v_max_f32 v58, s84, v58
    v_max_f32 v59, s84, v59
    v_add_f32 v56, v56, v144
    v_add_f32 v57, v57, v145
    v_add_f32 v58, v58, v146
    v_add_f32 v59, v59, v147
    v_cvt_pk_bf16_f32 v156, v56, v57
    v_cvt_pk_bf16_f32 v157, v58, v59
    v_fmac_f32 v88, v104, v139
    v_fmac_f32 v89, v105, v139
    v_fmac_f32 v90, v106, v139
    v_fmac_f32 v91, v107, v139
    v_mul_f32 v88, v88, v120
    v_mul_f32 v89, v89, v121
    v_mul_f32 v90, v90, v122
    v_mul_f32 v91, v91, v123
    v_cvt_pk_bf16_f32 v172, v88, v89
    v_cvt_pk_bf16_f32 v173, v90, v91
    v_fmac_f32 v44, v108, v136
    v_fmac_f32 v45, v109, v136
    v_fmac_f32 v46, v110, v136
    v_fmac_f32 v47, v111, v136
    v_fmaak_f32 v44, v44, v124, 0x358637bd
    v_fmaak_f32 v45, v45, v125, 0x358637bd
    v_fmaak_f32 v46, v46, v126, 0x358637bd
    v_fmaak_f32 v47, v47, v127, 0x358637bd
    v_mul_f32 v180, s82, v44
    v_mul_f32 v181, s82, v45
    v_mul_f32 v182, s82, v46
    v_mul_f32 v183, s82, v47
    v_exp_f32 v180, v180 clamp
    v_exp_f32 v181, v181 clamp
    v_exp_f32 v182, v182 clamp
    v_exp_f32 v183, v183 clamp
    v_max_f32 v44, s84, v44
    v_max_f32 v45, s84, v45
    v_max_f32 v46, s84, v46
    v_max_f32 v47, s84, v47
    v_add_f32 v44, v44, v180
    v_add_f32 v45, v45, v181
    v_add_f32 v46, v46, v182
    v_add_f32 v47, v47, v183
    v_cvt_pk_bf16_f32 v150, v44, v45
    v_cvt_pk_bf16_f32 v151, v46, v47
    v_fmac_f32 v76, v108, v138
    v_fmac_f32 v77, v109, v138
    v_fmac_f32 v78, v110, v138
    v_fmac_f32 v79, v111, v138
    v_mul_f32 v76, v76, v124
    v_mul_f32 v77, v77, v125
    v_mul_f32 v78, v78, v126
    v_mul_f32 v79, v79, v127
    v_cvt_pk_bf16_f32 v166, v76, v77
    v_cvt_pk_bf16_f32 v167, v78, v79
    v_fmac_f32 v60, v108, v137
    v_fmac_f32 v61, v109, v137
    v_fmac_f32 v62, v110, v137
    v_fmac_f32 v63, v111, v137
    v_fmaak_f32 v60, v60, v124, 0x358637bd
    v_fmaak_f32 v61, v61, v125, 0x358637bd
    v_fmaak_f32 v62, v62, v126, 0x358637bd
    v_fmaak_f32 v63, v63, v127, 0x358637bd
    v_mul_f32 v144, s82, v60
    v_mul_f32 v145, s82, v61
    v_mul_f32 v146, s82, v62
    v_mul_f32 v147, s82, v63
    v_exp_f32 v144, v144 clamp
    v_exp_f32 v145, v145 clamp
    v_exp_f32 v146, v146 clamp
    v_exp_f32 v147, v147 clamp
    v_max_f32 v60, s84, v60
    v_max_f32 v61, s84, v61
    v_max_f32 v62, s84, v62
    v_max_f32 v63, s84, v63
    v_add_f32 v60, v60, v144
    v_add_f32 v61, v61, v145
    v_add_f32 v62, v62, v146
    v_add_f32 v63, v63, v147
    v_cvt_pk_bf16_f32 v158, v60, v61
    v_cvt_pk_bf16_f32 v159, v62, v63
    v_fmac_f32 v92, v108, v139
    v_fmac_f32 v93, v109, v139
    v_fmac_f32 v94, v110, v139
    v_fmac_f32 v95, v111, v139
    v_mul_f32 v92, v92, v124
    v_mul_f32 v93, v93, v125
    v_mul_f32 v94, v94, v126
    v_mul_f32 v95, v95, v127
    v_cvt_pk_bf16_f32 v174, v92, v93
    v_cvt_pk_bf16_f32 v175, v94, v95
    v_fmac_f32 v48, v112, v136
    v_fmac_f32 v49, v113, v136
    v_fmac_f32 v50, v114, v136
    v_fmac_f32 v51, v115, v136
    v_fmaak_f32 v48, v48, v128, 0x358637bd
    v_fmaak_f32 v49, v49, v129, 0x358637bd
    v_fmaak_f32 v50, v50, v130, 0x358637bd
    v_fmaak_f32 v51, v51, v131, 0x358637bd
    v_mul_f32 v180, s82, v48
    v_mul_f32 v181, s82, v49
    v_mul_f32 v182, s82, v50
    v_mul_f32 v183, s82, v51
    v_exp_f32 v180, v180 clamp
    v_exp_f32 v181, v181 clamp
    v_exp_f32 v182, v182 clamp
    v_exp_f32 v183, v183 clamp
    v_max_f32 v48, s84, v48
    v_max_f32 v49, s84, v49
    v_max_f32 v50, s84, v50
    v_max_f32 v51, s84, v51
    v_add_f32 v48, v48, v180
    v_add_f32 v49, v49, v181
    v_add_f32 v50, v50, v182
    v_add_f32 v51, v51, v183
    v_cvt_pk_bf16_f32 v152, v48, v49
    v_cvt_pk_bf16_f32 v153, v50, v51
    v_fmac_f32 v80, v112, v138
    v_fmac_f32 v81, v113, v138
    v_fmac_f32 v82, v114, v138
    v_fmac_f32 v83, v115, v138
    v_mul_f32 v80, v80, v128
    v_mul_f32 v81, v81, v129
    v_mul_f32 v82, v82, v130
    v_mul_f32 v83, v83, v131
    v_cvt_pk_bf16_f32 v168, v80, v81
    v_cvt_pk_bf16_f32 v169, v82, v83
    v_fmac_f32 v64, v112, v137
    v_fmac_f32 v65, v113, v137
    v_fmac_f32 v66, v114, v137
    v_fmac_f32 v67, v115, v137
    v_fmaak_f32 v64, v64, v128, 0x358637bd
    v_fmaak_f32 v65, v65, v129, 0x358637bd
    v_fmaak_f32 v66, v66, v130, 0x358637bd
    v_fmaak_f32 v67, v67, v131, 0x358637bd
    v_mul_f32 v144, s82, v64
    v_mul_f32 v145, s82, v65
    v_mul_f32 v146, s82, v66
    v_mul_f32 v147, s82, v67
    v_exp_f32 v144, v144 clamp
    v_exp_f32 v145, v145 clamp
    v_exp_f32 v146, v146 clamp
    v_exp_f32 v147, v147 clamp
    v_max_f32 v64, s84, v64
    v_max_f32 v65, s84, v65
    v_max_f32 v66, s84, v66
    v_max_f32 v67, s84, v67
    v_add_f32 v64, v64, v144
    v_add_f32 v65, v65, v145
    v_add_f32 v66, v66, v146
    v_add_f32 v67, v67, v147
    v_cvt_pk_bf16_f32 v160, v64, v65
    v_cvt_pk_bf16_f32 v161, v66, v67
    v_fmac_f32 v96, v112, v139
    v_fmac_f32 v97, v113, v139
    v_fmac_f32 v98, v114, v139
    v_fmac_f32 v99, v115, v139
    v_mul_f32 v96, v96, v128
    v_mul_f32 v97, v97, v129
    v_mul_f32 v98, v98, v130
    v_mul_f32 v99, v99, v131
    v_cvt_pk_bf16_f32 v176, v96, v97
    v_cvt_pk_bf16_f32 v177, v98, v99
    v_fmac_f32 v52, v116, v136
    v_fmac_f32 v53, v117, v136
    v_fmac_f32 v54, v118, v136
    v_fmac_f32 v55, v119, v136
    v_fmaak_f32 v52, v52, v132, 0x358637bd
    v_fmaak_f32 v53, v53, v133, 0x358637bd
    v_fmaak_f32 v54, v54, v134, 0x358637bd
    v_fmaak_f32 v55, v55, v135, 0x358637bd
    v_mul_f32 v180, s82, v52
    v_mul_f32 v181, s82, v53
    v_mul_f32 v182, s82, v54
    v_mul_f32 v183, s82, v55
    v_exp_f32 v180, v180 clamp
    v_exp_f32 v181, v181 clamp
    v_exp_f32 v182, v182 clamp
    v_exp_f32 v183, v183 clamp
    v_max_f32 v52, s84, v52
    v_max_f32 v53, s84, v53
    v_max_f32 v54, s84, v54
    v_max_f32 v55, s84, v55
    v_add_f32 v52, v52, v180
    v_add_f32 v53, v53, v181
    v_add_f32 v54, v54, v182
    v_add_f32 v55, v55, v183
    v_cvt_pk_bf16_f32 v154, v52, v53
    v_cvt_pk_bf16_f32 v155, v54, v55
    v_fmac_f32 v84, v116, v138
    v_fmac_f32 v85, v117, v138
    v_fmac_f32 v86, v118, v138
    v_fmac_f32 v87, v119, v138
    v_mul_f32 v84, v84, v132
    v_mul_f32 v85, v85, v133
    v_mul_f32 v86, v86, v134
    v_mul_f32 v87, v87, v135
    v_cvt_pk_bf16_f32 v170, v84, v85
    v_cvt_pk_bf16_f32 v171, v86, v87
    v_fmac_f32 v68, v116, v137
    v_fmac_f32 v69, v117, v137
    v_fmac_f32 v70, v118, v137
    v_fmac_f32 v71, v119, v137
    v_fmaak_f32 v68, v68, v132, 0x358637bd
    v_fmaak_f32 v69, v69, v133, 0x358637bd
    v_fmaak_f32 v70, v70, v134, 0x358637bd
    v_fmaak_f32 v71, v71, v135, 0x358637bd
    v_mul_f32 v144, s82, v68
    v_mul_f32 v145, s82, v69
    v_mul_f32 v146, s82, v70
    v_mul_f32 v147, s82, v71
    v_exp_f32 v144, v144 clamp
    v_exp_f32 v145, v145 clamp
    v_exp_f32 v146, v146 clamp
    v_exp_f32 v147, v147 clamp
    v_max_f32 v68, s84, v68
    v_max_f32 v69, s84, v69
    v_max_f32 v70, s84, v70
    v_max_f32 v71, s84, v71
    v_add_f32 v68, v68, v144
    v_add_f32 v69, v69, v145
    v_add_f32 v70, v70, v146
    v_add_f32 v71, v71, v147
    v_cvt_pk_bf16_f32 v162, v68, v69
    v_cvt_pk_bf16_f32 v163, v70, v71
    v_fmac_f32 v100, v116, v139
    v_fmac_f32 v101, v117, v139
    v_fmac_f32 v102, v118, v139
    v_fmac_f32 v103, v119, v139
    v_mul_f32 v100, v100, v132
    v_mul_f32 v101, v101, v133
    v_mul_f32 v102, v102, v134
    v_mul_f32 v103, v103, v135
    v_cvt_pk_bf16_f32 v178, v100, v101
    v_cvt_pk_bf16_f32 v179, v102, v103
    v_mov_b32 v184, 0x3f803f80
    v_mov_b32 v185, 0x3f803f80
    v_mov_b32 v186, 0x3f803f80
    v_mov_b32 v187, 0x3f803f80
    v_mfma_f32_16x16x32_bf16 v[40:43], v[148:151], v[164:167], 0
    v_mfma_f32_16x16x32_bf16 v[44:47], v[148:151], v[172:175], 0
    v_mfma_f32_16x16x32_bf16 v[48:51], v[148:151], v[184:187], 0
    v_mfma_f32_16x16x32_bf16 v[52:55], v[156:159], v[164:167], 0
    v_mfma_f32_16x16x32_bf16 v[56:59], v[156:159], v[172:175], 0
    v_mfma_f32_16x16x32_bf16 v[60:63], v[156:159], v[184:187], 0
    v_mfma_f32_16x16x32_bf16 v[40:43], v[152:155], v[168:171], v[40:43]
    v_mfma_f32_16x16x32_bf16 v[44:47], v[152:155], v[176:179], v[44:47]
    v_mfma_f32_16x16x32_bf16 v[48:51], v[152:155], v[184:187], v[48:51]
    v_mfma_f32_16x16x32_bf16 v[52:55], v[160:163], v[168:171], v[52:55]
    v_mfma_f32_16x16x32_bf16 v[56:59], v[160:163], v[176:179], v[56:59]
    v_mfma_f32_16x16x32_bf16 v[60:63], v[160:163], v[184:187], v[60:63]
    v_lshlrev_b32 v188, 4, v1
    s_mul_i32 s37, s7, 6144
    s_add_u32 s37, s37, 122880
    v_add_u32 v188, s37, v188
    s_cmp_eq_u32 s6, 0
    s_cbranch_scc1 L_wm1_27
    ds_write_b128 v188, v[40:43] offset:0
    ds_write_b128 v188, v[44:47] offset:1024
    ds_write_b128 v188, v[48:51] offset:2048
    ds_write_b128 v188, v[52:55] offset:3072
    ds_write_b128 v188, v[56:59] offset:4096
    ds_write_b128 v188, v[60:63] offset:5120
    s_waitcnt lgkmcnt(0)
L_wm1_27:
    s_barrier
    s_cmp_eq_u32 s6, 0
    s_cbranch_scc0 L_q_28
    ds_read_b128 v[192:195], v188 offset:0
    ds_read_b128 v[196:199], v188 offset:1024
    ds_read_b128 v[200:203], v188 offset:2048
    ds_read_b128 v[204:207], v188 offset:3072
    ds_read_b128 v[208:211], v188 offset:4096
    ds_read_b128 v[212:215], v188 offset:5120
    s_add_u32 s16, s64, 0x3800000
    s_addc_u32 s17, s65, 0
    s_mov_b32 s18, 0x400000
    s_mov_b32 s19, 0x20000
    s_lshl_b32 s37, s4, 5
    s_lshl_b32 s38, s5, 1
    s_add_u32 s38, s38, s7
    s_add_u32 s37, s37, s38
    s_lshl_b32 s37, s37, 11
    s_lshl_b32 s38, s38, 4
    s_add_u32 s38, s38, s4
    s_lshl_b32 s38, s38, 7
    s_add_u32 s39, s38, 2097152
    v_bfe_u32 v216, v1, 4, 1
    v_lshlrev_b32 v216, 5, v216
    v_bfe_u32 v2, v1, 5, 1
    v_lshl_add_u32 v216, v2, 4, v216
    v_and_b32 v2, 15, v1
    v_lshl_add_u32 v2, v2, 6, v216
    v_lshrrev_b32 v3, 4, v1
    v_lshlrev_b32 v3, 4, v3
    s_waitcnt lgkmcnt(0)
    v_add_f32 v40, v40, v192
    v_add_f32 v41, v41, v193
    v_add_f32 v42, v42, v194
    v_add_f32 v43, v43, v195
    v_add_f32 v44, v44, v196
    v_add_f32 v45, v45, v197
    v_add_f32 v46, v46, v198
    v_add_f32 v47, v47, v199
    v_add_f32 v48, v48, v200
    v_add_f32 v49, v49, v201
    v_add_f32 v50, v50, v202
    v_add_f32 v51, v51, v203
    v_add_f32 v52, v52, v204
    v_add_f32 v53, v53, v205
    v_add_f32 v54, v54, v206
    v_add_f32 v55, v55, v207
    v_add_f32 v56, v56, v208
    v_add_f32 v57, v57, v209
    v_add_f32 v58, v58, v210
    v_add_f32 v59, v59, v211
    v_add_f32 v60, v60, v212
    v_add_f32 v61, v61, v213
    v_add_f32 v62, v62, v214
    v_add_f32 v63, v63, v215
    v_cvt_pk_bf16_f32 v220, v40, v41
    v_cvt_pk_bf16_f32 v221, v42, v43
    v_cvt_pk_bf16_f32 v222, v52, v53
    v_cvt_pk_bf16_f32 v223, v54, v55
    s_nop 0
    v_permlane16_swap_b32 v220, v222
    v_permlane16_swap_b32 v221, v223
    buffer_store_dwordx4 v[220:223], v2, s[16:19], s37 offen offset:0 sc1
    v_cvt_pk_bf16_f32 v224, v44, v45
    v_cvt_pk_bf16_f32 v225, v46, v47
    v_cvt_pk_bf16_f32 v226, v56, v57
    v_cvt_pk_bf16_f32 v227, v58, v59
    s_nop 0
    v_permlane16_swap_b32 v224, v226
    v_permlane16_swap_b32 v225, v227
    buffer_store_dwordx4 v[224:227], v2, s[16:19], s37 offen offset:1024 sc1
    s_mov_b32 exec_lo, 0x00010001
    s_mov_b32 exec_hi, 0x00010001
    buffer_store_dwordx4 v[48:51], v3, s[16:19], s39 offen offset:0 sc1
    buffer_store_dwordx4 v[60:63], v3, s[16:19], s39 offen offset:64 sc1
    s_mov_b64 exec, -1
    s_lshl_b32 s67, s5, 12
    s_add_u32 s67, s67, 327680
    s_lshl_b32 s68, s4, 1
    s_add_u32 s68, s68, s7
    s_lshl_b32 s68, s68, 7
    s_add_u32 s67, s67, s68
    s_waitcnt vmcnt(0)
    v_mov_b32 v2, 1
    v_mov_b32 v3, 0
    s_mov_b64 exec, 1
    buffer_store_dword v2, v3, s[88:91], s67 offen sc1
    s_mov_b64 exec, -1
L_q_28:
    v_and_b32 v140, 15, v1
    v_lshlrev_b32 v140, 2, v140
    v_add_u32 v140, s69, v140
    ds_read_b32 v104, v140 offset:0
    ds_read_b32 v108, v140 offset:512
    ds_read_b32 v105, v140 offset:64
    ds_read_b32 v109, v140 offset:576
    ds_read_b32 v106, v140 offset:128
    ds_read_b32 v110, v140 offset:640
    ds_read_b32 v107, v140 offset:192
    ds_read_b32 v111, v140 offset:704
    v_lshrrev_b32 v141, 4, v1
    v_lshlrev_b32 v141, 4, v141
    s_lshl_b32 s37, s7, 7
    s_add_u32 s37, s37, 154624
    v_add_u32 v141, s37, v141
    ds_read_b128 v[112:115], v141 offset:0
    ds_read_b128 v[116:119], v141 offset:64
    s_waitcnt lgkmcnt(0)
    v_fmac_f32 v8, v104, v112
    v_fmac_f32 v9, v104, v113
    v_fmac_f32 v10, v104, v114
    v_fmac_f32 v11, v104, v115
    v_fmaak_f32 v8, v8, v108, 0x358637bd
    v_fmaak_f32 v9, v9, v108, 0x358637bd
    v_fmaak_f32 v10, v10, v108, 0x358637bd
    v_fmaak_f32 v11, v11, v108, 0x358637bd
    v_mul_f32 v144, s82, v8
    v_mul_f32 v145, s82, v9
    v_mul_f32 v146, s82, v10
    v_mul_f32 v147, s82, v11
    v_exp_f32 v144, v144 clamp
    v_exp_f32 v145, v145 clamp
    v_exp_f32 v146, v146 clamp
    v_exp_f32 v147, v147 clamp
    v_max_f32 v8, s84, v8
    v_max_f32 v9, s84, v9
    v_max_f32 v10, s84, v10
    v_max_f32 v11, s84, v11
    v_add_f32 v8, v8, v144
    v_add_f32 v9, v9, v145
    v_add_f32 v10, v10, v146
    v_add_f32 v11, v11, v147
    v_cvt_pk_bf16_f32 v124, v8, v9
    v_cvt_pk_bf16_f32 v125, v10, v11
    v_fmac_f32 v24, v104, v116
    v_fmac_f32 v25, v104, v117
    v_fmac_f32 v26, v104, v118
    v_fmac_f32 v27, v104, v119
    v_fmaak_f32 v24, v24, v108, 0x358637bd
    v_fmaak_f32 v25, v25, v108, 0x358637bd
    v_fmaak_f32 v26, v26, v108, 0x358637bd
    v_fmaak_f32 v27, v27, v108, 0x358637bd
    v_mul_f32 v120, s82, v24
    v_mul_f32 v121, s82, v25
    v_mul_f32 v122, s82, v26
    v_mul_f32 v123, s82, v27
    v_exp_f32 v120, v120 clamp
    v_exp_f32 v121, v121 clamp
    v_exp_f32 v122, v122 clamp
    v_exp_f32 v123, v123 clamp
    v_max_f32 v24, s84, v24
    v_max_f32 v25, s84, v25
    v_max_f32 v26, s84, v26
    v_max_f32 v27, s84, v27
    v_add_f32 v24, v24, v120
    v_add_f32 v25, v25, v121
    v_add_f32 v26, v26, v122
    v_add_f32 v27, v27, v123
    v_cvt_pk_bf16_f32 v126, v24, v25
    v_cvt_pk_bf16_f32 v127, v26, v27
    v_fmac_f32 v12, v105, v112
    v_fmac_f32 v13, v105, v113
    v_fmac_f32 v14, v105, v114
    v_fmac_f32 v15, v105, v115
    v_fmaak_f32 v12, v12, v109, 0x358637bd
    v_fmaak_f32 v13, v13, v109, 0x358637bd
    v_fmaak_f32 v14, v14, v109, 0x358637bd
    v_fmaak_f32 v15, v15, v109, 0x358637bd
    v_mul_f32 v144, s82, v12
    v_mul_f32 v145, s82, v13
    v_mul_f32 v146, s82, v14
    v_mul_f32 v147, s82, v15
    v_exp_f32 v144, v144 clamp
    v_exp_f32 v145, v145 clamp
    v_exp_f32 v146, v146 clamp
    v_exp_f32 v147, v147 clamp
    v_max_f32 v12, s84, v12
    v_max_f32 v13, s84, v13
    v_max_f32 v14, s84, v14
    v_max_f32 v15, s84, v15
    v_add_f32 v12, v12, v144
    v_add_f32 v13, v13, v145
    v_add_f32 v14, v14, v146
    v_add_f32 v15, v15, v147
    v_cvt_pk_bf16_f32 v128, v12, v13
    v_cvt_pk_bf16_f32 v129, v14, v15
    v_fmac_f32 v28, v105, v116
    v_fmac_f32 v29, v105, v117
    v_fmac_f32 v30, v105, v118
    v_fmac_f32 v31, v105, v119
    v_fmaak_f32 v28, v28, v109, 0x358637bd
    v_fmaak_f32 v29, v29, v109, 0x358637bd
    v_fmaak_f32 v30, v30, v109, 0x358637bd
    v_fmaak_f32 v31, v31, v109, 0x358637bd
    v_mul_f32 v120, s82, v28
    v_mul_f32 v121, s82, v29
    v_mul_f32 v122, s82, v30
    v_mul_f32 v123, s82, v31
    v_exp_f32 v120, v120 clamp
    v_exp_f32 v121, v121 clamp
    v_exp_f32 v122, v122 clamp
    v_exp_f32 v123, v123 clamp
    v_max_f32 v28, s84, v28
    v_max_f32 v29, s84, v29
    v_max_f32 v30, s84, v30
    v_max_f32 v31, s84, v31
    v_add_f32 v28, v28, v120
    v_add_f32 v29, v29, v121
    v_add_f32 v30, v30, v122
    v_add_f32 v31, v31, v123
    v_cvt_pk_bf16_f32 v130, v28, v29
    v_cvt_pk_bf16_f32 v131, v30, v31
    v_fmac_f32 v16, v106, v112
    v_fmac_f32 v17, v106, v113
    v_fmac_f32 v18, v106, v114
    v_fmac_f32 v19, v106, v115
    v_fmaak_f32 v16, v16, v110, 0x358637bd
    v_fmaak_f32 v17, v17, v110, 0x358637bd
    v_fmaak_f32 v18, v18, v110, 0x358637bd
    v_fmaak_f32 v19, v19, v110, 0x358637bd
    v_mul_f32 v144, s82, v16
    v_mul_f32 v145, s82, v17
    v_mul_f32 v146, s82, v18
    v_mul_f32 v147, s82, v19
    v_exp_f32 v144, v144 clamp
    v_exp_f32 v145, v145 clamp
    v_exp_f32 v146, v146 clamp
    v_exp_f32 v147, v147 clamp
    v_max_f32 v16, s84, v16
    v_max_f32 v17, s84, v17
    v_max_f32 v18, s84, v18
    v_max_f32 v19, s84, v19
    v_add_f32 v16, v16, v144
    v_add_f32 v17, v17, v145
    v_add_f32 v18, v18, v146
    v_add_f32 v19, v19, v147
    v_cvt_pk_bf16_f32 v132, v16, v17
    v_cvt_pk_bf16_f32 v133, v18, v19
    v_fmac_f32 v32, v106, v116
    v_fmac_f32 v33, v106, v117
    v_fmac_f32 v34, v106, v118
    v_fmac_f32 v35, v106, v119
    v_fmaak_f32 v32, v32, v110, 0x358637bd
    v_fmaak_f32 v33, v33, v110, 0x358637bd
    v_fmaak_f32 v34, v34, v110, 0x358637bd
    v_fmaak_f32 v35, v35, v110, 0x358637bd
    v_mul_f32 v120, s82, v32
    v_mul_f32 v121, s82, v33
    v_mul_f32 v122, s82, v34
    v_mul_f32 v123, s82, v35
    v_exp_f32 v120, v120 clamp
    v_exp_f32 v121, v121 clamp
    v_exp_f32 v122, v122 clamp
    v_exp_f32 v123, v123 clamp
    v_max_f32 v32, s84, v32
    v_max_f32 v33, s84, v33
    v_max_f32 v34, s84, v34
    v_max_f32 v35, s84, v35
    v_add_f32 v32, v32, v120
    v_add_f32 v33, v33, v121
    v_add_f32 v34, v34, v122
    v_add_f32 v35, v35, v123
    v_cvt_pk_bf16_f32 v134, v32, v33
    v_cvt_pk_bf16_f32 v135, v34, v35
    v_fmac_f32 v20, v107, v112
    v_fmac_f32 v21, v107, v113
    v_fmac_f32 v22, v107, v114
    v_fmac_f32 v23, v107, v115
    v_fmaak_f32 v20, v20, v111, 0x358637bd
    v_fmaak_f32 v21, v21, v111, 0x358637bd
    v_fmaak_f32 v22, v22, v111, 0x358637bd
    v_fmaak_f32 v23, v23, v111, 0x358637bd
    v_mul_f32 v144, s82, v20
    v_mul_f32 v145, s82, v21
    v_mul_f32 v146, s82, v22
    v_mul_f32 v147, s82, v23
    v_exp_f32 v144, v144 clamp
    v_exp_f32 v145, v145 clamp
    v_exp_f32 v146, v146 clamp
    v_exp_f32 v147, v147 clamp
    v_max_f32 v20, s84, v20
    v_max_f32 v21, s84, v21
    v_max_f32 v22, s84, v22
    v_max_f32 v23, s84, v23
    v_add_f32 v20, v20, v144
    v_add_f32 v21, v21, v145
    v_add_f32 v22, v22, v146
    v_add_f32 v23, v23, v147
    v_cvt_pk_bf16_f32 v136, v20, v21
    v_cvt_pk_bf16_f32 v137, v22, v23
    v_fmac_f32 v36, v107, v116
    v_fmac_f32 v37, v107, v117
    v_fmac_f32 v38, v107, v118
    v_fmac_f32 v39, v107, v119
    v_fmaak_f32 v36, v36, v111, 0x358637bd
    v_fmaak_f32 v37, v37, v111, 0x358637bd
    v_fmaak_f32 v38, v38, v111, 0x358637bd
    v_fmaak_f32 v39, v39, v111, 0x358637bd
    v_mul_f32 v120, s82, v36
    v_mul_f32 v121, s82, v37
    v_mul_f32 v122, s82, v38
    v_mul_f32 v123, s82, v39
    v_exp_f32 v120, v120 clamp
    v_exp_f32 v121, v121 clamp
    v_exp_f32 v122, v122 clamp
    v_exp_f32 v123, v123 clamp
    v_max_f32 v36, s84, v36
    v_max_f32 v37, s84, v37
    v_max_f32 v38, s84, v38
    v_max_f32 v39, s84, v39
    v_add_f32 v36, v36, v120
    v_add_f32 v37, v37, v121
    v_add_f32 v38, v38, v122
    v_add_f32 v39, v39, v123
    v_cvt_pk_bf16_f32 v138, v36, v37
    v_cvt_pk_bf16_f32 v139, v38, v39
    s_barrier
    s_add_u32 s24, s64, 0x3800000
    s_addc_u32 s25, s65, 0
    s_mov_b32 s26, 0x400000
    s_mov_b32 s27, 0x20000
    v_lshlrev_b32 v2, 4, v1
    s_lshl_b32 s38, s5, 1
    s_add_u32 s38, s38, s7
    s_lshl_b32 s37, s6, 8
    s_add_u32 s37, s37, s38
    s_lshl_b32 s37, s37, 11
    s_lshl_b32 s38, s38, 4
    s_lshl_b32 s39, s6, 3
    s_add_u32 s38, s38, s39
    s_lshl_b32 s38, s38, 7
    s_add_u32 s38, s38, 2097152
    buffer_load_dwordx4 v[72:75], v2, s[24:27], s38 offen sc1
    buffer_load_dwordx4 v[8:11], v2, s[24:27], s37 offen offset:0 sc1
    buffer_load_dwordx4 v[12:15], v2, s[24:27], s37 offen offset:1024 sc1
    s_add_u32 s37, s37, 65536
    buffer_load_dwordx4 v[16:19], v2, s[24:27], s37 offen offset:0 sc1
    buffer_load_dwordx4 v[20:23], v2, s[24:27], s37 offen offset:1024 sc1
    s_add_u32 s37, s37, 65536
    buffer_load_dwordx4 v[24:27], v2, s[24:27], s37 offen offset:0 sc1
    buffer_load_dwordx4 v[28:31], v2, s[24:27], s37 offen offset:1024 sc1
    s_add_u32 s37, s37, 65536
    buffer_load_dwordx4 v[32:35], v2, s[24:27], s37 offen offset:0 sc1
    buffer_load_dwordx4 v[36:39], v2, s[24:27], s37 offen offset:1024 sc1
    s_add_u32 s37, s37, 65536
    buffer_load_dwordx4 v[40:43], v2, s[24:27], s37 offen offset:0 sc1
    buffer_load_dwordx4 v[44:47], v2, s[24:27], s37 offen offset:1024 sc1
    s_add_u32 s37, s37, 65536
    buffer_load_dwordx4 v[48:51], v2, s[24:27], s37 offen offset:0 sc1
    buffer_load_dwordx4 v[52:55], v2, s[24:27], s37 offen offset:1024 sc1
    s_add_u32 s37, s37, 65536
    buffer_load_dwordx4 v[56:59], v2, s[24:27], s37 offen offset:0 sc1
    buffer_load_dwordx4 v[60:63], v2, s[24:27], s37 offen offset:1024 sc1
    s_add_u32 s37, s37, 65536
    buffer_load_dwordx4 v[64:67], v2, s[24:27], s37 offen offset:0 sc1
    buffer_load_dwordx4 v[68:71], v2, s[24:27], s37 offen offset:1024 sc1
    v_mov_b32 v168, 0xffff0000
    s_waitcnt vmcnt(16)
    v_add_f32_dpp v72, v72, v72 row_ror:8 row_mask:0xf bank_mask:0xf
    v_add_f32_dpp v73, v73, v73 row_ror:8 row_mask:0xf bank_mask:0xf
    v_add_f32_dpp v74, v74, v74 row_ror:8 row_mask:0xf bank_mask:0xf
    v_add_f32_dpp v75, v75, v75 row_ror:8 row_mask:0xf bank_mask:0xf
    v_mov_b32 v164, v72
    v_mov_b32 v165, v73
    v_mov_b32 v166, v74
    v_mov_b32 v167, v75
    v_permlane16_swap_b32 v164, v72
    v_permlane16_swap_b32 v165, v73
    v_permlane16_swap_b32 v166, v74
    v_permlane16_swap_b32 v167, v75
    v_add_f32 v72, v72, v164
    v_add_f32 v73, v73, v165
    v_add_f32 v74, v74, v166
    v_add_f32 v75, v75, v167
    v_mov_b32 v164, v72
    v_mov_b32 v165, v73
    v_mov_b32 v166, v74
    v_mov_b32 v167, v75
    v_permlane32_swap_b32 v164, v72
    v_permlane32_swap_b32 v165, v73
    v_permlane32_swap_b32 v166, v74
    v_permlane32_swap_b32 v167, v75
    v_add_f32 v72, v72, v164
    v_add_f32 v73, v73, v165
    v_add_f32 v74, v74, v166
    v_add_f32 v75, v75, v167
    s_waitcnt vmcnt(14)
    v_lshlrev_b32 v148, 16, v8
    v_and_b32 v149, v168, v8
    v_lshlrev_b32 v150, 16, v9
    v_and_b32 v151, v168, v9
    v_lshlrev_b32 v152, 16, v10
    v_and_b32 v153, v168, v10
    v_lshlrev_b32 v154, 16, v11
    v_and_b32 v155, v168, v11
    v_lshlrev_b32 v156, 16, v12
    v_and_b32 v157, v168, v12
    v_lshlrev_b32 v158, 16, v13
    v_and_b32 v159, v168, v13
    v_lshlrev_b32 v160, 16, v14
    v_and_b32 v161, v168, v14
    v_lshlrev_b32 v162, 16, v15
    v_and_b32 v163, v168, v15
    s_waitcnt vmcnt(12)
    v_lshlrev_b32 v164, 16, v16
    v_and_b32 v165, v168, v16
    v_add_f32 v148, v148, v164
    v_add_f32 v149, v149, v165
    v_lshlrev_b32 v166, 16, v17
    v_and_b32 v167, v168, v17
    v_add_f32 v150, v150, v166
    v_add_f32 v151, v151, v167
    v_lshlrev_b32 v164, 16, v18
    v_and_b32 v165, v168, v18
    v_add_f32 v152, v152, v164
    v_add_f32 v153, v153, v165
    v_lshlrev_b32 v166, 16, v19
    v_and_b32 v167, v168, v19
    v_add_f32 v154, v154, v166
    v_add_f32 v155, v155, v167
    v_lshlrev_b32 v164, 16, v20
    v_and_b32 v165, v168, v20
    v_add_f32 v156, v156, v164
    v_add_f32 v157, v157, v165
    v_lshlrev_b32 v166, 16, v21
    v_and_b32 v167, v168, v21
    v_add_f32 v158, v158, v166
    v_add_f32 v159, v159, v167
    v_lshlrev_b32 v164, 16, v22
    v_and_b32 v165, v168, v22
    v_add_f32 v160, v160, v164
    v_add_f32 v161, v161, v165
    v_lshlrev_b32 v166, 16, v23
    v_and_b32 v167, v168, v23
    v_add_f32 v162, v162, v166
    v_add_f32 v163, v163, v167
    s_waitcnt vmcnt(10)
    v_lshlrev_b32 v164, 16, v24
    v_and_b32 v165, v168, v24
    v_add_f32 v148, v148, v164
    v_add_f32 v149, v149, v165
    v_lshlrev_b32 v166, 16, v25
    v_and_b32 v167, v168, v25
    v_add_f32 v150, v150, v166
    v_add_f32 v151, v151, v167
    v_lshlrev_b32 v164, 16, v26
    v_and_b32 v165, v168, v26
    v_add_f32 v152, v152, v164
    v_add_f32 v153, v153, v165
    v_lshlrev_b32 v166, 16, v27
    v_and_b32 v167, v168, v27
    v_add_f32 v154, v154, v166
    v_add_f32 v155, v155, v167
    v_lshlrev_b32 v164, 16, v28
    v_and_b32 v165, v168, v28
    v_add_f32 v156, v156, v164
    v_add_f32 v157, v157, v165
    v_lshlrev_b32 v166, 16, v29
    v_and_b32 v167, v168, v29
    v_add_f32 v158, v158, v166
    v_add_f32 v159, v159, v167
    v_lshlrev_b32 v164, 16, v30
    v_and_b32 v165, v168, v30
    v_add_f32 v160, v160, v164
    v_add_f32 v161, v161, v165
    v_lshlrev_b32 v166, 16, v31
    v_and_b32 v167, v168, v31
    v_add_f32 v162, v162, v166
    v_add_f32 v163, v163, v167
    s_waitcnt vmcnt(8)
    v_lshlrev_b32 v164, 16, v32
    v_and_b32 v165, v168, v32
    v_add_f32 v148, v148, v164
    v_add_f32 v149, v149, v165
    v_lshlrev_b32 v166, 16, v33
    v_and_b32 v167, v168, v33
    v_add_f32 v150, v150, v166
    v_add_f32 v151, v151, v167
    v_lshlrev_b32 v164, 16, v34
    v_and_b32 v165, v168, v34
    v_add_f32 v152, v152, v164
    v_add_f32 v153, v153, v165
    v_lshlrev_b32 v166, 16, v35
    v_and_b32 v167, v168, v35
    v_add_f32 v154, v154, v166
    v_add_f32 v155, v155, v167
    v_lshlrev_b32 v164, 16, v36
    v_and_b32 v165, v168, v36
    v_add_f32 v156, v156, v164
    v_add_f32 v157, v157, v165
    v_lshlrev_b32 v166, 16, v37
    v_and_b32 v167, v168, v37
    v_add_f32 v158, v158, v166
    v_add_f32 v159, v159, v167
    v_lshlrev_b32 v164, 16, v38
    v_and_b32 v165, v168, v38
    v_add_f32 v160, v160, v164
    v_add_f32 v161, v161, v165
    v_lshlrev_b32 v166, 16, v39
    v_and_b32 v167, v168, v39
    v_add_f32 v162, v162, v166
    v_add_f32 v163, v163, v167
    s_waitcnt vmcnt(6)
    v_lshlrev_b32 v164, 16, v40
    v_and_b32 v165, v168, v40
    v_add_f32 v148, v148, v164
    v_add_f32 v149, v149, v165
    v_lshlrev_b32 v166, 16, v41
    v_and_b32 v167, v168, v41
    v_add_f32 v150, v150, v166
    v_add_f32 v151, v151, v167
    v_lshlrev_b32 v164, 16, v42
    v_and_b32 v165, v168, v42
    v_add_f32 v152, v152, v164
    v_add_f32 v153, v153, v165
    v_lshlrev_b32 v166, 16, v43
    v_and_b32 v167, v168, v43
    v_add_f32 v154, v154, v166
    v_add_f32 v155, v155, v167
    v_lshlrev_b32 v164, 16, v44
    v_and_b32 v165, v168, v44
    v_add_f32 v156, v156, v164
    v_add_f32 v157, v157, v165
    v_lshlrev_b32 v166, 16, v45
    v_and_b32 v167, v168, v45
    v_add_f32 v158, v158, v166
    v_add_f32 v159, v159, v167
    v_lshlrev_b32 v164, 16, v46
    v_and_b32 v165, v168, v46
    v_add_f32 v160, v160, v164
    v_add_f32 v161, v161, v165
    v_lshlrev_b32 v166, 16, v47
    v_and_b32 v167, v168, v47
    v_add_f32 v162, v162, v166
    v_add_f32 v163, v163, v167
    s_waitcnt vmcnt(4)
    v_lshlrev_b32 v164, 16, v48
    v_and_b32 v165, v168, v48
    v_add_f32 v148, v148, v164
    v_add_f32 v149, v149, v165
    v_lshlrev_b32 v166, 16, v49
    v_and_b32 v167, v168, v49
    v_add_f32 v150, v150, v166
    v_add_f32 v151, v151, v167
    v_lshlrev_b32 v164, 16, v50
    v_and_b32 v165, v168, v50
    v_add_f32 v152, v152, v164
    v_add_f32 v153, v153, v165
    v_lshlrev_b32 v166, 16, v51
    v_and_b32 v167, v168, v51
    v_add_f32 v154, v154, v166
    v_add_f32 v155, v155, v167
    v_lshlrev_b32 v164, 16, v52
    v_and_b32 v165, v168, v52
    v_add_f32 v156, v156, v164
    v_add_f32 v157, v157, v165
    v_lshlrev_b32 v166, 16, v53
    v_and_b32 v167, v168, v53
    v_add_f32 v158, v158, v166
    v_add_f32 v159, v159, v167
    v_lshlrev_b32 v164, 16, v54
    v_and_b32 v165, v168, v54
    v_add_f32 v160, v160, v164
    v_add_f32 v161, v161, v165
    v_lshlrev_b32 v166, 16, v55
    v_and_b32 v167, v168, v55
    v_add_f32 v162, v162, v166
    v_add_f32 v163, v163, v167
    s_waitcnt vmcnt(2)
    v_lshlrev_b32 v164, 16, v56
    v_and_b32 v165, v168, v56
    v_add_f32 v148, v148, v164
    v_add_f32 v149, v149, v165
    v_lshlrev_b32 v166, 16, v57
    v_and_b32 v167, v168, v57
    v_add_f32 v150, v150, v166
    v_add_f32 v151, v151, v167
    v_lshlrev_b32 v164, 16, v58
    v_and_b32 v165, v168, v58
    v_add_f32 v152, v152, v164
    v_add_f32 v153, v153, v165
    v_lshlrev_b32 v166, 16, v59
    v_and_b32 v167, v168, v59
    v_add_f32 v154, v154, v166
    v_add_f32 v155, v155, v167
    v_lshlrev_b32 v164, 16, v60
    v_and_b32 v165, v168, v60
    v_add_f32 v156, v156, v164
    v_add_f32 v157, v157, v165
    v_lshlrev_b32 v166, 16, v61
    v_and_b32 v167, v168, v61
    v_add_f32 v158, v158, v166
    v_add_f32 v159, v159, v167
    v_lshlrev_b32 v164, 16, v62
    v_and_b32 v165, v168, v62
    v_add_f32 v160, v160, v164
    v_add_f32 v161, v161, v165
    v_lshlrev_b32 v166, 16, v63
    v_and_b32 v167, v168, v63
    v_add_f32 v162, v162, v166
    v_add_f32 v163, v163, v167
    s_waitcnt vmcnt(0)
    v_lshlrev_b32 v164, 16, v64
    v_and_b32 v165, v168, v64
    v_add_f32 v148, v148, v164
    v_add_f32 v149, v149, v165
    v_lshlrev_b32 v166, 16, v65
    v_and_b32 v167, v168, v65
    v_add_f32 v150, v150, v166
    v_add_f32 v151, v151, v167
    v_lshlrev_b32 v164, 16, v66
    v_and_b32 v165, v168, v66
    v_add_f32 v152, v152, v164
    v_add_f32 v153, v153, v165
    v_lshlrev_b32 v166, 16, v67
    v_and_b32 v167, v168, v67
    v_add_f32 v154, v154, v166
    v_add_f32 v155, v155, v167
    v_lshlrev_b32 v164, 16, v68
    v_and_b32 v165, v168, v68
    v_add_f32 v156, v156, v164
    v_add_f32 v157, v157, v165
    v_lshlrev_b32 v166, 16, v69
    v_and_b32 v167, v168, v69
    v_add_f32 v158, v158, v166
    v_add_f32 v159, v159, v167
    v_lshlrev_b32 v164, 16, v70
    v_and_b32 v165, v168, v70
    v_add_f32 v160, v160, v164
    v_add_f32 v161, v161, v165
    v_lshlrev_b32 v166, 16, v71
    v_and_b32 v167, v168, v71
    v_add_f32 v162, v162, v166
    v_add_f32 v163, v163, v167
    v_lshrrev_b32 v2, 2, v1
    v_lshlrev_b32 v2, 7, v2
    v_and_b32 v3, 3, v1
    v_lshl_add_u32 v2, v3, 5, v2
    s_mul_i32 s37, s3, 5120
    s_add_u32 s37, s37, 122880
    v_add_u32 v2, s37, v2
    ds_write_b128 v2, v[148:151] offset:0
    ds_write_b128 v2, v[152:155] offset:16
    ds_write_b128 v2, v[156:159] offset:2048
    ds_write_b128 v2, v[160:163] offset:2064
    v_and_b32 v3, 7, v1
    v_lshlrev_b32 v3, 4, v3
    v_add_u32 v3, s37, v3
    ds_write_b128 v3, v[72:75] offset:4096
    s_waitcnt lgkmcnt(0)
    s_barrier
    v_and_b32 v2, 15, v1
    v_lshlrev_b32 v2, 7, v2
    v_lshrrev_b32 v3, 4, v1
    v_lshl_add_u32 v2, v3, 4, v2
    v_lshlrev_b32 v3, 4, v3
    s_mul_i32 s37, s7, 5120
    s_add_u32 s37, s37, 122880
    v_add_u32 v2, s37, v2
    v_add_u32 v3, s37, v3
    ds_read_b128 v[8:11], v2 offset:0
    ds_read_b128 v[12:15], v2 offset:64
    ds_read_b128 v[16:19], v2 offset:2048
    ds_read_b128 v[20:23], v2 offset:2112
    ds_read_b128 v[24:27], v3 offset:4096
    ds_read_b128 v[28:31], v3 offset:4160
    ds_read_b128 v[32:35], v2 offset:10240
    ds_read_b128 v[36:39], v2 offset:10304
    ds_read_b128 v[40:43], v2 offset:12288
    ds_read_b128 v[44:47], v2 offset:12352
    ds_read_b128 v[48:51], v3 offset:14336
    ds_read_b128 v[52:55], v3 offset:14400
    s_waitcnt lgkmcnt(0)
    v_add_f32 v8, v8, v32
    v_add_f32 v9, v9, v33
    v_add_f32 v10, v10, v34
    v_add_f32 v11, v11, v35
    v_add_f32 v12, v12, v36
    v_add_f32 v13, v13, v37
    v_add_f32 v14, v14, v38
    v_add_f32 v15, v15, v39
    v_add_f32 v16, v16, v40
    v_add_f32 v17, v17, v41
    v_add_f32 v18, v18, v42
    v_add_f32 v19, v19, v43
    v_add_f32 v20, v20, v44
    v_add_f32 v21, v21, v45
    v_add_f32 v22, v22, v46
    v_add_f32 v23, v23, v47
    v_add_f32 v24, v24, v48
    v_add_f32 v25, v25, v49
    v_add_f32 v26, v26, v50
    v_add_f32 v27, v27, v51
    v_add_f32 v28, v28, v52
    v_add_f32 v29, v29, v53
    v_add_f32 v30, v30, v54
    v_add_f32 v31, v31, v55
    v_cvt_pk_bf16_f32 v56, v8, v9
    v_cvt_pk_bf16_f32 v57, v10, v11
    v_cvt_pk_bf16_f32 v58, v12, v13
    v_cvt_pk_bf16_f32 v59, v14, v15
    v_cvt_pk_bf16_f32 v60, v16, v17
    v_cvt_pk_bf16_f32 v61, v18, v19
    v_cvt_pk_bf16_f32 v62, v20, v21
    v_cvt_pk_bf16_f32 v63, v22, v23
    v_cvt_pk_bf16_f32 v64, v24, v25
    v_cvt_pk_bf16_f32 v65, v26, v27
    v_cvt_pk_bf16_f32 v66, v28, v29
    v_cvt_pk_bf16_f32 v67, v30, v31
    v_mfma_f32_16x16x32_bf16 v[8:11], v[56:59], v[124:127], 0
    v_mfma_f32_16x16x32_bf16 v[12:15], v[60:63], v[124:127], 0
    v_mfma_f32_16x16x32_bf16 v[16:19], v[64:67], v[124:127], 0
    v_mfma_f32_16x16x32_bf16 v[20:23], v[56:59], v[128:131], 0
    v_mfma_f32_16x16x32_bf16 v[24:27], v[60:63], v[128:131], 0
    v_mfma_f32_16x16x32_bf16 v[28:31], v[64:67], v[128:131], 0
    v_mfma_f32_16x16x32_bf16 v[32:35], v[56:59], v[132:135], 0
    v_mfma_f32_16x16x32_bf16 v[36:39], v[60:63], v[132:135], 0
    v_mfma_f32_16x16x32_bf16 v[40:43], v[64:67], v[132:135], 0
    v_mfma_f32_16x16x32_bf16 v[44:47], v[56:59], v[136:139], 0
    v_mfma_f32_16x16x32_bf16 v[48:51], v[60:63], v[136:139], 0
    v_mfma_f32_16x16x32_bf16 v[52:55], v[64:67], v[136:139], 0
    s_add_u32 s16, s64, 0xf00000
    s_addc_u32 s17, s65, 0
    s_mov_b32 s18, 0x400000
    s_mov_b32 s19, 0x20000
    v_bfe_u32 v169, v1, 4, 1
    v_lshlrev_b32 v169, 5, v169
    v_bfe_u32 v2, v1, 5, 1
    v_lshl_add_u32 v169, v2, 4, v169
    v_and_b32 v2, 15, v1
    s_mov_b32 s68, 2048
    v_mad_u32_u24 v169, v2, s68, v169
    s_lshl_b32 s37, s4, 7
    s_lshl_b32 s38, s6, 6
    s_add_u32 s37, s37, s38
    s_mul_i32 s37, s37, 2048
    s_lshl_b32 s38, s5, 7
    s_add_u32 s37, s37, s38
    s_lshl_b32 s38, s7, 6
    s_add_u32 s37, s37, s38
    v_add_f32 v16, 0x358637bd, v16
    v_rcp_f32 v16, v16
    s_nop 0
    v_mul_f32 v8, v8, v16
    v_mul_f32 v9, v9, v16
    v_mul_f32 v10, v10, v16
    v_mul_f32 v11, v11, v16
    v_mul_f32 v12, v12, v16
    v_mul_f32 v13, v13, v16
    v_mul_f32 v14, v14, v16
    v_mul_f32 v15, v15, v16
    v_cvt_pk_bf16_f32 v172, v8, v9
    v_cvt_pk_bf16_f32 v173, v10, v11
    v_cvt_pk_bf16_f32 v174, v12, v13
    v_cvt_pk_bf16_f32 v175, v14, v15
    s_nop 0
    v_permlane16_swap_b32 v172, v174
    v_permlane16_swap_b32 v173, v175
    s_add_u32 s38, s37, 0
    buffer_store_dwordx4 v[172:175], v169, s[16:19], s38 offen sc1
    v_add_f32 v28, 0x358637bd, v28
    v_rcp_f32 v28, v28
    s_nop 0
    v_mul_f32 v20, v20, v28
    v_mul_f32 v21, v21, v28
    v_mul_f32 v22, v22, v28
    v_mul_f32 v23, v23, v28
    v_mul_f32 v24, v24, v28
    v_mul_f32 v25, v25, v28
    v_mul_f32 v26, v26, v28
    v_mul_f32 v27, v27, v28
    v_cvt_pk_bf16_f32 v176, v20, v21
    v_cvt_pk_bf16_f32 v177, v22, v23
    v_cvt_pk_bf16_f32 v178, v24, v25
    v_cvt_pk_bf16_f32 v179, v26, v27
    s_nop 0
    v_permlane16_swap_b32 v176, v178
    v_permlane16_swap_b32 v177, v179
    s_add_u32 s38, s37, 32768
    buffer_store_dwordx4 v[176:179], v169, s[16:19], s38 offen sc1
    v_add_f32 v40, 0x358637bd, v40
    v_rcp_f32 v40, v40
    s_nop 0
    v_mul_f32 v32, v32, v40
    v_mul_f32 v33, v33, v40
    v_mul_f32 v34, v34, v40
    v_mul_f32 v35, v35, v40
    v_mul_f32 v36, v36, v40
    v_mul_f32 v37, v37, v40
    v_mul_f32 v38, v38, v40
    v_mul_f32 v39, v39, v40
    v_cvt_pk_bf16_f32 v180, v32, v33
    v_cvt_pk_bf16_f32 v181, v34, v35
    v_cvt_pk_bf16_f32 v182, v36, v37
    v_cvt_pk_bf16_f32 v183, v38, v39
    s_nop 0
    v_permlane16_swap_b32 v180, v182
    v_permlane16_swap_b32 v181, v183
    s_add_u32 s38, s37, 65536
    buffer_store_dwordx4 v[180:183], v169, s[16:19], s38 offen sc1
    v_add_f32 v52, 0x358637bd, v52
    v_rcp_f32 v52, v52
    s_nop 0
    v_mul_f32 v44, v44, v52
    v_mul_f32 v45, v45, v52
    v_mul_f32 v46, v46, v52
    v_mul_f32 v47, v47, v52
    v_mul_f32 v48, v48, v52
    v_mul_f32 v49, v49, v52
    v_mul_f32 v50, v50, v52
    v_mul_f32 v51, v51, v52
    v_cvt_pk_bf16_f32 v184, v44, v45
    v_cvt_pk_bf16_f32 v185, v46, v47
    v_cvt_pk_bf16_f32 v186, v48, v49
    v_cvt_pk_bf16_f32 v187, v50, v51
    s_nop 0
    v_permlane16_swap_b32 v184, v186
    v_permlane16_swap_b32 v185, v187
    s_add_u32 s38, s37, 98304
    buffer_store_dwordx4 v[184:187], v169, s[16:19], s38 offen sc1
    s_waitcnt vmcnt(0)
    v_mov_b32 v2, 1
    v_mov_b32 v3, 155648
    s_mov_b64 exec, 1
    ds_add_rtn_u32 v3, v3, v2
    s_waitcnt lgkmcnt(0)
    v_readfirstlane_b32 s68, v3
    s_nop 0
    s_and_b32 s68, s68, 3
    s_cmp_eq_u32 s68, 3
    s_cbranch_scc0 L_nf_29
    s_lshl_b32 s67, s4, 12
    s_add_u32 s67, s67, 393216
    s_lshl_b32 s68, s5, 7
    s_add_u32 s67, s67, s68
    v_mov_b32 v3, 0
    buffer_store_dword v2, v3, s[88:91], s67 offen sc1
L_nf_29:
    s_mov_b64 exec, -1
    s_and_b32 s37, s2, 3
    s_lshl_b32 s37, s37, 2
    s_bfe_u32 s38, s2, 0x20003
    s_add_u32 s4, s37, s38
    s_bfe_u32 s37, s2, 0x10002
    s_lshl_b32 s37, s37, 3
    s_lshr_b32 s38, s2, 5
    s_add_u32 s5, s37, s38
    v_and_b32 v1, 63, v0
    s_mov_b32 s6, s3
    s_mov_b32 s7, 0
    s_mul_i32 s39, s6, 4096
    v_and_b32 v2, 15, v1
    v_lshrrev_b32 v3, 1, v2
    v_lshlrev_b32 v2, 7, v2
    v_add_u32 v2, s39, v2
    v_lshrrev_b32 v4, 4, v1
    v_xor_b32 v3, v3, v4
    v_lshl_add_u32 v4, v3, 4, v2
    v_xor_b32 v5, 64, v4
    v_lshrrev_b32 v2, 4, v1
    v_lshlrev_b32 v2, 3, v2
    v_bfe_u32 v3, v1, 2, 2
    v_add_u32 v44, v2, v3
    v_bfe_u32 v45, v1, 3, 1
    v_lshlrev_b32 v45, 1, v45
    v_bfe_u32 v3, v1, 4, 1
    v_lshl_add_u32 v45, v3, 2, v45
    v_bfe_u32 v3, v1, 1, 1
    v_xor_b32 v3, v3, v45
    v_lshlrev_b32 v3, 4, v3
    v_lshl_add_u32 v3, v44, 7, v3
    v_and_b32 v2, 1, v1
    v_lshl_add_u32 v3, v2, 3, v3
    v_add_u32 v6, 16384, v3
    v_bfe_u32 v3, v1, 1, 1
    v_add_u32 v3, 2, v3
    v_xor_b32 v3, v3, v45
    v_lshlrev_b32 v3, 4, v3
    v_lshl_add_u32 v3, v44, 7, v3
    v_and_b32 v2, 1, v1
    v_lshl_add_u32 v3, v2, 3, v3
    v_add_u32 v7, 16384, v3
    v_bfe_u32 v3, v1, 1, 1
    v_add_u32 v3, 4, v3
    v_xor_b32 v3, v3, v45
    v_lshlrev_b32 v3, 4, v3
    v_lshl_add_u32 v3, v44, 7, v3
    v_and_b32 v2, 1, v1
    v_lshl_add_u32 v3, v2, 3, v3
    v_add_u32 v8, 16384, v3
    v_bfe_u32 v3, v1, 1, 1
    v_add_u32 v3, 6, v3
    v_xor_b32 v3, v3, v45
    v_lshlrev_b32 v3, 4, v3
    v_lshl_add_u32 v3, v44, 7, v3
    v_and_b32 v2, 1, v1
    v_lshl_add_u32 v3, v2, 3, v3
    v_add_u32 v9, 16384, v3
    v_mov_b32 v12, 0
    v_mov_b32 v13, 0
    v_mov_b32 v14, 0
    v_mov_b32 v15, 0
    v_mov_b32 v16, 0
    v_mov_b32 v17, 0
    v_mov_b32 v18, 0
    v_mov_b32 v19, 0
    v_mov_b32 v20, 0
    v_mov_b32 v21, 0
    v_mov_b32 v22, 0
    v_mov_b32 v23, 0
    v_mov_b32 v24, 0
    v_mov_b32 v25, 0
    v_mov_b32 v26, 0
    v_mov_b32 v27, 0
    v_mov_b32 v28, 0
    v_mov_b32 v29, 0
    v_mov_b32 v30, 0
    v_mov_b32 v31, 0
    v_mov_b32 v32, 0
    v_mov_b32 v33, 0
    v_mov_b32 v34, 0
    v_mov_b32 v35, 0
    v_mov_b32 v36, 0
    v_mov_b32 v37, 0
    v_mov_b32 v38, 0
    v_mov_b32 v39, 0
    v_mov_b32 v40, 0
    v_mov_b32 v41, 0
    v_mov_b32 v42, 0
    v_mov_b32 v43, 0
    s_waitcnt lgkmcnt(0)
    s_barrier
    s_mov_b32 s34, 0
    s_mov_b32 s46, -98304
    s_mov_b32 s47, 24576
    s_setprio 2
    s_barrier
    ds_read_b128 v[44:47], v4 offset:0
    ds_read_b64_tr_b16 v[76:77], v6 offset:0
    ds_read_b64_tr_b16 v[78:79], v6 offset:512
    ds_read_b128 v[48:51], v4 offset:2048
    ds_read_b64_tr_b16 v[80:81], v7 offset:0
    ds_read_b64_tr_b16 v[82:83], v7 offset:512
    ds_read_b64_tr_b16 v[84:85], v8 offset:0
    ds_read_b64_tr_b16 v[86:87], v8 offset:512
    ds_read_b64_tr_b16 v[88:89], v9 offset:0
    ds_read_b64_tr_b16 v[90:91], v9 offset:512
    ds_read_b128 v[52:55], v5 offset:0
    ds_read_b64_tr_b16 v[92:93], v6 offset:4096
    ds_read_b64_tr_b16 v[94:95], v6 offset:4608
    ds_read_b128 v[56:59], v5 offset:2048
    ds_read_b64_tr_b16 v[96:97], v7 offset:4096
    ds_read_b64_tr_b16 v[98:99], v7 offset:4608
    ds_read_b64_tr_b16 v[100:101], v8 offset:4096
    ds_read_b64_tr_b16 v[102:103], v8 offset:4608
    ds_read_b64_tr_b16 v[104:105], v9 offset:4096
    ds_read_b64_tr_b16 v[106:107], v9 offset:4608
    s_add_u32 s34, s34, 24576
    s_cmp_eq_u32 s34, 122880
    s_cselect_b32 s36, s46, s47
    s_cselect_b32 s34, 0, s34
    v_add_u32 v4, s36, v4
    v_add_u32 v5, s36, v5
    v_add_u32 v6, s36, v6
    v_add_u32 v7, s36, v7
    v_add_u32 v8, s36, v8
    v_add_u32 v9, s36, v9
    s_waitcnt lgkmcnt(0)
    s_barrier
    s_mov_b32 s35, 7
.p2align 6
L_cl_30:
    v_mfma_f32_16x16x32_bf16 v[12:15], v[76:79], v[44:47], v[12:15]
    ds_read_b128 v[60:63], v4 offset:0
    ds_read_b64_tr_b16 v[108:109], v6 offset:0
    v_mfma_f32_16x16x32_bf16 v[16:19], v[76:79], v[48:51], v[16:19]
    ds_read_b64_tr_b16 v[110:111], v6 offset:512
    ds_read_b128 v[64:67], v4 offset:2048
    v_mfma_f32_16x16x32_bf16 v[20:23], v[80:83], v[44:47], v[20:23]
    ds_read_b64_tr_b16 v[112:113], v7 offset:0
    ds_read_b64_tr_b16 v[114:115], v7 offset:512
    v_mfma_f32_16x16x32_bf16 v[24:27], v[80:83], v[48:51], v[24:27]
    ds_read_b64_tr_b16 v[116:117], v8 offset:0
    ds_read_b64_tr_b16 v[118:119], v8 offset:512
    v_mfma_f32_16x16x32_bf16 v[28:31], v[84:87], v[44:47], v[28:31]
    ds_read_b64_tr_b16 v[120:121], v9 offset:0
    ds_read_b64_tr_b16 v[122:123], v9 offset:512
    v_mfma_f32_16x16x32_bf16 v[32:35], v[84:87], v[48:51], v[32:35]
    ds_read_b128 v[68:71], v5 offset:0
    ds_read_b64_tr_b16 v[124:125], v6 offset:4096
    v_mfma_f32_16x16x32_bf16 v[36:39], v[88:91], v[44:47], v[36:39]
    ds_read_b64_tr_b16 v[126:127], v6 offset:4608
    ds_read_b128 v[72:75], v5 offset:2048
    v_mfma_f32_16x16x32_bf16 v[40:43], v[88:91], v[48:51], v[40:43]
    ds_read_b64_tr_b16 v[128:129], v7 offset:4096
    ds_read_b64_tr_b16 v[130:131], v7 offset:4608
    v_mfma_f32_16x16x32_bf16 v[12:15], v[92:95], v[52:55], v[12:15]
    ds_read_b64_tr_b16 v[132:133], v8 offset:4096
    ds_read_b64_tr_b16 v[134:135], v8 offset:4608
    v_mfma_f32_16x16x32_bf16 v[16:19], v[92:95], v[56:59], v[16:19]
    ds_read_b64_tr_b16 v[136:137], v9 offset:4096
    ds_read_b64_tr_b16 v[138:139], v9 offset:4608
    v_mfma_f32_16x16x32_bf16 v[20:23], v[96:99], v[52:55], v[20:23]
    s_add_u32 s34, s34, 24576
    s_cmp_eq_u32 s34, 122880
    v_mfma_f32_16x16x32_bf16 v[24:27], v[96:99], v[56:59], v[24:27]
    s_cselect_b32 s36, s46, s47
    s_cselect_b32 s34, 0, s34
    v_mfma_f32_16x16x32_bf16 v[28:31], v[100:103], v[52:55], v[28:31]
    v_add_u32 v4, s36, v4
    v_add_u32 v5, s36, v5
    v_mfma_f32_16x16x32_bf16 v[32:35], v[100:103], v[56:59], v[32:35]
    v_add_u32 v6, s36, v6
    v_add_u32 v7, s36, v7
    v_mfma_f32_16x16x32_bf16 v[36:39], v[104:107], v[52:55], v[36:39]
    v_add_u32 v8, s36, v8
    v_add_u32 v9, s36, v9
    v_mfma_f32_16x16x32_bf16 v[40:43], v[104:107], v[56:59], v[40:43]
    s_waitcnt lgkmcnt(0)
    s_barrier
    v_mfma_f32_16x16x32_bf16 v[12:15], v[108:111], v[60:63], v[12:15]
    ds_read_b128 v[44:47], v4 offset:0
    ds_read_b64_tr_b16 v[76:77], v6 offset:0
    v_mfma_f32_16x16x32_bf16 v[16:19], v[108:111], v[64:67], v[16:19]
    ds_read_b64_tr_b16 v[78:79], v6 offset:512
    ds_read_b128 v[48:51], v4 offset:2048
    v_mfma_f32_16x16x32_bf16 v[20:23], v[112:115], v[60:63], v[20:23]
    ds_read_b64_tr_b16 v[80:81], v7 offset:0
    ds_read_b64_tr_b16 v[82:83], v7 offset:512
    v_mfma_f32_16x16x32_bf16 v[24:27], v[112:115], v[64:67], v[24:27]
    ds_read_b64_tr_b16 v[84:85], v8 offset:0
    ds_read_b64_tr_b16 v[86:87], v8 offset:512
    v_mfma_f32_16x16x32_bf16 v[28:31], v[116:119], v[60:63], v[28:31]
    ds_read_b64_tr_b16 v[88:89], v9 offset:0
    ds_read_b64_tr_b16 v[90:91], v9 offset:512
    v_mfma_f32_16x16x32_bf16 v[32:35], v[116:119], v[64:67], v[32:35]
    ds_read_b128 v[52:55], v5 offset:0
    ds_read_b64_tr_b16 v[92:93], v6 offset:4096
    v_mfma_f32_16x16x32_bf16 v[36:39], v[120:123], v[60:63], v[36:39]
    ds_read_b64_tr_b16 v[94:95], v6 offset:4608
    ds_read_b128 v[56:59], v5 offset:2048
    v_mfma_f32_16x16x32_bf16 v[40:43], v[120:123], v[64:67], v[40:43]
    ds_read_b64_tr_b16 v[96:97], v7 offset:4096
    ds_read_b64_tr_b16 v[98:99], v7 offset:4608
    v_mfma_f32_16x16x32_bf16 v[12:15], v[124:127], v[68:71], v[12:15]
    ds_read_b64_tr_b16 v[100:101], v8 offset:4096
    ds_read_b64_tr_b16 v[102:103], v8 offset:4608
    v_mfma_f32_16x16x32_bf16 v[16:19], v[124:127], v[72:75], v[16:19]
    ds_read_b64_tr_b16 v[104:105], v9 offset:4096
    ds_read_b64_tr_b16 v[106:107], v9 offset:4608
    v_mfma_f32_16x16x32_bf16 v[20:23], v[128:131], v[68:71], v[20:23]
    s_add_u32 s34, s34, 24576
    s_cmp_eq_u32 s34, 122880
    v_mfma_f32_16x16x32_bf16 v[24:27], v[128:131], v[72:75], v[24:27]
    s_cselect_b32 s36, s46, s47
    s_cselect_b32 s34, 0, s34
    v_mfma_f32_16x16x32_bf16 v[28:31], v[132:135], v[68:71], v[28:31]
    v_add_u32 v4, s36, v4
    v_add_u32 v5, s36, v5
    v_mfma_f32_16x16x32_bf16 v[32:35], v[132:135], v[72:75], v[32:35]
    v_add_u32 v6, s36, v6
    v_add_u32 v7, s36, v7
    v_mfma_f32_16x16x32_bf16 v[36:39], v[136:139], v[68:71], v[36:39]
    v_add_u32 v8, s36, v8
    v_add_u32 v9, s36, v9
    v_mfma_f32_16x16x32_bf16 v[40:43], v[136:139], v[72:75], v[40:43]
    s_sub_u32 s35, s35, 1
    s_cmp_lg_u32 s35, 0
    s_waitcnt lgkmcnt(0)
    s_barrier
    s_cbranch_scc1 L_cl_30
    v_mfma_f32_16x16x32_bf16 v[12:15], v[76:79], v[44:47], v[12:15]
    ds_read_b128 v[60:63], v4 offset:0
    ds_read_b64_tr_b16 v[108:109], v6 offset:0
    v_mfma_f32_16x16x32_bf16 v[16:19], v[76:79], v[48:51], v[16:19]
    ds_read_b64_tr_b16 v[110:111], v6 offset:512
    ds_read_b128 v[64:67], v4 offset:2048
    v_mfma_f32_16x16x32_bf16 v[20:23], v[80:83], v[44:47], v[20:23]
    ds_read_b64_tr_b16 v[112:113], v7 offset:0
    ds_read_b64_tr_b16 v[114:115], v7 offset:512
    v_mfma_f32_16x16x32_bf16 v[24:27], v[80:83], v[48:51], v[24:27]
    ds_read_b64_tr_b16 v[116:117], v8 offset:0
    ds_read_b64_tr_b16 v[118:119], v8 offset:512
    v_mfma_f32_16x16x32_bf16 v[28:31], v[84:87], v[44:47], v[28:31]
    ds_read_b64_tr_b16 v[120:121], v9 offset:0
    ds_read_b64_tr_b16 v[122:123], v9 offset:512
    v_mfma_f32_16x16x32_bf16 v[32:35], v[84:87], v[48:51], v[32:35]
    ds_read_b128 v[68:71], v5 offset:0
    ds_read_b64_tr_b16 v[124:125], v6 offset:4096
    v_mfma_f32_16x16x32_bf16 v[36:39], v[88:91], v[44:47], v[36:39]
    ds_read_b64_tr_b16 v[126:127], v6 offset:4608
    ds_read_b128 v[72:75], v5 offset:2048
    v_mfma_f32_16x16x32_bf16 v[40:43], v[88:91], v[48:51], v[40:43]
    ds_read_b64_tr_b16 v[128:129], v7 offset:4096
    ds_read_b64_tr_b16 v[130:131], v7 offset:4608
    v_mfma_f32_16x16x32_bf16 v[12:15], v[92:95], v[52:55], v[12:15]
    ds_read_b64_tr_b16 v[132:133], v8 offset:4096
    ds_read_b64_tr_b16 v[134:135], v8 offset:4608
    v_mfma_f32_16x16x32_bf16 v[16:19], v[92:95], v[56:59], v[16:19]
    ds_read_b64_tr_b16 v[136:137], v9 offset:4096
    ds_read_b64_tr_b16 v[138:139], v9 offset:4608
    v_mfma_f32_16x16x32_bf16 v[20:23], v[96:99], v[52:55], v[20:23]
    v_mfma_f32_16x16x32_bf16 v[24:27], v[96:99], v[56:59], v[24:27]
    v_mfma_f32_16x16x32_bf16 v[28:31], v[100:103], v[52:55], v[28:31]
    v_mfma_f32_16x16x32_bf16 v[32:35], v[100:103], v[56:59], v[32:35]
    v_mfma_f32_16x16x32_bf16 v[36:39], v[104:107], v[52:55], v[36:39]
    v_mfma_f32_16x16x32_bf16 v[40:43], v[104:107], v[56:59], v[40:43]
    s_waitcnt lgkmcnt(0)
    s_barrier
    v_mfma_f32_16x16x32_bf16 v[12:15], v[108:111], v[60:63], v[12:15]
    v_mfma_f32_16x16x32_bf16 v[16:19], v[108:111], v[64:67], v[16:19]
    v_mfma_f32_16x16x32_bf16 v[20:23], v[112:115], v[60:63], v[20:23]
    v_mfma_f32_16x16x32_bf16 v[24:27], v[112:115], v[64:67], v[24:27]
    v_mfma_f32_16x16x32_bf16 v[28:31], v[116:119], v[60:63], v[28:31]
    v_mfma_f32_16x16x32_bf16 v[32:35], v[116:119], v[64:67], v[32:35]
    v_mfma_f32_16x16x32_bf16 v[36:39], v[120:123], v[60:63], v[36:39]
    v_mfma_f32_16x16x32_bf16 v[40:43], v[120:123], v[64:67], v[40:43]
    v_mfma_f32_16x16x32_bf16 v[12:15], v[124:127], v[68:71], v[12:15]
    v_mfma_f32_16x16x32_bf16 v[16:19], v[124:127], v[72:75], v[16:19]
    v_mfma_f32_16x16x32_bf16 v[20:23], v[128:131], v[68:71], v[20:23]
    v_mfma_f32_16x16x32_bf16 v[24:27], v[128:131], v[72:75], v[24:27]
    v_mfma_f32_16x16x32_bf16 v[28:31], v[132:135], v[68:71], v[28:31]
    v_mfma_f32_16x16x32_bf16 v[32:35], v[132:135], v[72:75], v[32:35]
    v_mfma_f32_16x16x32_bf16 v[36:39], v[136:139], v[68:71], v[36:39]
    v_mfma_f32_16x16x32_bf16 v[40:43], v[136:139], v[72:75], v[40:43]
    s_setprio 0
    v_and_b32 v2, 15, v1
    v_lshrrev_b32 v3, 1, v2
    v_lshlrev_b32 v2, 7, v2
    s_lshl_b32 s37, s6, 12
    s_add_u32 s37, s37, 135168
    v_add_u32 v2, s37, v2
    v_bfe_u32 v64, v1, 4, 1
    v_lshl_add_u32 v2, v64, 3, v2
    v_bfe_u32 v64, v1, 5, 1
    v_add_u32 v65, 0, v64
    v_xor_b32 v65, v65, v3
    v_lshl_add_u32 v60, v65, 4, v2
    v_add_u32 v65, 2, v64
    v_xor_b32 v65, v65, v3
    v_lshl_add_u32 v61, v65, 4, v2
    v_add_u32 v65, 4, v64
    v_xor_b32 v65, v65, v3
    v_lshl_add_u32 v62, v65, 4, v2
    v_add_u32 v65, 6, v64
    v_xor_b32 v65, v65, v3
    v_lshl_add_u32 v63, v65, 4, v2
    ds_read_b64 v[44:45], v60 offset:0
    ds_read_b64 v[46:47], v61 offset:0
    ds_read_b64 v[48:49], v62 offset:0
    ds_read_b64 v[50:51], v63 offset:0
    ds_read_b64 v[52:53], v60 offset:2048
    ds_read_b64 v[54:55], v61 offset:2048
    ds_read_b64 v[56:57], v62 offset:2048
    ds_read_b64 v[58:59], v63 offset:2048
    s_mov_b32 s16, s64
    s_mov_b32 s17, s65
    s_mov_b32 s18, 0x400000
    s_mov_b32 s19, 0x20000
    s_add_u32 s24, s64, 0x3cc0000
    s_addc_u32 s25, s65, 0
    s_mov_b32 s26, 0x40000
    s_mov_b32 s27, 0x20000
    v_bfe_u32 v64, v1, 4, 1
    v_lshlrev_b32 v64, 5, v64
    v_bfe_u32 v2, v1, 5, 1
    v_lshl_add_u32 v64, v2, 4, v64
    v_and_b32 v2, 15, v1
    s_mov_b32 s68, 2048
    v_mad_u32_u24 v64, v2, s68, v64
    s_lshl_b32 s37, s4, 7
    s_lshl_b32 s38, s6, 5
    s_add_u32 s69, s37, s38
    s_mul_i32 s37, s69, 2048
    s_lshl_b32 s38, s5, 7
    s_add_u32 s37, s37, s38
    v_mov_b32 v96, 0xffff0000
    s_waitcnt lgkmcnt(0)
    v_lshlrev_b32 v76, 16, v44
    v_and_b32 v77, v96, v44
    v_lshlrev_b32 v78, 16, v45
    v_and_b32 v79, v96, v45
    v_add_f32 v12, v12, v76
    v_add_f32 v13, v13, v77
    v_add_f32 v14, v14, v78
    v_add_f32 v15, v15, v79
    v_cvt_pk_bf16_f32 v80, v12, v13
    v_cvt_pk_bf16_f32 v81, v14, v15
    v_mov_b32 v70, v12
    v_mul_f32 v72, v12, v12
    v_mov_b32 v71, v13
    v_mul_f32 v73, v13, v13
    v_add_f32 v70, v70, v14
    v_fmac_f32 v72, v14, v14
    v_add_f32 v71, v71, v15
    v_fmac_f32 v73, v15, v15
    v_lshlrev_b32 v76, 16, v46
    v_and_b32 v77, v96, v46
    v_lshlrev_b32 v78, 16, v47
    v_and_b32 v79, v96, v47
    v_add_f32 v20, v20, v76
    v_add_f32 v21, v21, v77
    v_add_f32 v22, v22, v78
    v_add_f32 v23, v23, v79
    v_cvt_pk_bf16_f32 v82, v20, v21
    v_cvt_pk_bf16_f32 v83, v22, v23
    v_add_f32 v70, v70, v20
    v_fmac_f32 v72, v20, v20
    v_add_f32 v71, v71, v21
    v_fmac_f32 v73, v21, v21
    v_add_f32 v70, v70, v22
    v_fmac_f32 v72, v22, v22
    v_add_f32 v71, v71, v23
    v_fmac_f32 v73, v23, v23
    v_lshlrev_b32 v76, 16, v48
    v_and_b32 v77, v96, v48
    v_lshlrev_b32 v78, 16, v49
    v_and_b32 v79, v96, v49
    v_add_f32 v28, v28, v76
    v_add_f32 v29, v29, v77
    v_add_f32 v30, v30, v78
    v_add_f32 v31, v31, v79
    v_cvt_pk_bf16_f32 v84, v28, v29
    v_cvt_pk_bf16_f32 v85, v30, v31
    v_add_f32 v70, v70, v28
    v_fmac_f32 v72, v28, v28
    v_add_f32 v71, v71, v29
    v_fmac_f32 v73, v29, v29
    v_add_f32 v70, v70, v30
    v_fmac_f32 v72, v30, v30
    v_add_f32 v71, v71, v31
    v_fmac_f32 v73, v31, v31
    v_lshlrev_b32 v76, 16, v50
    v_and_b32 v77, v96, v50
    v_lshlrev_b32 v78, 16, v51
    v_and_b32 v79, v96, v51
    v_add_f32 v36, v36, v76
    v_add_f32 v37, v37, v77
    v_add_f32 v38, v38, v78
    v_add_f32 v39, v39, v79
    v_cvt_pk_bf16_f32 v86, v36, v37
    v_cvt_pk_bf16_f32 v87, v38, v39
    v_add_f32 v70, v70, v36
    v_fmac_f32 v72, v36, v36
    v_add_f32 v71, v71, v37
    v_fmac_f32 v73, v37, v37
    v_add_f32 v70, v70, v38
    v_fmac_f32 v72, v38, v38
    v_add_f32 v71, v71, v39
    v_fmac_f32 v73, v39, v39
    v_add_f32 v66, v70, v71
    v_add_f32 v67, v72, v73
    v_permlane16_swap_b32 v80, v82
    v_permlane16_swap_b32 v81, v83
    s_add_u32 s38, s37, 0
    buffer_store_dwordx4 v[80:83], v64, s[16:19], s38 offen offset:0 sc1
    v_permlane16_swap_b32 v84, v86
    v_permlane16_swap_b32 v85, v87
    s_add_u32 s38, s37, 0
    buffer_store_dwordx4 v[84:87], v64, s[16:19], s38 offen offset:64 sc1
    v_lshlrev_b32 v76, 16, v52
    v_and_b32 v77, v96, v52
    v_lshlrev_b32 v78, 16, v53
    v_and_b32 v79, v96, v53
    v_add_f32 v16, v16, v76
    v_add_f32 v17, v17, v77
    v_add_f32 v18, v18, v78
    v_add_f32 v19, v19, v79
    v_cvt_pk_bf16_f32 v88, v16, v17
    v_cvt_pk_bf16_f32 v89, v18, v19
    v_mov_b32 v70, v16
    v_mul_f32 v72, v16, v16
    v_mov_b32 v71, v17
    v_mul_f32 v73, v17, v17
    v_add_f32 v70, v70, v18
    v_fmac_f32 v72, v18, v18
    v_add_f32 v71, v71, v19
    v_fmac_f32 v73, v19, v19
    v_lshlrev_b32 v76, 16, v54
    v_and_b32 v77, v96, v54
    v_lshlrev_b32 v78, 16, v55
    v_and_b32 v79, v96, v55
    v_add_f32 v24, v24, v76
    v_add_f32 v25, v25, v77
    v_add_f32 v26, v26, v78
    v_add_f32 v27, v27, v79
    v_cvt_pk_bf16_f32 v90, v24, v25
    v_cvt_pk_bf16_f32 v91, v26, v27
    v_add_f32 v70, v70, v24
    v_fmac_f32 v72, v24, v24
    v_add_f32 v71, v71, v25
    v_fmac_f32 v73, v25, v25
    v_add_f32 v70, v70, v26
    v_fmac_f32 v72, v26, v26
    v_add_f32 v71, v71, v27
    v_fmac_f32 v73, v27, v27
    v_lshlrev_b32 v76, 16, v56
    v_and_b32 v77, v96, v56
    v_lshlrev_b32 v78, 16, v57
    v_and_b32 v79, v96, v57
    v_add_f32 v32, v32, v76
    v_add_f32 v33, v33, v77
    v_add_f32 v34, v34, v78
    v_add_f32 v35, v35, v79
    v_cvt_pk_bf16_f32 v92, v32, v33
    v_cvt_pk_bf16_f32 v93, v34, v35
    v_add_f32 v70, v70, v32
    v_fmac_f32 v72, v32, v32
    v_add_f32 v71, v71, v33
    v_fmac_f32 v73, v33, v33
    v_add_f32 v70, v70, v34
    v_fmac_f32 v72, v34, v34
    v_add_f32 v71, v71, v35
    v_fmac_f32 v73, v35, v35
    v_lshlrev_b32 v76, 16, v58
    v_and_b32 v77, v96, v58
    v_lshlrev_b32 v78, 16, v59
    v_and_b32 v79, v96, v59
    v_add_f32 v40, v40, v76
    v_add_f32 v41, v41, v77
    v_add_f32 v42, v42, v78
    v_add_f32 v43, v43, v79
    v_cvt_pk_bf16_f32 v94, v40, v41
    v_cvt_pk_bf16_f32 v95, v42, v43
    v_add_f32 v70, v70, v40
    v_fmac_f32 v72, v40, v40
    v_add_f32 v71, v71, v41
    v_fmac_f32 v73, v41, v41
    v_add_f32 v70, v70, v42
    v_fmac_f32 v72, v42, v42
    v_add_f32 v71, v71, v43
    v_fmac_f32 v73, v43, v43
    v_add_f32 v68, v70, v71
    v_add_f32 v69, v72, v73
    v_permlane16_swap_b32 v88, v90
    v_permlane16_swap_b32 v89, v91
    s_add_u32 s38, s37, 32768
    buffer_store_dwordx4 v[88:91], v64, s[16:19], s38 offen offset:0 sc1
    v_permlane16_swap_b32 v92, v94
    v_permlane16_swap_b32 v93, v95
    s_add_u32 s38, s37, 32768
    buffer_store_dwordx4 v[92:95], v64, s[16:19], s38 offen offset:64 sc1
    v_mov_b32 v76, v66
    v_mov_b32 v77, v67
    v_mov_b32 v78, v68
    v_mov_b32 v79, v69
    v_permlane16_swap_b32 v76, v66
    v_permlane16_swap_b32 v77, v67
    v_permlane16_swap_b32 v78, v68
    v_permlane16_swap_b32 v79, v69
    v_add_f32 v66, v66, v76
    v_add_f32 v67, v67, v77
    v_add_f32 v68, v68, v78
    v_add_f32 v69, v69, v79
    v_mov_b32 v76, v66
    v_mov_b32 v77, v67
    v_mov_b32 v78, v68
    v_mov_b32 v79, v69
    v_permlane32_swap_b32 v76, v66
    v_permlane32_swap_b32 v77, v67
    v_permlane32_swap_b32 v78, v68
    v_permlane32_swap_b32 v79, v69
    v_add_f32 v66, v66, v76
    v_add_f32 v67, v67, v77
    v_add_f32 v68, v68, v78
    v_add_f32 v69, v69, v79
    v_cmp_le_u32 vcc, 16, v1
    s_nop 1
    v_cndmask_b32 v66, v66, v68, vcc
    v_cndmask_b32 v67, v67, v69, vcc
    v_lshlrev_b32 v2, 3, v1
    s_lshl_b32 s37, s69, 3
    s_lshl_b32 s38, s5, 14
    s_add_u32 s37, s37, s38
    s_mov_b32 exec_hi, 0
    buffer_store_dwordx2 v[66:67], v2, s[24:27], s37 offen sc1
    s_mov_b64 exec, -1
    s_barrier
    s_waitcnt vmcnt(0)
    v_mov_b32 v2, 1
    v_mov_b32 v3, 155648
    s_mov_b64 exec, 1
    ds_add_rtn_u32 v3, v3, v2
    s_waitcnt lgkmcnt(0)
    v_readfirstlane_b32 s68, v3
    s_nop 0
    s_and_b32 s68, s68, 3
    s_cmp_eq_u32 s68, 3
    s_cbranch_scc0 L_nf_31
    s_lshl_b32 s67, s4, 12
    s_add_u32 s67, s67, 458752
    s_lshl_b32 s68, s5, 7
    s_add_u32 s67, s67, s68
    v_mov_b32 v3, 0
    buffer_store_dword v2, v3, s[88:91], s67 offen sc1
L_nf_31:
    s_mov_b64 exec, -1
    s_and_b32 s37, s2, 1
    s_lshl_b32 s37, s37, 3
    s_bfe_u32 s38, s2, 0x30003
    s_add_u32 s4, s37, s38
    s_bfe_u32 s37, s2, 0x20001
    s_lshl_b32 s37, s37, 2
    s_lshr_b32 s38, s2, 6
    s_add_u32 s5, s37, s38
    v_and_b32 v1, 63, v0
    s_lshr_b32 s6, s3, 1
    s_and_b32 s7, s3, 1
    s_mul_i32 s39, s6, 8192
    v_and_b32 v2, 15, v1
    v_lshrrev_b32 v3, 1, v2
    v_lshlrev_b32 v2, 7, v2
    v_add_u32 v2, s39, v2
    v_lshrrev_b32 v4, 4, v1
    v_xor_b32 v3, v3, v4
    v_lshl_add_u32 v4, v3, 4, v2
    v_xor_b32 v5, 64, v4
    v_lshrrev_b32 v2, 4, v1
    v_lshlrev_b32 v2, 3, v2
    v_bfe_u32 v3, v1, 2, 2
    v_add_u32 v124, v2, v3
    v_bfe_u32 v125, v1, 3, 1
    v_lshlrev_b32 v125, 1, v125
    v_bfe_u32 v3, v1, 4, 1
    v_lshl_add_u32 v125, v3, 2, v125
    v_bfe_u32 v3, v1, 1, 1
    s_lshl_b32 s39, s7, 2
    s_add_u32 s39, s39, 0
    v_add_u32 v3, s39, v3
    v_xor_b32 v3, v3, v125
    v_lshlrev_b32 v3, 4, v3
    v_lshl_add_u32 v3, v124, 7, v3
    v_and_b32 v2, 1, v1
    v_lshl_add_u32 v3, v2, 3, v3
    v_add_u32 v6, 16384, v3
    v_bfe_u32 v3, v1, 1, 1
    s_lshl_b32 s39, s7, 2
    s_add_u32 s39, s39, 2
    v_add_u32 v3, s39, v3
    v_xor_b32 v3, v3, v125
    v_lshlrev_b32 v3, 4, v3
    v_lshl_add_u32 v3, v124, 7, v3
    v_and_b32 v2, 1, v1
    v_lshl_add_u32 v3, v2, 3, v3
    v_add_u32 v7, 16384, v3
    v_bfe_u32 v3, v1, 1, 1
    s_lshl_b32 s39, s7, 1
    v_add_u32 v3, s39, v3
    v_bfe_u32 v2, v1, 4, 1
    v_lshlrev_b32 v2, 1, v2
    v_xor_b32 v3, v3, v2
    v_lshlrev_b32 v3, 4, v3
    v_lshl_add_u32 v3, v124, 6, v3
    v_and_b32 v2, 1, v1
    v_lshl_add_u32 v3, v2, 3, v3
    v_add_u32 v8, 40960, v3
    v_mov_b32 v12, 0
    v_mov_b32 v13, 0
    v_mov_b32 v14, 0
    v_mov_b32 v15, 0
    v_mov_b32 v16, 0
    v_mov_b32 v17, 0
    v_mov_b32 v18, 0
    v_mov_b32 v19, 0
    v_mov_b32 v20, 0
    v_mov_b32 v21, 0
    v_mov_b32 v22, 0
    v_mov_b32 v23, 0
    v_mov_b32 v24, 0
    v_mov_b32 v25, 0
    v_mov_b32 v26, 0
    v_mov_b32 v27, 0
    v_mov_b32 v28, 0
    v_mov_b32 v29, 0
    v_mov_b32 v30, 0
    v_mov_b32 v31, 0
    v_mov_b32 v32, 0
    v_mov_b32 v33, 0
    v_mov_b32 v34, 0
    v_mov_b32 v35, 0
    v_mov_b32 v36, 0
    v_mov_b32 v37, 0
    v_mov_b32 v38, 0
    v_mov_b32 v39, 0
    v_mov_b32 v40, 0
    v_mov_b32 v41, 0
    v_mov_b32 v42, 0
    v_mov_b32 v43, 0
    v_mov_b32 v44, 0
    v_mov_b32 v45, 0
    v_mov_b32 v46, 0
    v_mov_b32 v47, 0
    v_mov_b32 v48, 0
    v_mov_b32 v49, 0
    v_mov_b32 v50, 0
    v_mov_b32 v51, 0
    v_mov_b32 v52, 0
    v_mov_b32 v53, 0
    v_mov_b32 v54, 0
    v_mov_b32 v55, 0
    v_mov_b32 v56, 0
    v_mov_b32 v57, 0
    v_mov_b32 v58, 0
    v_mov_b32 v59, 0
    v_mov_b32 v60, 0
    v_mov_b32 v61, 0
    v_mov_b32 v62, 0
    v_mov_b32 v63, 0
    v_mov_b32 v64, 0
    v_mov_b32 v65, 0
    v_mov_b32 v66, 0
    v_mov_b32 v67, 0
    v_mov_b32 v68, 0
    v_mov_b32 v69, 0
    v_mov_b32 v70, 0
    v_mov_b32 v71, 0
    v_mov_b32 v72, 0
    v_mov_b32 v73, 0
    v_mov_b32 v74, 0
    v_mov_b32 v75, 0
    v_mov_b32 v76, 0
    v_mov_b32 v77, 0
    v_mov_b32 v78, 0
    v_mov_b32 v79, 0
    v_mov_b32 v80, 0
    v_mov_b32 v81, 0
    v_mov_b32 v82, 0
    v_mov_b32 v83, 0
    v_mov_b32 v84, 0
    v_mov_b32 v85, 0
    v_mov_b32 v86, 0
    v_mov_b32 v87, 0
    v_mov_b32 v88, 0
    v_mov_b32 v89, 0
    v_mov_b32 v90, 0
    v_mov_b32 v91, 0
    v_mov_b32 v92, 0
    v_mov_b32 v93, 0
    v_mov_b32 v94, 0
    v_mov_b32 v95, 0
    v_mov_b32 v96, 0
    v_mov_b32 v97, 0
    v_mov_b32 v98, 0
    v_mov_b32 v99, 0
    v_mov_b32 v100, 0
    v_mov_b32 v101, 0
    v_mov_b32 v102, 0
    v_mov_b32 v103, 0
    v_mov_b32 v104, 0
    v_mov_b32 v105, 0
    v_mov_b32 v106, 0
    v_mov_b32 v107, 0
    v_mov_b32 v108, 0
    v_mov_b32 v109, 0
    v_mov_b32 v110, 0
    v_mov_b32 v111, 0
    v_mov_b32 v112, 0
    v_mov_b32 v113, 0
    v_mov_b32 v114, 0
    v_mov_b32 v115, 0
    v_mov_b32 v116, 0
    v_mov_b32 v117, 0
    v_mov_b32 v118, 0
    v_mov_b32 v119, 0
    v_mov_b32 v120, 0
    v_mov_b32 v121, 0
    v_mov_b32 v122, 0
    v_mov_b32 v123, 0
    s_waitcnt lgkmcnt(0)
    s_barrier
    s_mov_b32 s34, 0
    s_mov_b32 s46, -90112
    s_mov_b32 s47, 45056
    s_setprio 2
    s_barrier
    ds_read_b128 v[124:127], v4 offset:0
    ds_read_b64_tr_b16 v[156:157], v6 offset:0
    ds_read_b64_tr_b16 v[158:159], v6 offset:512
    ds_read_b128 v[128:131], v4 offset:2048
    ds_read_b128 v[132:135], v4 offset:4096
    ds_read_b128 v[136:139], v4 offset:6144
    ds_read_b64_tr_b16 v[160:161], v7 offset:0
    ds_read_b64_tr_b16 v[162:163], v7 offset:512
    ds_read_b64_tr_b16 v[164:165], v6 offset:8192
    ds_read_b64_tr_b16 v[166:167], v6 offset:8704
    ds_read_b64_tr_b16 v[168:169], v7 offset:8192
    ds_read_b64_tr_b16 v[170:171], v7 offset:8704
    ds_read_b64_tr_b16 v[172:173], v6 offset:16384
    ds_read_b64_tr_b16 v[174:175], v6 offset:16896
    ds_read_b64_tr_b16 v[176:177], v7 offset:16384
    ds_read_b64_tr_b16 v[178:179], v7 offset:16896
    ds_read_b64_tr_b16 v[180:181], v8 offset:0
    ds_read_b64_tr_b16 v[182:183], v8 offset:256
    s_mov_b32 s35, 15
    s_waitcnt lgkmcnt(0)
.p2align 6
L_cl_32:
    v_mfma_f32_16x16x32_bf16 v[12:15], v[156:159], v[124:127], v[12:15]
    ds_read_b128 v[140:143], v5 offset:0
    v_mfma_f32_16x16x32_bf16 v[16:19], v[156:159], v[128:131], v[16:19]
    ds_read_b64_tr_b16 v[184:185], v6 offset:4096
    v_mfma_f32_16x16x32_bf16 v[20:23], v[156:159], v[132:135], v[20:23]
    ds_read_b64_tr_b16 v[186:187], v6 offset:4608
    v_mfma_f32_16x16x32_bf16 v[24:27], v[156:159], v[136:139], v[24:27]
    ds_read_b128 v[144:147], v5 offset:2048
    v_mfma_f32_16x16x32_bf16 v[28:31], v[160:163], v[124:127], v[28:31]
    ds_read_b128 v[148:151], v5 offset:4096
    v_mfma_f32_16x16x32_bf16 v[32:35], v[160:163], v[128:131], v[32:35]
    ds_read_b128 v[152:155], v5 offset:6144
    v_mfma_f32_16x16x32_bf16 v[36:39], v[160:163], v[132:135], v[36:39]
    ds_read_b64_tr_b16 v[188:189], v7 offset:4096
    v_mfma_f32_16x16x32_bf16 v[40:43], v[160:163], v[136:139], v[40:43]
    ds_read_b64_tr_b16 v[190:191], v7 offset:4608
    v_mfma_f32_16x16x32_bf16 v[44:47], v[164:167], v[124:127], v[44:47]
    ds_read_b64_tr_b16 v[192:193], v6 offset:12288
    v_mfma_f32_16x16x32_bf16 v[48:51], v[164:167], v[128:131], v[48:51]
    ds_read_b64_tr_b16 v[194:195], v6 offset:12800
    v_mfma_f32_16x16x32_bf16 v[52:55], v[164:167], v[132:135], v[52:55]
    ds_read_b64_tr_b16 v[196:197], v7 offset:12288
    v_mfma_f32_16x16x32_bf16 v[56:59], v[164:167], v[136:139], v[56:59]
    ds_read_b64_tr_b16 v[198:199], v7 offset:12800
    v_mfma_f32_16x16x32_bf16 v[60:63], v[168:171], v[124:127], v[60:63]
    ds_read_b64_tr_b16 v[200:201], v6 offset:20480
    v_mfma_f32_16x16x32_bf16 v[64:67], v[168:171], v[128:131], v[64:67]
    ds_read_b64_tr_b16 v[202:203], v6 offset:20992
    v_mfma_f32_16x16x32_bf16 v[68:71], v[168:171], v[132:135], v[68:71]
    ds_read_b64_tr_b16 v[204:205], v7 offset:20480
    v_mfma_f32_16x16x32_bf16 v[72:75], v[168:171], v[136:139], v[72:75]
    ds_read_b64_tr_b16 v[206:207], v7 offset:20992
    v_mfma_f32_16x16x32_bf16 v[76:79], v[172:175], v[124:127], v[76:79]
    ds_read_b64_tr_b16 v[208:209], v8 offset:2048
    v_mfma_f32_16x16x32_bf16 v[80:83], v[172:175], v[128:131], v[80:83]
    ds_read_b64_tr_b16 v[210:211], v8 offset:2304
    v_mfma_f32_16x16x32_bf16 v[84:87], v[172:175], v[132:135], v[84:87]
    s_add_u32 s34, s34, 45056
    v_mfma_f32_16x16x32_bf16 v[88:91], v[172:175], v[136:139], v[88:91]
    s_cmp_eq_u32 s34, 135168
    v_mfma_f32_16x16x32_bf16 v[92:95], v[176:179], v[124:127], v[92:95]
    s_cselect_b32 s36, s46, s47
    v_mfma_f32_16x16x32_bf16 v[96:99], v[176:179], v[128:131], v[96:99]
    s_cselect_b32 s34, 0, s34
    v_mfma_f32_16x16x32_bf16 v[100:103], v[176:179], v[132:135], v[100:103]
    v_add_u32 v4, s36, v4
    v_mfma_f32_16x16x32_bf16 v[104:107], v[176:179], v[136:139], v[104:107]
    v_add_u32 v5, s36, v5
    v_mfma_f32_16x16x32_bf16 v[108:111], v[180:183], v[124:127], v[108:111]
    v_add_u32 v6, s36, v6
    v_mfma_f32_16x16x32_bf16 v[112:115], v[180:183], v[128:131], v[112:115]
    v_add_u32 v7, s36, v7
    v_mfma_f32_16x16x32_bf16 v[116:119], v[180:183], v[132:135], v[116:119]
    v_add_u32 v8, s36, v8
    v_mfma_f32_16x16x32_bf16 v[120:123], v[180:183], v[136:139], v[120:123]
    s_waitcnt lgkmcnt(0)
    s_barrier
    v_mfma_f32_16x16x32_bf16 v[12:15], v[184:187], v[140:143], v[12:15]
    ds_read_b128 v[124:127], v4 offset:0
    v_mfma_f32_16x16x32_bf16 v[16:19], v[184:187], v[144:147], v[16:19]
    ds_read_b64_tr_b16 v[156:157], v6 offset:0
    v_mfma_f32_16x16x32_bf16 v[20:23], v[184:187], v[148:151], v[20:23]
    ds_read_b64_tr_b16 v[158:159], v6 offset:512
    v_mfma_f32_16x16x32_bf16 v[24:27], v[184:187], v[152:155], v[24:27]
    ds_read_b128 v[128:131], v4 offset:2048
    v_mfma_f32_16x16x32_bf16 v[28:31], v[188:191], v[140:143], v[28:31]
    ds_read_b128 v[132:135], v4 offset:4096
    v_mfma_f32_16x16x32_bf16 v[32:35], v[188:191], v[144:147], v[32:35]
    ds_read_b128 v[136:139], v4 offset:6144
    v_mfma_f32_16x16x32_bf16 v[36:39], v[188:191], v[148:151], v[36:39]
    ds_read_b64_tr_b16 v[160:161], v7 offset:0
    v_mfma_f32_16x16x32_bf16 v[40:43], v[188:191], v[152:155], v[40:43]
    ds_read_b64_tr_b16 v[162:163], v7 offset:512
    v_mfma_f32_16x16x32_bf16 v[44:47], v[192:195], v[140:143], v[44:47]
    ds_read_b64_tr_b16 v[164:165], v6 offset:8192
    v_mfma_f32_16x16x32_bf16 v[48:51], v[192:195], v[144:147], v[48:51]
    ds_read_b64_tr_b16 v[166:167], v6 offset:8704
    v_mfma_f32_16x16x32_bf16 v[52:55], v[192:195], v[148:151], v[52:55]
    ds_read_b64_tr_b16 v[168:169], v7 offset:8192
    v_mfma_f32_16x16x32_bf16 v[56:59], v[192:195], v[152:155], v[56:59]
    ds_read_b64_tr_b16 v[170:171], v7 offset:8704
    v_mfma_f32_16x16x32_bf16 v[60:63], v[196:199], v[140:143], v[60:63]
    ds_read_b64_tr_b16 v[172:173], v6 offset:16384
    v_mfma_f32_16x16x32_bf16 v[64:67], v[196:199], v[144:147], v[64:67]
    ds_read_b64_tr_b16 v[174:175], v6 offset:16896
    v_mfma_f32_16x16x32_bf16 v[68:71], v[196:199], v[148:151], v[68:71]
    ds_read_b64_tr_b16 v[176:177], v7 offset:16384
    v_mfma_f32_16x16x32_bf16 v[72:75], v[196:199], v[152:155], v[72:75]
    ds_read_b64_tr_b16 v[178:179], v7 offset:16896
    v_mfma_f32_16x16x32_bf16 v[76:79], v[200:203], v[140:143], v[76:79]
    ds_read_b64_tr_b16 v[180:181], v8 offset:0
    v_mfma_f32_16x16x32_bf16 v[80:83], v[200:203], v[144:147], v[80:83]
    ds_read_b64_tr_b16 v[182:183], v8 offset:256
    v_mfma_f32_16x16x32_bf16 v[84:87], v[200:203], v[148:151], v[84:87]
    v_mfma_f32_16x16x32_bf16 v[88:91], v[200:203], v[152:155], v[88:91]
    v_mfma_f32_16x16x32_bf16 v[92:95], v[204:207], v[140:143], v[92:95]
    v_mfma_f32_16x16x32_bf16 v[96:99], v[204:207], v[144:147], v[96:99]
    v_mfma_f32_16x16x32_bf16 v[100:103], v[204:207], v[148:151], v[100:103]
    v_mfma_f32_16x16x32_bf16 v[104:107], v[204:207], v[152:155], v[104:107]
    v_mfma_f32_16x16x32_bf16 v[108:111], v[208:211], v[140:143], v[108:111]
    v_mfma_f32_16x16x32_bf16 v[112:115], v[208:211], v[144:147], v[112:115]
    v_mfma_f32_16x16x32_bf16 v[116:119], v[208:211], v[148:151], v[116:119]
    v_mfma_f32_16x16x32_bf16 v[120:123], v[208:211], v[152:155], v[120:123]
    s_sub_u32 s35, s35, 1
    s_cmp_lg_u32 s35, 0
    s_waitcnt lgkmcnt(0)
    s_cbranch_scc1 L_cl_32
    v_mfma_f32_16x16x32_bf16 v[12:15], v[156:159], v[124:127], v[12:15]
    ds_read_b128 v[140:143], v5 offset:0
    v_mfma_f32_16x16x32_bf16 v[16:19], v[156:159], v[128:131], v[16:19]
    ds_read_b64_tr_b16 v[184:185], v6 offset:4096
    v_mfma_f32_16x16x32_bf16 v[20:23], v[156:159], v[132:135], v[20:23]
    ds_read_b64_tr_b16 v[186:187], v6 offset:4608
    v_mfma_f32_16x16x32_bf16 v[24:27], v[156:159], v[136:139], v[24:27]
    ds_read_b128 v[144:147], v5 offset:2048
    v_mfma_f32_16x16x32_bf16 v[28:31], v[160:163], v[124:127], v[28:31]
    ds_read_b128 v[148:151], v5 offset:4096
    v_mfma_f32_16x16x32_bf16 v[32:35], v[160:163], v[128:131], v[32:35]
    ds_read_b128 v[152:155], v5 offset:6144
    v_mfma_f32_16x16x32_bf16 v[36:39], v[160:163], v[132:135], v[36:39]
    ds_read_b64_tr_b16 v[188:189], v7 offset:4096
    v_mfma_f32_16x16x32_bf16 v[40:43], v[160:163], v[136:139], v[40:43]
    ds_read_b64_tr_b16 v[190:191], v7 offset:4608
    v_mfma_f32_16x16x32_bf16 v[44:47], v[164:167], v[124:127], v[44:47]
    ds_read_b64_tr_b16 v[192:193], v6 offset:12288
    v_mfma_f32_16x16x32_bf16 v[48:51], v[164:167], v[128:131], v[48:51]
    ds_read_b64_tr_b16 v[194:195], v6 offset:12800
    v_mfma_f32_16x16x32_bf16 v[52:55], v[164:167], v[132:135], v[52:55]
    ds_read_b64_tr_b16 v[196:197], v7 offset:12288
    v_mfma_f32_16x16x32_bf16 v[56:59], v[164:167], v[136:139], v[56:59]
    ds_read_b64_tr_b16 v[198:199], v7 offset:12800
    v_mfma_f32_16x16x32_bf16 v[60:63], v[168:171], v[124:127], v[60:63]
    ds_read_b64_tr_b16 v[200:201], v6 offset:20480
    v_mfma_f32_16x16x32_bf16 v[64:67], v[168:171], v[128:131], v[64:67]
    ds_read_b64_tr_b16 v[202:203], v6 offset:20992
    v_mfma_f32_16x16x32_bf16 v[68:71], v[168:171], v[132:135], v[68:71]
    ds_read_b64_tr_b16 v[204:205], v7 offset:20480
    v_mfma_f32_16x16x32_bf16 v[72:75], v[168:171], v[136:139], v[72:75]
    ds_read_b64_tr_b16 v[206:207], v7 offset:20992
    v_mfma_f32_16x16x32_bf16 v[76:79], v[172:175], v[124:127], v[76:79]
    ds_read_b64_tr_b16 v[208:209], v8 offset:2048
    v_mfma_f32_16x16x32_bf16 v[80:83], v[172:175], v[128:131], v[80:83]
    ds_read_b64_tr_b16 v[210:211], v8 offset:2304
    v_mfma_f32_16x16x32_bf16 v[84:87], v[172:175], v[132:135], v[84:87]
    v_mfma_f32_16x16x32_bf16 v[88:91], v[172:175], v[136:139], v[88:91]
    v_mfma_f32_16x16x32_bf16 v[92:95], v[176:179], v[124:127], v[92:95]
    v_mfma_f32_16x16x32_bf16 v[96:99], v[176:179], v[128:131], v[96:99]
    v_mfma_f32_16x16x32_bf16 v[100:103], v[176:179], v[132:135], v[100:103]
    v_mfma_f32_16x16x32_bf16 v[104:107], v[176:179], v[136:139], v[104:107]
    v_mfma_f32_16x16x32_bf16 v[108:111], v[180:183], v[124:127], v[108:111]
    v_mfma_f32_16x16x32_bf16 v[112:115], v[180:183], v[128:131], v[112:115]
    v_mfma_f32_16x16x32_bf16 v[116:119], v[180:183], v[132:135], v[116:119]
    v_mfma_f32_16x16x32_bf16 v[120:123], v[180:183], v[136:139], v[120:123]
    s_waitcnt lgkmcnt(0)
    s_barrier
    v_mfma_f32_16x16x32_bf16 v[12:15], v[184:187], v[140:143], v[12:15]
    v_mfma_f32_16x16x32_bf16 v[16:19], v[184:187], v[144:147], v[16:19]
    v_mfma_f32_16x16x32_bf16 v[20:23], v[184:187], v[148:151], v[20:23]
    v_mfma_f32_16x16x32_bf16 v[24:27], v[184:187], v[152:155], v[24:27]
    v_mfma_f32_16x16x32_bf16 v[28:31], v[188:191], v[140:143], v[28:31]
    v_mfma_f32_16x16x32_bf16 v[32:35], v[188:191], v[144:147], v[32:35]
    v_mfma_f32_16x16x32_bf16 v[36:39], v[188:191], v[148:151], v[36:39]
    v_mfma_f32_16x16x32_bf16 v[40:43], v[188:191], v[152:155], v[40:43]
    v_mfma_f32_16x16x32_bf16 v[44:47], v[192:195], v[140:143], v[44:47]
    v_mfma_f32_16x16x32_bf16 v[48:51], v[192:195], v[144:147], v[48:51]
    v_mfma_f32_16x16x32_bf16 v[52:55], v[192:195], v[148:151], v[52:55]
    v_mfma_f32_16x16x32_bf16 v[56:59], v[192:195], v[152:155], v[56:59]
    v_mfma_f32_16x16x32_bf16 v[60:63], v[196:199], v[140:143], v[60:63]
    v_mfma_f32_16x16x32_bf16 v[64:67], v[196:199], v[144:147], v[64:67]
    v_mfma_f32_16x16x32_bf16 v[68:71], v[196:199], v[148:151], v[68:71]
    v_mfma_f32_16x16x32_bf16 v[72:75], v[196:199], v[152:155], v[72:75]
    v_mfma_f32_16x16x32_bf16 v[76:79], v[200:203], v[140:143], v[76:79]
    v_mfma_f32_16x16x32_bf16 v[80:83], v[200:203], v[144:147], v[80:83]
    v_mfma_f32_16x16x32_bf16 v[84:87], v[200:203], v[148:151], v[84:87]
    v_mfma_f32_16x16x32_bf16 v[88:91], v[200:203], v[152:155], v[88:91]
    v_mfma_f32_16x16x32_bf16 v[92:95], v[204:207], v[140:143], v[92:95]
    v_mfma_f32_16x16x32_bf16 v[96:99], v[204:207], v[144:147], v[96:99]
    v_mfma_f32_16x16x32_bf16 v[100:103], v[204:207], v[148:151], v[100:103]
    v_mfma_f32_16x16x32_bf16 v[104:107], v[204:207], v[152:155], v[104:107]
    v_mfma_f32_16x16x32_bf16 v[108:111], v[208:211], v[140:143], v[108:111]
    v_mfma_f32_16x16x32_bf16 v[112:115], v[208:211], v[144:147], v[112:115]
    v_mfma_f32_16x16x32_bf16 v[116:119], v[208:211], v[148:151], v[116:119]
    v_mfma_f32_16x16x32_bf16 v[120:123], v[208:211], v[152:155], v[120:123]
    s_setprio 0
    s_lshl_b32 s69, s6, 8
    s_add_u32 s69, s69, 151552
    v_and_b32 v188, 15, v1
    v_lshlrev_b32 v188, 2, v188
    v_add_u32 v188, s69, v188
    ds_read_b32 v124, v188 offset:0
    ds_read_b32 v128, v188 offset:512
    ds_read_b32 v132, v188 offset:1024
    ds_read_b32 v125, v188 offset:64
    ds_read_b32 v129, v188 offset:576
    ds_read_b32 v133, v188 offset:1088
    ds_read_b32 v126, v188 offset:128
    ds_read_b32 v130, v188 offset:640
    ds_read_b32 v134, v188 offset:1152
    ds_read_b32 v127, v188 offset:192
    ds_read_b32 v131, v188 offset:704
    ds_read_b32 v135, v188 offset:1216
    v_lshrrev_b32 v189, 4, v1
    v_lshlrev_b32 v189, 4, v189
    v_add_u32 v189, 154624, v189
    s_lshl_b32 s37, s7, 6
    v_add_u32 v191, s37, v189
    s_lshl_b32 s37, s7, 7
    v_add_u32 v189, s37, v189
    s_waitcnt lgkmcnt(0)
    ds_read_b128 v[136:139], v189 offset:0
    ds_read_b128 v[140:143], v189 offset:64
    ds_read_b128 v[144:147], v189 offset:256
    ds_read_b128 v[148:151], v189 offset:320
    ds_read_b128 v[152:155], v189 offset:512
    ds_read_b128 v[156:159], v189 offset:576
    ds_read_b128 v[160:163], v191 offset:768
    s_add_u32 s16, s64, 0x4200000
    s_addc_u32 s17, s65, 0
    s_mov_b32 s18, 0xe00000
    s_mov_b32 s19, 0x20000
    s_lshr_b32 s39, s5, 1
    s_mul_i32 s39, s39, 896
    s_and_b32 s66, s5, 1
    s_lshl_b32 s66, s66, 9
    s_add_u32 s39, s39, s66
    s_and_b32 s66, s5, 1
    s_mul_i32 s66, s66, -448
    s_add_u32 s66, s66, 384
    v_bfe_u32 v190, v1, 4, 1
    v_lshlrev_b32 v190, 5, v190
    v_bfe_u32 v2, v1, 5, 1
    v_lshl_add_u32 v190, v2, 4, v190
    v_and_b32 v2, 15, v1
    v_mul_u32_u24 v2, 7168, v2
    v_add_u32 v190, v190, v2
    s_lshl_b32 s37, s7, 6
    v_add_u32 v190, s37, v190
    v_lshrrev_b32 v191, 4, v1
    v_lshl_add_u32 v191, v191, 3, v2
    s_lshl_b32 s37, s7, 5
    s_add_u32 s37, s37, s66
    s_add_u32 s37, s37, s39
    v_add_u32 v191, s37, v191
    v_add_u32 v190, s39, v190
    s_lshl_b32 s37, s4, 7
    s_lshl_b32 s38, s6, 6
    s_add_u32 s37, s37, s38
    s_mul_i32 s37, s37, 7168
    s_waitcnt lgkmcnt(0)
    v_fmac_f32 v108, v124, v160
    v_fmac_f32 v109, v124, v161
    v_fmac_f32 v110, v124, v162
    v_fmac_f32 v111, v124, v163
    v_mul_f32 v164, v108, v128
    v_mul_f32 v165, v109, v128
    v_mul_f32 v166, v110, v128
    v_mul_f32 v167, v111, v128
    v_exp_f32 v164, v164
    v_exp_f32 v165, v165
    v_exp_f32 v166, v166
    v_exp_f32 v167, v167
    v_fma_f32 v164, v164, v132, v132
    v_fma_f32 v165, v165, v132, v132
    v_fma_f32 v166, v166, v132, v132
    v_fma_f32 v167, v167, v132, v132
    v_rcp_f32 v164, v164
    v_rcp_f32 v165, v165
    v_rcp_f32 v166, v166
    v_rcp_f32 v167, v167
    v_mul_f32 v108, v108, v164
    v_mul_f32 v109, v109, v165
    v_mul_f32 v110, v110, v166
    v_mul_f32 v111, v111, v167
    v_cvt_pk_bf16_f32 v192, v108, v109
    v_cvt_pk_bf16_f32 v193, v110, v111
    v_fmac_f32 v112, v125, v160
    v_fmac_f32 v113, v125, v161
    v_fmac_f32 v114, v125, v162
    v_fmac_f32 v115, v125, v163
    v_mul_f32 v168, v112, v129
    v_mul_f32 v169, v113, v129
    v_mul_f32 v170, v114, v129
    v_mul_f32 v171, v115, v129
    v_exp_f32 v168, v168
    v_exp_f32 v169, v169
    v_exp_f32 v170, v170
    v_exp_f32 v171, v171
    v_fma_f32 v168, v168, v133, v133
    v_fma_f32 v169, v169, v133, v133
    v_fma_f32 v170, v170, v133, v133
    v_fma_f32 v171, v171, v133, v133
    v_rcp_f32 v168, v168
    v_rcp_f32 v169, v169
    v_rcp_f32 v170, v170
    v_rcp_f32 v171, v171
    v_mul_f32 v112, v112, v168
    v_mul_f32 v113, v113, v169
    v_mul_f32 v114, v114, v170
    v_mul_f32 v115, v115, v171
    v_cvt_pk_bf16_f32 v194, v112, v113
    v_cvt_pk_bf16_f32 v195, v114, v115
    v_fmac_f32 v116, v126, v160
    v_fmac_f32 v117, v126, v161
    v_fmac_f32 v118, v126, v162
    v_fmac_f32 v119, v126, v163
    v_mul_f32 v208, v116, v130
    v_mul_f32 v209, v117, v130
    v_mul_f32 v210, v118, v130
    v_mul_f32 v211, v119, v130
    v_exp_f32 v208, v208
    v_exp_f32 v209, v209
    v_exp_f32 v210, v210
    v_exp_f32 v211, v211
    v_fma_f32 v208, v208, v134, v134
    v_fma_f32 v209, v209, v134, v134
    v_fma_f32 v210, v210, v134, v134
    v_fma_f32 v211, v211, v134, v134
    v_rcp_f32 v208, v208
    v_rcp_f32 v209, v209
    v_rcp_f32 v210, v210
    v_rcp_f32 v211, v211
    v_mul_f32 v116, v116, v208
    v_mul_f32 v117, v117, v209
    v_mul_f32 v118, v118, v210
    v_mul_f32 v119, v119, v211
    v_cvt_pk_bf16_f32 v196, v116, v117
    v_cvt_pk_bf16_f32 v197, v118, v119
    v_fmac_f32 v120, v127, v160
    v_fmac_f32 v121, v127, v161
    v_fmac_f32 v122, v127, v162
    v_fmac_f32 v123, v127, v163
    v_mul_f32 v164, v120, v131
    v_mul_f32 v165, v121, v131
    v_mul_f32 v166, v122, v131
    v_mul_f32 v167, v123, v131
    v_exp_f32 v164, v164
    v_exp_f32 v165, v165
    v_exp_f32 v166, v166
    v_exp_f32 v167, v167
    v_fma_f32 v164, v164, v135, v135
    v_fma_f32 v165, v165, v135, v135
    v_fma_f32 v166, v166, v135, v135
    v_fma_f32 v167, v167, v135, v135
    v_rcp_f32 v164, v164
    v_rcp_f32 v165, v165
    v_rcp_f32 v166, v166
    v_rcp_f32 v167, v167
    v_mul_f32 v120, v120, v164
    v_mul_f32 v121, v121, v165
    v_mul_f32 v122, v122, v166
    v_mul_f32 v123, v123, v167
    v_cvt_pk_bf16_f32 v198, v120, v121
    v_cvt_pk_bf16_f32 v199, v122, v123
    v_lshlrev_b32 v204, 4, v1
    s_lshl_b32 s38, s3, 10
    s_add_u32 s38, s38, 131072
    v_add_u32 v204, s38, v204
    s_cmp_eq_u32 s7, 0
    s_cbranch_scc0 L_g7a_33
    ds_write_b128 v204, v[196:199]
    s_branch L_g7b_34
L_g7a_33:
    ds_write_b128 v204, v[192:195]
L_g7b_34:
    v_fmac_f32 v12, v124, v136
    v_fmac_f32 v13, v124, v137
    v_fmac_f32 v14, v124, v138
    v_fmac_f32 v15, v124, v139
    v_fmac_f32 v28, v124, v140
    v_fmac_f32 v29, v124, v141
    v_fmac_f32 v30, v124, v142
    v_fmac_f32 v31, v124, v143
    v_mul_f32 v164, v12, v128
    v_mul_f32 v165, v13, v128
    v_mul_f32 v166, v14, v128
    v_mul_f32 v167, v15, v128
    v_mul_f32 v168, v28, v128
    v_mul_f32 v169, v29, v128
    v_mul_f32 v170, v30, v128
    v_mul_f32 v171, v31, v128
    v_exp_f32 v164, v164
    v_exp_f32 v165, v165
    v_exp_f32 v166, v166
    v_exp_f32 v167, v167
    v_exp_f32 v168, v168
    v_exp_f32 v169, v169
    v_exp_f32 v170, v170
    v_exp_f32 v171, v171
    v_fma_f32 v164, v164, v132, v132
    v_fma_f32 v165, v165, v132, v132
    v_fma_f32 v166, v166, v132, v132
    v_fma_f32 v167, v167, v132, v132
    v_fma_f32 v168, v168, v132, v132
    v_fma_f32 v169, v169, v132, v132
    v_fma_f32 v170, v170, v132, v132
    v_fma_f32 v171, v171, v132, v132
    v_rcp_f32 v164, v164
    v_rcp_f32 v165, v165
    v_rcp_f32 v166, v166
    v_rcp_f32 v167, v167
    v_rcp_f32 v168, v168
    v_rcp_f32 v169, v169
    v_rcp_f32 v170, v170
    v_rcp_f32 v171, v171
    v_mul_f32 v12, v12, v164
    v_mul_f32 v13, v13, v165
    v_mul_f32 v14, v14, v166
    v_mul_f32 v15, v15, v167
    v_mul_f32 v28, v28, v168
    v_mul_f32 v29, v29, v169
    v_mul_f32 v30, v30, v170
    v_mul_f32 v31, v31, v171
    v_cvt_pk_bf16_f32 v172, v12, v13
    v_cvt_pk_bf16_f32 v173, v14, v15
    v_cvt_pk_bf16_f32 v174, v28, v29
    v_cvt_pk_bf16_f32 v175, v30, v31
    s_nop 0
    v_permlane16_swap_b32 v172, v174
    v_permlane16_swap_b32 v173, v175
    s_add_u32 s38, s37, 0
    buffer_store_dwordx4 v[172:175], v190, s[16:19], s38 offen offset:0 sc1
    v_fmac_f32 v44, v124, v144
    v_fmac_f32 v45, v124, v145
    v_fmac_f32 v46, v124, v146
    v_fmac_f32 v47, v124, v147
    v_fmac_f32 v60, v124, v148
    v_fmac_f32 v61, v124, v149
    v_fmac_f32 v62, v124, v150
    v_fmac_f32 v63, v124, v151
    v_mul_f32 v212, v44, v128
    v_mul_f32 v213, v45, v128
    v_mul_f32 v214, v46, v128
    v_mul_f32 v215, v47, v128
    v_mul_f32 v216, v60, v128
    v_mul_f32 v217, v61, v128
    v_mul_f32 v218, v62, v128
    v_mul_f32 v219, v63, v128
    v_exp_f32 v212, v212
    v_exp_f32 v213, v213
    v_exp_f32 v214, v214
    v_exp_f32 v215, v215
    v_exp_f32 v216, v216
    v_exp_f32 v217, v217
    v_exp_f32 v218, v218
    v_exp_f32 v219, v219
    v_fma_f32 v212, v212, v132, v132
    v_fma_f32 v213, v213, v132, v132
    v_fma_f32 v214, v214, v132, v132
    v_fma_f32 v215, v215, v132, v132
    v_fma_f32 v216, v216, v132, v132
    v_fma_f32 v217, v217, v132, v132
    v_fma_f32 v218, v218, v132, v132
    v_fma_f32 v219, v219, v132, v132
    v_rcp_f32 v212, v212
    v_rcp_f32 v213, v213
    v_rcp_f32 v214, v214
    v_rcp_f32 v215, v215
    v_rcp_f32 v216, v216
    v_rcp_f32 v217, v217
    v_rcp_f32 v218, v218
    v_rcp_f32 v219, v219
    v_mul_f32 v44, v44, v212
    v_mul_f32 v45, v45, v213
    v_mul_f32 v46, v46, v214
    v_mul_f32 v47, v47, v215
    v_mul_f32 v60, v60, v216
    v_mul_f32 v61, v61, v217
    v_mul_f32 v62, v62, v218
    v_mul_f32 v63, v63, v219
    v_cvt_pk_bf16_f32 v176, v44, v45
    v_cvt_pk_bf16_f32 v177, v46, v47
    v_cvt_pk_bf16_f32 v178, v60, v61
    v_cvt_pk_bf16_f32 v179, v62, v63
    s_nop 0
    v_permlane16_swap_b32 v176, v178
    v_permlane16_swap_b32 v177, v179
    buffer_store_dwordx4 v[176:179], v190, s[16:19], s38 offen offset:128 sc1
    v_fmac_f32 v76, v124, v152
    v_fmac_f32 v77, v124, v153
    v_fmac_f32 v78, v124, v154
    v_fmac_f32 v79, v124, v155
    v_fmac_f32 v92, v124, v156
    v_fmac_f32 v93, v124, v157
    v_fmac_f32 v94, v124, v158
    v_fmac_f32 v95, v124, v159
    v_mul_f32 v164, v76, v128
    v_mul_f32 v165, v77, v128
    v_mul_f32 v166, v78, v128
    v_mul_f32 v167, v79, v128
    v_mul_f32 v168, v92, v128
    v_mul_f32 v169, v93, v128
    v_mul_f32 v170, v94, v128
    v_mul_f32 v171, v95, v128
    v_exp_f32 v164, v164
    v_exp_f32 v165, v165
    v_exp_f32 v166, v166
    v_exp_f32 v167, v167
    v_exp_f32 v168, v168
    v_exp_f32 v169, v169
    v_exp_f32 v170, v170
    v_exp_f32 v171, v171
    v_fma_f32 v164, v164, v132, v132
    v_fma_f32 v165, v165, v132, v132
    v_fma_f32 v166, v166, v132, v132
    v_fma_f32 v167, v167, v132, v132
    v_fma_f32 v168, v168, v132, v132
    v_fma_f32 v169, v169, v132, v132
    v_fma_f32 v170, v170, v132, v132
    v_fma_f32 v171, v171, v132, v132
    v_rcp_f32 v164, v164
    v_rcp_f32 v165, v165
    v_rcp_f32 v166, v166
    v_rcp_f32 v167, v167
    v_rcp_f32 v168, v168
    v_rcp_f32 v169, v169
    v_rcp_f32 v170, v170
    v_rcp_f32 v171, v171
    v_mul_f32 v76, v76, v164
    v_mul_f32 v77, v77, v165
    v_mul_f32 v78, v78, v166
    v_mul_f32 v79, v79, v167
    v_mul_f32 v92, v92, v168
    v_mul_f32 v93, v93, v169
    v_mul_f32 v94, v94, v170
    v_mul_f32 v95, v95, v171
    v_cvt_pk_bf16_f32 v180, v76, v77
    v_cvt_pk_bf16_f32 v181, v78, v79
    v_cvt_pk_bf16_f32 v182, v92, v93
    v_cvt_pk_bf16_f32 v183, v94, v95
    s_nop 0
    v_permlane16_swap_b32 v180, v182
    v_permlane16_swap_b32 v181, v183
    buffer_store_dwordx4 v[180:183], v190, s[16:19], s38 offen offset:256 sc1
    v_fmac_f32 v16, v125, v136
    v_fmac_f32 v17, v125, v137
    v_fmac_f32 v18, v125, v138
    v_fmac_f32 v19, v125, v139
    v_fmac_f32 v32, v125, v140
    v_fmac_f32 v33, v125, v141
    v_fmac_f32 v34, v125, v142
    v_fmac_f32 v35, v125, v143
    v_mul_f32 v212, v16, v129
    v_mul_f32 v213, v17, v129
    v_mul_f32 v214, v18, v129
    v_mul_f32 v215, v19, v129
    v_mul_f32 v216, v32, v129
    v_mul_f32 v217, v33, v129
    v_mul_f32 v218, v34, v129
    v_mul_f32 v219, v35, v129
    v_exp_f32 v212, v212
    v_exp_f32 v213, v213
    v_exp_f32 v214, v214
    v_exp_f32 v215, v215
    v_exp_f32 v216, v216
    v_exp_f32 v217, v217
    v_exp_f32 v218, v218
    v_exp_f32 v219, v219
    v_fma_f32 v212, v212, v133, v133
    v_fma_f32 v213, v213, v133, v133
    v_fma_f32 v214, v214, v133, v133
    v_fma_f32 v215, v215, v133, v133
    v_fma_f32 v216, v216, v133, v133
    v_fma_f32 v217, v217, v133, v133
    v_fma_f32 v218, v218, v133, v133
    v_fma_f32 v219, v219, v133, v133
    v_rcp_f32 v212, v212
    v_rcp_f32 v213, v213
    v_rcp_f32 v214, v214
    v_rcp_f32 v215, v215
    v_rcp_f32 v216, v216
    v_rcp_f32 v217, v217
    v_rcp_f32 v218, v218
    v_rcp_f32 v219, v219
    v_mul_f32 v16, v16, v212
    v_mul_f32 v17, v17, v213
    v_mul_f32 v18, v18, v214
    v_mul_f32 v19, v19, v215
    v_mul_f32 v32, v32, v216
    v_mul_f32 v33, v33, v217
    v_mul_f32 v34, v34, v218
    v_mul_f32 v35, v35, v219
    v_cvt_pk_bf16_f32 v184, v16, v17
    v_cvt_pk_bf16_f32 v185, v18, v19
    v_cvt_pk_bf16_f32 v186, v32, v33
    v_cvt_pk_bf16_f32 v187, v34, v35
    s_nop 0
    v_permlane16_swap_b32 v184, v186
    v_permlane16_swap_b32 v185, v187
    s_add_u32 s38, s37, 114688
    buffer_store_dwordx4 v[184:187], v190, s[16:19], s38 offen offset:0 sc1
    v_fmac_f32 v48, v125, v144
    v_fmac_f32 v49, v125, v145
    v_fmac_f32 v50, v125, v146
    v_fmac_f32 v51, v125, v147
    v_fmac_f32 v64, v125, v148
    v_fmac_f32 v65, v125, v149
    v_fmac_f32 v66, v125, v150
    v_fmac_f32 v67, v125, v151
    v_mul_f32 v164, v48, v129
    v_mul_f32 v165, v49, v129
    v_mul_f32 v166, v50, v129
    v_mul_f32 v167, v51, v129
    v_mul_f32 v168, v64, v129
    v_mul_f32 v169, v65, v129
    v_mul_f32 v170, v66, v129
    v_mul_f32 v171, v67, v129
    v_exp_f32 v164, v164
    v_exp_f32 v165, v165
    v_exp_f32 v166, v166
    v_exp_f32 v167, v167
    v_exp_f32 v168, v168
    v_exp_f32 v169, v169
    v_exp_f32 v170, v170
    v_exp_f32 v171, v171
    v_fma_f32 v164, v164, v133, v133
    v_fma_f32 v165, v165, v133, v133
    v_fma_f32 v166, v166, v133, v133
    v_fma_f32 v167, v167, v133, v133
    v_fma_f32 v168, v168, v133, v133
    v_fma_f32 v169, v169, v133, v133
    v_fma_f32 v170, v170, v133, v133
    v_fma_f32 v171, v171, v133, v133
    v_rcp_f32 v164, v164
    v_rcp_f32 v165, v165
    v_rcp_f32 v166, v166
    v_rcp_f32 v167, v167
    v_rcp_f32 v168, v168
    v_rcp_f32 v169, v169
    v_rcp_f32 v170, v170
    v_rcp_f32 v171, v171
    v_mul_f32 v48, v48, v164
    v_mul_f32 v49, v49, v165
    v_mul_f32 v50, v50, v166
    v_mul_f32 v51, v51, v167
    v_mul_f32 v64, v64, v168
    v_mul_f32 v65, v65, v169
    v_mul_f32 v66, v66, v170
    v_mul_f32 v67, v67, v171
    v_cvt_pk_bf16_f32 v172, v48, v49
    v_cvt_pk_bf16_f32 v173, v50, v51
    v_cvt_pk_bf16_f32 v174, v64, v65
    v_cvt_pk_bf16_f32 v175, v66, v67
    s_nop 0
    v_permlane16_swap_b32 v172, v174
    v_permlane16_swap_b32 v173, v175
    buffer_store_dwordx4 v[172:175], v190, s[16:19], s38 offen offset:128 sc1
    v_fmac_f32 v80, v125, v152
    v_fmac_f32 v81, v125, v153
    v_fmac_f32 v82, v125, v154
    v_fmac_f32 v83, v125, v155
    v_fmac_f32 v96, v125, v156
    v_fmac_f32 v97, v125, v157
    v_fmac_f32 v98, v125, v158
    v_fmac_f32 v99, v125, v159
    v_mul_f32 v212, v80, v129
    v_mul_f32 v213, v81, v129
    v_mul_f32 v214, v82, v129
    v_mul_f32 v215, v83, v129
    v_mul_f32 v216, v96, v129
    v_mul_f32 v217, v97, v129
    v_mul_f32 v218, v98, v129
    v_mul_f32 v219, v99, v129
    v_exp_f32 v212, v212
    v_exp_f32 v213, v213
    v_exp_f32 v214, v214
    v_exp_f32 v215, v215
    v_exp_f32 v216, v216
    v_exp_f32 v217, v217
    v_exp_f32 v218, v218
    v_exp_f32 v219, v219
    v_fma_f32 v212, v212, v133, v133
    v_fma_f32 v213, v213, v133, v133
    v_fma_f32 v214, v214, v133, v133
    v_fma_f32 v215, v215, v133, v133
    v_fma_f32 v216, v216, v133, v133
    v_fma_f32 v217, v217, v133, v133
    v_fma_f32 v218, v218, v133, v133
    v_fma_f32 v219, v219, v133, v133
    v_rcp_f32 v212, v212
    v_rcp_f32 v213, v213
    v_rcp_f32 v214, v214
    v_rcp_f32 v215, v215
    v_rcp_f32 v216, v216
    v_rcp_f32 v217, v217
    v_rcp_f32 v218, v218
    v_rcp_f32 v219, v219
    v_mul_f32 v80, v80, v212
    v_mul_f32 v81, v81, v213
    v_mul_f32 v82, v82, v214
    v_mul_f32 v83, v83, v215
    v_mul_f32 v96, v96, v216
    v_mul_f32 v97, v97, v217
    v_mul_f32 v98, v98, v218
    v_mul_f32 v99, v99, v219
    v_cvt_pk_bf16_f32 v176, v80, v81
    v_cvt_pk_bf16_f32 v177, v82, v83
    v_cvt_pk_bf16_f32 v178, v96, v97
    v_cvt_pk_bf16_f32 v179, v98, v99
    s_nop 0
    v_permlane16_swap_b32 v176, v178
    v_permlane16_swap_b32 v177, v179
    buffer_store_dwordx4 v[176:179], v190, s[16:19], s38 offen offset:256 sc1
    v_fmac_f32 v20, v126, v136
    v_fmac_f32 v21, v126, v137
    v_fmac_f32 v22, v126, v138
    v_fmac_f32 v23, v126, v139
    v_fmac_f32 v36, v126, v140
    v_fmac_f32 v37, v126, v141
    v_fmac_f32 v38, v126, v142
    v_fmac_f32 v39, v126, v143
    v_mul_f32 v164, v20, v130
    v_mul_f32 v165, v21, v130
    v_mul_f32 v166, v22, v130
    v_mul_f32 v167, v23, v130
    v_mul_f32 v168, v36, v130
    v_mul_f32 v169, v37, v130
    v_mul_f32 v170, v38, v130
    v_mul_f32 v171, v39, v130
    v_exp_f32 v164, v164
    v_exp_f32 v165, v165
    v_exp_f32 v166, v166
    v_exp_f32 v167, v167
    v_exp_f32 v168, v168
    v_exp_f32 v169, v169
    v_exp_f32 v170, v170
    v_exp_f32 v171, v171
    v_fma_f32 v164, v164, v134, v134
    v_fma_f32 v165, v165, v134, v134
    v_fma_f32 v166, v166, v134, v134
    v_fma_f32 v167, v167, v134, v134
    v_fma_f32 v168, v168, v134, v134
    v_fma_f32 v169, v169, v134, v134
    v_fma_f32 v170, v170, v134, v134
    v_fma_f32 v171, v171, v134, v134
    v_rcp_f32 v164, v164
    v_rcp_f32 v165, v165
    v_rcp_f32 v166, v166
    v_rcp_f32 v167, v167
    v_rcp_f32 v168, v168
    v_rcp_f32 v169, v169
    v_rcp_f32 v170, v170
    v_rcp_f32 v171, v171
    v_mul_f32 v20, v20, v164
    v_mul_f32 v21, v21, v165
    v_mul_f32 v22, v22, v166
    v_mul_f32 v23, v23, v167
    v_mul_f32 v36, v36, v168
    v_mul_f32 v37, v37, v169
    v_mul_f32 v38, v38, v170
    v_mul_f32 v39, v39, v171
    v_cvt_pk_bf16_f32 v180, v20, v21
    v_cvt_pk_bf16_f32 v181, v22, v23
    v_cvt_pk_bf16_f32 v182, v36, v37
    v_cvt_pk_bf16_f32 v183, v38, v39
    s_nop 0
    v_permlane16_swap_b32 v180, v182
    v_permlane16_swap_b32 v181, v183
    s_add_u32 s38, s37, 229376
    buffer_store_dwordx4 v[180:183], v190, s[16:19], s38 offen offset:0 sc1
    v_fmac_f32 v52, v126, v144
    v_fmac_f32 v53, v126, v145
    v_fmac_f32 v54, v126, v146
    v_fmac_f32 v55, v126, v147
    v_fmac_f32 v68, v126, v148
    v_fmac_f32 v69, v126, v149
    v_fmac_f32 v70, v126, v150
    v_fmac_f32 v71, v126, v151
    v_mul_f32 v212, v52, v130
    v_mul_f32 v213, v53, v130
    v_mul_f32 v214, v54, v130
    v_mul_f32 v215, v55, v130
    v_mul_f32 v216, v68, v130
    v_mul_f32 v217, v69, v130
    v_mul_f32 v218, v70, v130
    v_mul_f32 v219, v71, v130
    v_exp_f32 v212, v212
    v_exp_f32 v213, v213
    v_exp_f32 v214, v214
    v_exp_f32 v215, v215
    v_exp_f32 v216, v216
    v_exp_f32 v217, v217
    v_exp_f32 v218, v218
    v_exp_f32 v219, v219
    v_fma_f32 v212, v212, v134, v134
    v_fma_f32 v213, v213, v134, v134
    v_fma_f32 v214, v214, v134, v134
    v_fma_f32 v215, v215, v134, v134
    v_fma_f32 v216, v216, v134, v134
    v_fma_f32 v217, v217, v134, v134
    v_fma_f32 v218, v218, v134, v134
    v_fma_f32 v219, v219, v134, v134
    v_rcp_f32 v212, v212
    v_rcp_f32 v213, v213
    v_rcp_f32 v214, v214
    v_rcp_f32 v215, v215
    v_rcp_f32 v216, v216
    v_rcp_f32 v217, v217
    v_rcp_f32 v218, v218
    v_rcp_f32 v219, v219
    v_mul_f32 v52, v52, v212
    v_mul_f32 v53, v53, v213
    v_mul_f32 v54, v54, v214
    v_mul_f32 v55, v55, v215
    v_mul_f32 v68, v68, v216
    v_mul_f32 v69, v69, v217
    v_mul_f32 v70, v70, v218
    v_mul_f32 v71, v71, v219
    v_cvt_pk_bf16_f32 v184, v52, v53
    v_cvt_pk_bf16_f32 v185, v54, v55
    v_cvt_pk_bf16_f32 v186, v68, v69
    v_cvt_pk_bf16_f32 v187, v70, v71
    s_nop 0
    v_permlane16_swap_b32 v184, v186
    v_permlane16_swap_b32 v185, v187
    buffer_store_dwordx4 v[184:187], v190, s[16:19], s38 offen offset:128 sc1
    v_fmac_f32 v84, v126, v152
    v_fmac_f32 v85, v126, v153
    v_fmac_f32 v86, v126, v154
    v_fmac_f32 v87, v126, v155
    v_fmac_f32 v100, v126, v156
    v_fmac_f32 v101, v126, v157
    v_fmac_f32 v102, v126, v158
    v_fmac_f32 v103, v126, v159
    v_mul_f32 v164, v84, v130
    v_mul_f32 v165, v85, v130
    v_mul_f32 v166, v86, v130
    v_mul_f32 v167, v87, v130
    v_mul_f32 v168, v100, v130
    v_mul_f32 v169, v101, v130
    v_mul_f32 v170, v102, v130
    v_mul_f32 v171, v103, v130
    v_exp_f32 v164, v164
    v_exp_f32 v165, v165
    v_exp_f32 v166, v166
    v_exp_f32 v167, v167
    v_exp_f32 v168, v168
    v_exp_f32 v169, v169
    v_exp_f32 v170, v170
    v_exp_f32 v171, v171
    v_fma_f32 v164, v164, v134, v134
    v_fma_f32 v165, v165, v134, v134
    v_fma_f32 v166, v166, v134, v134
    v_fma_f32 v167, v167, v134, v134
    v_fma_f32 v168, v168, v134, v134
    v_fma_f32 v169, v169, v134, v134
    v_fma_f32 v170, v170, v134, v134
    v_fma_f32 v171, v171, v134, v134
    v_rcp_f32 v164, v164
    v_rcp_f32 v165, v165
    v_rcp_f32 v166, v166
    v_rcp_f32 v167, v167
    v_rcp_f32 v168, v168
    v_rcp_f32 v169, v169
    v_rcp_f32 v170, v170
    v_rcp_f32 v171, v171
    v_mul_f32 v84, v84, v164
    v_mul_f32 v85, v85, v165
    v_mul_f32 v86, v86, v166
    v_mul_f32 v87, v87, v167
    v_mul_f32 v100, v100, v168
    v_mul_f32 v101, v101, v169
    v_mul_f32 v102, v102, v170
    v_mul_f32 v103, v103, v171
    v_cvt_pk_bf16_f32 v172, v84, v85
    v_cvt_pk_bf16_f32 v173, v86, v87
    v_cvt_pk_bf16_f32 v174, v100, v101
    v_cvt_pk_bf16_f32 v175, v102, v103
    s_nop 0
    v_permlane16_swap_b32 v172, v174
    v_permlane16_swap_b32 v173, v175
    buffer_store_dwordx4 v[172:175], v190, s[16:19], s38 offen offset:256 sc1
    v_fmac_f32 v24, v127, v136
    v_fmac_f32 v25, v127, v137
    v_fmac_f32 v26, v127, v138
    v_fmac_f32 v27, v127, v139
    v_fmac_f32 v40, v127, v140
    v_fmac_f32 v41, v127, v141
    v_fmac_f32 v42, v127, v142
    v_fmac_f32 v43, v127, v143
    v_mul_f32 v212, v24, v131
    v_mul_f32 v213, v25, v131
    v_mul_f32 v214, v26, v131
    v_mul_f32 v215, v27, v131
    v_mul_f32 v216, v40, v131
    v_mul_f32 v217, v41, v131
    v_mul_f32 v218, v42, v131
    v_mul_f32 v219, v43, v131
    v_exp_f32 v212, v212
    v_exp_f32 v213, v213
    v_exp_f32 v214, v214
    v_exp_f32 v215, v215
    v_exp_f32 v216, v216
    v_exp_f32 v217, v217
    v_exp_f32 v218, v218
    v_exp_f32 v219, v219
    v_fma_f32 v212, v212, v135, v135
    v_fma_f32 v213, v213, v135, v135
    v_fma_f32 v214, v214, v135, v135
    v_fma_f32 v215, v215, v135, v135
    v_fma_f32 v216, v216, v135, v135
    v_fma_f32 v217, v217, v135, v135
    v_fma_f32 v218, v218, v135, v135
    v_fma_f32 v219, v219, v135, v135
    v_rcp_f32 v212, v212
    v_rcp_f32 v213, v213
    v_rcp_f32 v214, v214
    v_rcp_f32 v215, v215
    v_rcp_f32 v216, v216
    v_rcp_f32 v217, v217
    v_rcp_f32 v218, v218
    v_rcp_f32 v219, v219
    v_mul_f32 v24, v24, v212
    v_mul_f32 v25, v25, v213
    v_mul_f32 v26, v26, v214
    v_mul_f32 v27, v27, v215
    v_mul_f32 v40, v40, v216
    v_mul_f32 v41, v41, v217
    v_mul_f32 v42, v42, v218
    v_mul_f32 v43, v43, v219
    v_cvt_pk_bf16_f32 v176, v24, v25
    v_cvt_pk_bf16_f32 v177, v26, v27
    v_cvt_pk_bf16_f32 v178, v40, v41
    v_cvt_pk_bf16_f32 v179, v42, v43
    s_nop 0
    v_permlane16_swap_b32 v176, v178
    v_permlane16_swap_b32 v177, v179
    s_add_u32 s38, s37, 344064
    buffer_store_dwordx4 v[176:179], v190, s[16:19], s38 offen offset:0 sc1
    v_fmac_f32 v56, v127, v144
    v_fmac_f32 v57, v127, v145
    v_fmac_f32 v58, v127, v146
    v_fmac_f32 v59, v127, v147
    v_fmac_f32 v72, v127, v148
    v_fmac_f32 v73, v127, v149
    v_fmac_f32 v74, v127, v150
    v_fmac_f32 v75, v127, v151
    v_mul_f32 v164, v56, v131
    v_mul_f32 v165, v57, v131
    v_mul_f32 v166, v58, v131
    v_mul_f32 v167, v59, v131
    v_mul_f32 v168, v72, v131
    v_mul_f32 v169, v73, v131
    v_mul_f32 v170, v74, v131
    v_mul_f32 v171, v75, v131
    v_exp_f32 v164, v164
    v_exp_f32 v165, v165
    v_exp_f32 v166, v166
    v_exp_f32 v167, v167
    v_exp_f32 v168, v168
    v_exp_f32 v169, v169
    v_exp_f32 v170, v170
    v_exp_f32 v171, v171
    v_fma_f32 v164, v164, v135, v135
    v_fma_f32 v165, v165, v135, v135
    v_fma_f32 v166, v166, v135, v135
    v_fma_f32 v167, v167, v135, v135
    v_fma_f32 v168, v168, v135, v135
    v_fma_f32 v169, v169, v135, v135
    v_fma_f32 v170, v170, v135, v135
    v_fma_f32 v171, v171, v135, v135
    v_rcp_f32 v164, v164
    v_rcp_f32 v165, v165
    v_rcp_f32 v166, v166
    v_rcp_f32 v167, v167
    v_rcp_f32 v168, v168
    v_rcp_f32 v169, v169
    v_rcp_f32 v170, v170
    v_rcp_f32 v171, v171
    v_mul_f32 v56, v56, v164
    v_mul_f32 v57, v57, v165
    v_mul_f32 v58, v58, v166
    v_mul_f32 v59, v59, v167
    v_mul_f32 v72, v72, v168
    v_mul_f32 v73, v73, v169
    v_mul_f32 v74, v74, v170
    v_mul_f32 v75, v75, v171
    v_cvt_pk_bf16_f32 v180, v56, v57
    v_cvt_pk_bf16_f32 v181, v58, v59
    v_cvt_pk_bf16_f32 v182, v72, v73
    v_cvt_pk_bf16_f32 v183, v74, v75
    s_nop 0
    v_permlane16_swap_b32 v180, v182
    v_permlane16_swap_b32 v181, v183
    buffer_store_dwordx4 v[180:183], v190, s[16:19], s38 offen offset:128 sc1
    v_fmac_f32 v88, v127, v152
    v_fmac_f32 v89, v127, v153
    v_fmac_f32 v90, v127, v154
    v_fmac_f32 v91, v127, v155
    v_fmac_f32 v104, v127, v156
    v_fmac_f32 v105, v127, v157
    v_fmac_f32 v106, v127, v158
    v_fmac_f32 v107, v127, v159
    v_mul_f32 v212, v88, v131
    v_mul_f32 v213, v89, v131
    v_mul_f32 v214, v90, v131
    v_mul_f32 v215, v91, v131
    v_mul_f32 v216, v104, v131
    v_mul_f32 v217, v105, v131
    v_mul_f32 v218, v106, v131
    v_mul_f32 v219, v107, v131
    v_exp_f32 v212, v212
    v_exp_f32 v213, v213
    v_exp_f32 v214, v214
    v_exp_f32 v215, v215
    v_exp_f32 v216, v216
    v_exp_f32 v217, v217
    v_exp_f32 v218, v218
    v_exp_f32 v219, v219
    v_fma_f32 v212, v212, v135, v135
    v_fma_f32 v213, v213, v135, v135
    v_fma_f32 v214, v214, v135, v135
    v_fma_f32 v215, v215, v135, v135
    v_fma_f32 v216, v216, v135, v135
    v_fma_f32 v217, v217, v135, v135
    v_fma_f32 v218, v218, v135, v135
    v_fma_f32 v219, v219, v135, v135
    v_rcp_f32 v212, v212
    v_rcp_f32 v213, v213
    v_rcp_f32 v214, v214
    v_rcp_f32 v215, v215
    v_rcp_f32 v216, v216
    v_rcp_f32 v217, v217
    v_rcp_f32 v218, v218
    v_rcp_f32 v219, v219
    v_mul_f32 v88, v88, v212
    v_mul_f32 v89, v89, v213
    v_mul_f32 v90, v90, v214
    v_mul_f32 v91, v91, v215
    v_mul_f32 v104, v104, v216
    v_mul_f32 v105, v105, v217
    v_mul_f32 v106, v106, v218
    v_mul_f32 v107, v107, v219
    v_cvt_pk_bf16_f32 v184, v88, v89
    v_cvt_pk_bf16_f32 v185, v90, v91
    v_cvt_pk_bf16_f32 v186, v104, v105
    v_cvt_pk_bf16_f32 v187, v106, v107
    s_nop 0
    v_permlane16_swap_b32 v184, v186
    v_permlane16_swap_b32 v185, v187
    buffer_store_dwordx4 v[184:187], v190, s[16:19], s38 offen offset:256 sc1
    s_waitcnt lgkmcnt(0)
    s_barrier
    v_xor_b32 v204, 1024, v204
    ds_read_b128 v[200:203], v204
    v_bfe_u32 v191, v1, 4, 1
    v_lshlrev_b32 v191, 5, v191
    v_bfe_u32 v2, v1, 5, 1
    v_lshl_add_u32 v191, v2, 4, v191
    v_and_b32 v2, 15, v1
    v_mul_u32_u24 v2, 7168, v2
    v_add_u32 v191, v191, v2
    s_add_u32 s38, s66, s39
    v_add_u32 v191, s38, v191
    s_waitcnt lgkmcnt(0)
    s_cmp_eq_u32 s7, 0
    s_cbranch_scc0 L_g7c_35
    v_mov_b32 v172, v192
    v_mov_b32 v174, v200
    v_mov_b32 v173, v193
    v_mov_b32 v175, v201
    v_mov_b32 v176, v194
    v_mov_b32 v178, v202
    v_mov_b32 v177, v195
    v_mov_b32 v179, v203
    s_mov_b32 s68, 0
    s_branch L_g7d_36
L_g7c_35:
    v_mov_b32 v172, v200
    v_mov_b32 v174, v196
    v_mov_b32 v173, v201
    v_mov_b32 v175, v197
    v_mov_b32 v176, v202
    v_mov_b32 v178, v198
    v_mov_b32 v177, v203
    v_mov_b32 v179, v199
    s_mov_b32 s68, 229376
L_g7d_36:
    s_add_u32 s68, s68, s37
    v_permlane16_swap_b32 v172, v174
    v_permlane16_swap_b32 v173, v175
    s_add_u32 s38, s68, 0
    buffer_store_dwordx4 v[172:175], v191, s[16:19], s38 offen sc1
    v_permlane16_swap_b32 v176, v178
    v_permlane16_swap_b32 v177, v179
    s_add_u32 s38, s68, 114688
    buffer_store_dwordx4 v[176:179], v191, s[16:19], s38 offen sc1
    s_waitcnt vmcnt(0)
    v_mov_b32 v2, 1
    v_mov_b32 v3, 155648
    s_mov_b64 exec, 1
    ds_add_rtn_u32 v3, v3, v2
    s_waitcnt lgkmcnt(0)
    v_readfirstlane_b32 s68, v3
    s_nop 0
    s_and_b32 s68, s68, 3
    s_cmp_eq_u32 s68, 3
    s_cbranch_scc0 L_nf_37
    s_lshl_b32 s67, s4, 12
    s_add_u32 s67, s67, 524288
    s_lshl_b32 s68, s5, 7
    s_add_u32 s67, s67, s68
    v_mov_b32 v3, 0
    buffer_store_dword v2, v3, s[88:91], s67 offen sc1
L_nf_37:
    s_mov_b64 exec, -1
    s_and_b32 s86, s2, 1
    s_bfe_u32 s37, s2, 0x10001
    s_lshl_b32 s37, s37, 3
    s_bfe_u32 s38, s2, 0x30003
    s_add_u32 s4, s37, s38
    s_bfe_u32 s37, s2, 0x10002
    s_lshl_b32 s37, s37, 2
    s_lshr_b32 s38, s2, 6
    s_add_u32 s5, s37, s38
    v_and_b32 v1, 63, v0
    s_lshr_b32 s6, s3, 1
    s_and_b32 s7, s3, 1
    s_mul_i32 s39, s6, 8192
    v_and_b32 v2, 15, v1
    v_lshrrev_b32 v3, 1, v2
    v_lshlrev_b32 v2, 7, v2
    v_add_u32 v2, s39, v2
    v_lshrrev_b32 v4, 4, v1
    v_xor_b32 v3, v3, v4
    v_lshl_add_u32 v4, v3, 4, v2
    v_xor_b32 v5, 64, v4
    s_lshl_b32 s37, s86, 12
    s_xor_b32 s38, s37, 4096
    v_add_u32 v6, s38, v4
    v_add_u32 v4, s37, v4
    v_add_u32 v7, s38, v5
    v_add_u32 v5, s37, v5
    v_lshrrev_b32 v2, 4, v1
    v_lshlrev_b32 v2, 3, v2
    v_bfe_u32 v3, v1, 2, 2
    v_add_u32 v76, v2, v3
    v_bfe_u32 v77, v1, 3, 1
    v_lshlrev_b32 v77, 1, v77
    v_bfe_u32 v3, v1, 4, 1
    v_lshl_add_u32 v77, v3, 2, v77
    v_bfe_u32 v3, v1, 1, 1
    s_lshl_b32 s39, s7, 2
    s_add_u32 s39, s39, 0
    v_add_u32 v3, s39, v3
    v_xor_b32 v3, v3, v77
    v_lshlrev_b32 v3, 4, v3
    v_lshl_add_u32 v3, v76, 7, v3
    v_and_b32 v2, 1, v1
    v_lshl_add_u32 v3, v2, 3, v3
    v_add_u32 v8, 16384, v3
    v_bfe_u32 v3, v1, 1, 1
    s_lshl_b32 s39, s7, 2
    s_add_u32 s39, s39, 2
    v_add_u32 v3, s39, v3
    v_xor_b32 v3, v3, v77
    v_lshlrev_b32 v3, 4, v3
    v_lshl_add_u32 v3, v76, 7, v3
    v_and_b32 v2, 1, v1
    v_lshl_add_u32 v3, v2, 3, v3
    v_add_u32 v9, 16384, v3
    v_mov_b32 v12, 0
    v_mov_b32 v13, 0
    v_mov_b32 v14, 0
    v_mov_b32 v15, 0
    v_mov_b32 v16, 0
    v_mov_b32 v17, 0
    v_mov_b32 v18, 0
    v_mov_b32 v19, 0
    v_mov_b32 v20, 0
    v_mov_b32 v21, 0
    v_mov_b32 v22, 0
    v_mov_b32 v23, 0
    v_mov_b32 v24, 0
    v_mov_b32 v25, 0
    v_mov_b32 v26, 0
    v_mov_b32 v27, 0
    v_mov_b32 v28, 0
    v_mov_b32 v29, 0
    v_mov_b32 v30, 0
    v_mov_b32 v31, 0
    v_mov_b32 v32, 0
    v_mov_b32 v33, 0
    v_mov_b32 v34, 0
    v_mov_b32 v35, 0
    v_mov_b32 v36, 0
    v_mov_b32 v37, 0
    v_mov_b32 v38, 0
    v_mov_b32 v39, 0
    v_mov_b32 v40, 0
    v_mov_b32 v41, 0
    v_mov_b32 v42, 0
    v_mov_b32 v43, 0
    v_mov_b32 v44, 0
    v_mov_b32 v45, 0
    v_mov_b32 v46, 0
    v_mov_b32 v47, 0
    v_mov_b32 v48, 0
    v_mov_b32 v49, 0
    v_mov_b32 v50, 0
    v_mov_b32 v51, 0
    v_mov_b32 v52, 0
    v_mov_b32 v53, 0
    v_mov_b32 v54, 0
    v_mov_b32 v55, 0
    v_mov_b32 v56, 0
    v_mov_b32 v57, 0
    v_mov_b32 v58, 0
    v_mov_b32 v59, 0
    v_mov_b32 v60, 0
    v_mov_b32 v61, 0
    v_mov_b32 v62, 0
    v_mov_b32 v63, 0
    v_mov_b32 v64, 0
    v_mov_b32 v65, 0
    v_mov_b32 v66, 0
    v_mov_b32 v67, 0
    v_mov_b32 v68, 0
    v_mov_b32 v69, 0
    v_mov_b32 v70, 0
    v_mov_b32 v71, 0
    v_mov_b32 v72, 0
    v_mov_b32 v73, 0
    v_mov_b32 v74, 0
    v_mov_b32 v75, 0
    s_waitcnt lgkmcnt(0)
    s_barrier
    s_mov_b32 s34, 0
    s_mov_b32 s46, -65536
    s_mov_b32 s47, 32768
    s_setprio 2
    s_barrier
    ds_read_b128 v[76:79], v4 offset:0
    ds_read_b64_tr_b16 v[108:109], v8 offset:0
    ds_read_b64_tr_b16 v[110:111], v8 offset:512
    ds_read_b128 v[80:83], v4 offset:2048
    ds_read_b128 v[84:87], v6 offset:0
    ds_read_b128 v[88:91], v6 offset:2048
    ds_read_b64_tr_b16 v[112:113], v9 offset:0
    ds_read_b64_tr_b16 v[114:115], v9 offset:512
    ds_read_b64_tr_b16 v[116:117], v8 offset:8192
    ds_read_b64_tr_b16 v[118:119], v8 offset:8704
    ds_read_b64_tr_b16 v[120:121], v9 offset:8192
    ds_read_b64_tr_b16 v[122:123], v9 offset:8704
    s_mov_b32 s35, 27
    s_waitcnt lgkmcnt(0)
.p2align 6
L_cl_38:
    v_mfma_f32_16x16x32_bf16 v[12:15], v[108:111], v[76:79], v[12:15]
    ds_read_b128 v[92:95], v5 offset:0
    v_mfma_f32_16x16x32_bf16 v[16:19], v[108:111], v[80:83], v[16:19]
    ds_read_b64_tr_b16 v[124:125], v8 offset:4096
    v_mfma_f32_16x16x32_bf16 v[20:23], v[108:111], v[84:87], v[20:23]
    ds_read_b64_tr_b16 v[126:127], v8 offset:4608
    v_mfma_f32_16x16x32_bf16 v[24:27], v[108:111], v[88:91], v[24:27]
    ds_read_b128 v[96:99], v5 offset:2048
    v_mfma_f32_16x16x32_bf16 v[28:31], v[112:115], v[76:79], v[28:31]
    ds_read_b128 v[100:103], v7 offset:0
    v_mfma_f32_16x16x32_bf16 v[32:35], v[112:115], v[80:83], v[32:35]
    ds_read_b128 v[104:107], v7 offset:2048
    v_mfma_f32_16x16x32_bf16 v[36:39], v[112:115], v[84:87], v[36:39]
    ds_read_b64_tr_b16 v[128:129], v9 offset:4096
    v_mfma_f32_16x16x32_bf16 v[40:43], v[112:115], v[88:91], v[40:43]
    ds_read_b64_tr_b16 v[130:131], v9 offset:4608
    v_mfma_f32_16x16x32_bf16 v[44:47], v[116:119], v[76:79], v[44:47]
    ds_read_b64_tr_b16 v[132:133], v8 offset:12288
    v_mfma_f32_16x16x32_bf16 v[48:51], v[116:119], v[80:83], v[48:51]
    ds_read_b64_tr_b16 v[134:135], v8 offset:12800
    v_mfma_f32_16x16x32_bf16 v[52:55], v[116:119], v[84:87], v[52:55]
    ds_read_b64_tr_b16 v[136:137], v9 offset:12288
    v_mfma_f32_16x16x32_bf16 v[56:59], v[116:119], v[88:91], v[56:59]
    ds_read_b64_tr_b16 v[138:139], v9 offset:12800
    v_mfma_f32_16x16x32_bf16 v[60:63], v[120:123], v[76:79], v[60:63]
    s_add_u32 s34, s34, 32768
    v_mfma_f32_16x16x32_bf16 v[64:67], v[120:123], v[80:83], v[64:67]
    s_cmp_eq_u32 s34, 98304
    v_mfma_f32_16x16x32_bf16 v[68:71], v[120:123], v[84:87], v[68:71]
    s_cselect_b32 s36, s46, s47
    v_mfma_f32_16x16x32_bf16 v[72:75], v[120:123], v[88:91], v[72:75]
    s_cselect_b32 s34, 0, s34
    v_add_u32 v4, s36, v4
    v_add_u32 v5, s36, v5
    v_add_u32 v6, s36, v6
    v_add_u32 v7, s36, v7
    v_add_u32 v8, s36, v8
    v_add_u32 v9, s36, v9
    s_waitcnt lgkmcnt(0)
    s_barrier
    v_mfma_f32_16x16x32_bf16 v[12:15], v[124:127], v[92:95], v[12:15]
    ds_read_b128 v[76:79], v4 offset:0
    v_mfma_f32_16x16x32_bf16 v[16:19], v[124:127], v[96:99], v[16:19]
    ds_read_b64_tr_b16 v[108:109], v8 offset:0
    v_mfma_f32_16x16x32_bf16 v[20:23], v[124:127], v[100:103], v[20:23]
    ds_read_b64_tr_b16 v[110:111], v8 offset:512
    v_mfma_f32_16x16x32_bf16 v[24:27], v[124:127], v[104:107], v[24:27]
    ds_read_b128 v[80:83], v4 offset:2048
    v_mfma_f32_16x16x32_bf16 v[28:31], v[128:131], v[92:95], v[28:31]
    ds_read_b128 v[84:87], v6 offset:0
    v_mfma_f32_16x16x32_bf16 v[32:35], v[128:131], v[96:99], v[32:35]
    ds_read_b128 v[88:91], v6 offset:2048
    v_mfma_f32_16x16x32_bf16 v[36:39], v[128:131], v[100:103], v[36:39]
    ds_read_b64_tr_b16 v[112:113], v9 offset:0
    v_mfma_f32_16x16x32_bf16 v[40:43], v[128:131], v[104:107], v[40:43]
    ds_read_b64_tr_b16 v[114:115], v9 offset:512
    v_mfma_f32_16x16x32_bf16 v[44:47], v[132:135], v[92:95], v[44:47]
    ds_read_b64_tr_b16 v[116:117], v8 offset:8192
    v_mfma_f32_16x16x32_bf16 v[48:51], v[132:135], v[96:99], v[48:51]
    ds_read_b64_tr_b16 v[118:119], v8 offset:8704
    v_mfma_f32_16x16x32_bf16 v[52:55], v[132:135], v[100:103], v[52:55]
    ds_read_b64_tr_b16 v[120:121], v9 offset:8192
    v_mfma_f32_16x16x32_bf16 v[56:59], v[132:135], v[104:107], v[56:59]
    ds_read_b64_tr_b16 v[122:123], v9 offset:8704
    v_mfma_f32_16x16x32_bf16 v[60:63], v[136:139], v[92:95], v[60:63]
    v_mfma_f32_16x16x32_bf16 v[64:67], v[136:139], v[96:99], v[64:67]
    v_mfma_f32_16x16x32_bf16 v[68:71], v[136:139], v[100:103], v[68:71]
    v_mfma_f32_16x16x32_bf16 v[72:75], v[136:139], v[104:107], v[72:75]
    s_sub_u32 s35, s35, 1
    s_cmp_lg_u32 s35, 0
    s_waitcnt lgkmcnt(0)
    s_cbranch_scc1 L_cl_38
    v_mfma_f32_16x16x32_bf16 v[12:15], v[108:111], v[76:79], v[12:15]
    ds_read_b128 v[92:95], v5 offset:0
    v_mfma_f32_16x16x32_bf16 v[16:19], v[108:111], v[80:83], v[16:19]
    ds_read_b64_tr_b16 v[124:125], v8 offset:4096
    v_mfma_f32_16x16x32_bf16 v[20:23], v[108:111], v[84:87], v[20:23]
    ds_read_b64_tr_b16 v[126:127], v8 offset:4608
    v_mfma_f32_16x16x32_bf16 v[24:27], v[108:111], v[88:91], v[24:27]
    ds_read_b128 v[96:99], v5 offset:2048
    v_mfma_f32_16x16x32_bf16 v[28:31], v[112:115], v[76:79], v[28:31]
    ds_read_b128 v[100:103], v7 offset:0
    v_mfma_f32_16x16x32_bf16 v[32:35], v[112:115], v[80:83], v[32:35]
    ds_read_b128 v[104:107], v7 offset:2048
    v_mfma_f32_16x16x32_bf16 v[36:39], v[112:115], v[84:87], v[36:39]
    ds_read_b64_tr_b16 v[128:129], v9 offset:4096
    v_mfma_f32_16x16x32_bf16 v[40:43], v[112:115], v[88:91], v[40:43]
    ds_read_b64_tr_b16 v[130:131], v9 offset:4608
    v_mfma_f32_16x16x32_bf16 v[44:47], v[116:119], v[76:79], v[44:47]
    ds_read_b64_tr_b16 v[132:133], v8 offset:12288
    v_mfma_f32_16x16x32_bf16 v[48:51], v[116:119], v[80:83], v[48:51]
    ds_read_b64_tr_b16 v[134:135], v8 offset:12800
    v_mfma_f32_16x16x32_bf16 v[52:55], v[116:119], v[84:87], v[52:55]
    ds_read_b64_tr_b16 v[136:137], v9 offset:12288
    v_mfma_f32_16x16x32_bf16 v[56:59], v[116:119], v[88:91], v[56:59]
    ds_read_b64_tr_b16 v[138:139], v9 offset:12800
    v_mfma_f32_16x16x32_bf16 v[60:63], v[120:123], v[76:79], v[60:63]
    v_mfma_f32_16x16x32_bf16 v[64:67], v[120:123], v[80:83], v[64:67]
    v_mfma_f32_16x16x32_bf16 v[68:71], v[120:123], v[84:87], v[68:71]
    v_mfma_f32_16x16x32_bf16 v[72:75], v[120:123], v[88:91], v[72:75]
    s_waitcnt lgkmcnt(0)
    s_barrier
    v_mfma_f32_16x16x32_bf16 v[12:15], v[124:127], v[92:95], v[12:15]
    v_mfma_f32_16x16x32_bf16 v[16:19], v[124:127], v[96:99], v[16:19]
    v_mfma_f32_16x16x32_bf16 v[20:23], v[124:127], v[100:103], v[20:23]
    v_mfma_f32_16x16x32_bf16 v[24:27], v[124:127], v[104:107], v[24:27]
    v_mfma_f32_16x16x32_bf16 v[28:31], v[128:131], v[92:95], v[28:31]
    v_mfma_f32_16x16x32_bf16 v[32:35], v[128:131], v[96:99], v[32:35]
    v_mfma_f32_16x16x32_bf16 v[36:39], v[128:131], v[100:103], v[36:39]
    v_mfma_f32_16x16x32_bf16 v[40:43], v[128:131], v[104:107], v[40:43]
    v_mfma_f32_16x16x32_bf16 v[44:47], v[132:135], v[92:95], v[44:47]
    v_mfma_f32_16x16x32_bf16 v[48:51], v[132:135], v[96:99], v[48:51]
    v_mfma_f32_16x16x32_bf16 v[52:55], v[132:135], v[100:103], v[52:55]
    v_mfma_f32_16x16x32_bf16 v[56:59], v[132:135], v[104:107], v[56:59]
    v_mfma_f32_16x16x32_bf16 v[60:63], v[136:139], v[92:95], v[60:63]
    v_mfma_f32_16x16x32_bf16 v[64:67], v[136:139], v[96:99], v[64:67]
    v_mfma_f32_16x16x32_bf16 v[68:71], v[136:139], v[100:103], v[68:71]
    v_mfma_f32_16x16x32_bf16 v[72:75], v[136:139], v[104:107], v[72:75]
    s_setprio 0
    s_add_u32 s24, s64, 0x6400000
    s_addc_u32 s25, s65, 0
    s_mov_b32 s26, 0x800000
    s_mov_b32 s27, 0x20000
    v_lshlrev_b32 v76, 4, v1
    s_lshl_b32 s37, s2, 2
    s_add_u32 s37, s37, s3
    s_lshl_b32 s37, s37, 13
    s_add_u32 s38, s37, 0
    buffer_store_dwordx4 v[20:23], v76, s[24:27], s38 offen offset:0 sc1
    buffer_store_dwordx4 v[24:27], v76, s[24:27], s38 offen offset:1024 sc1
    buffer_store_dwordx4 v[36:39], v76, s[24:27], s38 offen offset:2048 sc1
    buffer_store_dwordx4 v[40:43], v76, s[24:27], s38 offen offset:3072 sc1
    s_add_u32 s38, s37, 4096
    buffer_store_dwordx4 v[52:55], v76, s[24:27], s38 offen offset:0 sc1
    buffer_store_dwordx4 v[56:59], v76, s[24:27], s38 offen offset:1024 sc1
    buffer_store_dwordx4 v[68:71], v76, s[24:27], s38 offen offset:2048 sc1
    buffer_store_dwordx4 v[72:75], v76, s[24:27], s38 offen offset:3072 sc1
    s_barrier
    v_and_b32 v2, 15, v1
    v_lshrrev_b32 v3, 1, v2
    v_lshlrev_b32 v2, 7, v2
    s_lshl_b32 s38, s6, 12
    s_add_u32 s38, s38, 135168
    v_add_u32 v2, s38, v2
    v_bfe_u32 v100, v1, 4, 1
    v_lshl_add_u32 v2, v100, 3, v2
    v_bfe_u32 v100, v1, 5, 1
    s_lshl_b32 s38, s7, 2
    v_add_u32 v100, s38, v100
    v_add_u32 v101, 0, v100
    v_xor_b32 v101, v101, v3
    v_lshl_add_u32 v96, v101, 4, v2
    v_add_u32 v101, 2, v100
    v_xor_b32 v101, v101, v3
    v_lshl_add_u32 v97, v101, 4, v2
    ds_read_b64 v[80:81], v96 offset:0
    ds_read_b64 v[82:83], v97 offset:0
    ds_read_b64 v[84:85], v96 offset:8192
    ds_read_b64 v[86:87], v97 offset:8192
    ds_read_b64 v[88:89], v96 offset:2048
    ds_read_b64 v[90:91], v97 offset:2048
    ds_read_b64 v[92:93], v96 offset:10240
    ds_read_b64 v[94:95], v97 offset:10240
    s_lshl_b32 s67, s2, 2
    s_add_u32 s67, s67, s3
    s_lshl_b32 s67, s67, 7
    s_add_u32 s67, s67, 851968
    s_waitcnt vmcnt(0)
    v_mov_b32 v2, 1
    v_mov_b32 v3, 0
    s_mov_b64 exec, 1
    buffer_store_dword v2, v3, s[88:91], s67 offen sc1
    s_mov_b64 exec, -1
    s_xor_b32 s67, s2, 1
    s_lshl_b32 s67, s67, 2
    s_add_u32 s67, s67, s3
    s_lshl_b32 s67, s67, 7
    s_add_u32 s67, s67, 851968
    v_and_b32 v112, 0, v1
    v_lshlrev_b32 v112, 7, v112
    s_mov_b32 s68, 400000
L_poll_39:
    buffer_load_dword v113, v112, s[88:91], s67 offen sc1
    s_waitcnt vmcnt(0)
    v_cmp_ne_u32 vcc, 0, v113
    s_nop 0
    s_cmp_eq_u64 vcc, -1
    s_cbranch_scc1 L_polld_40
    s_sleep 1
    s_sub_u32 s68, s68, 1
    s_cmp_lg_u32 s68, 0
    s_cbranch_scc1 L_poll_39
    s_mov_b32 s92, s62
    s_mov_b32 s93, s63
    s_mov_b32 s94, 256
    s_mov_b32 s95, 0x20000
    v_mov_b32 v113, 1025
    v_mov_b32 v112, 0
    buffer_store_dword v113, v112, s[92:95], 0 offen
L_polld_40:
    s_xor_b32 s37, s2, 1
    s_lshl_b32 s37, s37, 2
    s_add_u32 s37, s37, s3
    s_lshl_b32 s37, s37, 13
    s_add_u32 s38, s37, 0
    buffer_load_dwordx4 v[136:139], v76, s[24:27], s38 offen offset:0 sc1
    buffer_load_dwordx4 v[140:143], v76, s[24:27], s38 offen offset:1024 sc1
    buffer_load_dwordx4 v[144:147], v76, s[24:27], s38 offen offset:2048 sc1
    buffer_load_dwordx4 v[148:151], v76, s[24:27], s38 offen offset:3072 sc1
    s_add_u32 s38, s37, 4096
    buffer_load_dwordx4 v[152:155], v76, s[24:27], s38 offen offset:0 sc1
    buffer_load_dwordx4 v[156:159], v76, s[24:27], s38 offen offset:1024 sc1
    buffer_load_dwordx4 v[160:163], v76, s[24:27], s38 offen offset:2048 sc1
    buffer_load_dwordx4 v[164:167], v76, s[24:27], s38 offen offset:3072 sc1
    s_mov_b32 s16, s60
    s_mov_b32 s17, s61
    s_mov_b32 s18, 0x400000
    s_mov_b32 s19, 0x20000
    v_bfe_u32 v100, v1, 4, 1
    v_lshlrev_b32 v100, 5, v100
    v_bfe_u32 v2, v1, 5, 1
    v_lshl_add_u32 v100, v2, 4, v100
    v_and_b32 v2, 15, v1
    s_mov_b32 s68, 2048
    v_mad_u32_u24 v100, v2, s68, v100
    s_lshl_b32 s37, s4, 7
    s_lshl_b32 s38, s6, 6
    s_add_u32 s37, s37, s38
    s_lshl_b32 s38, s86, 5
    s_add_u32 s69, s37, s38
    s_mul_i32 s37, s69, 2048
    s_lshl_b32 s38, s5, 8
    s_add_u32 s37, s37, s38
    s_lshl_b32 s38, s7, 6
    s_add_u32 s37, s37, s38
    v_mov_b32 v132, 0xffff0000
    s_waitcnt lgkmcnt(0)
    v_lshlrev_b32 v112, 16, v80
    v_and_b32 v113, v132, v80
    v_lshlrev_b32 v114, 16, v81
    v_and_b32 v115, v132, v81
    v_add_f32 v12, v12, v112
    v_add_f32 v13, v13, v113
    v_add_f32 v14, v14, v114
    v_add_f32 v15, v15, v115
    v_lshlrev_b32 v112, 16, v82
    v_and_b32 v113, v132, v82
    v_lshlrev_b32 v114, 16, v83
    v_and_b32 v115, v132, v83
    v_add_f32 v28, v28, v112
    v_add_f32 v29, v29, v113
    v_add_f32 v30, v30, v114
    v_add_f32 v31, v31, v115
    v_lshlrev_b32 v112, 16, v84
    v_and_b32 v113, v132, v84
    v_lshlrev_b32 v114, 16, v85
    v_and_b32 v115, v132, v85
    v_add_f32 v44, v44, v112
    v_add_f32 v45, v45, v113
    v_add_f32 v46, v46, v114
    v_add_f32 v47, v47, v115
    v_lshlrev_b32 v112, 16, v86
    v_and_b32 v113, v132, v86
    v_lshlrev_b32 v114, 16, v87
    v_and_b32 v115, v132, v87
    v_add_f32 v60, v60, v112
    v_add_f32 v61, v61, v113
    v_add_f32 v62, v62, v114
    v_add_f32 v63, v63, v115
    v_lshlrev_b32 v112, 16, v88
    v_and_b32 v113, v132, v88
    v_lshlrev_b32 v114, 16, v89
    v_and_b32 v115, v132, v89
    v_add_f32 v16, v16, v112
    v_add_f32 v17, v17, v113
    v_add_f32 v18, v18, v114
    v_add_f32 v19, v19, v115
    v_lshlrev_b32 v112, 16, v90
    v_and_b32 v113, v132, v90
    v_lshlrev_b32 v114, 16, v91
    v_and_b32 v115, v132, v91
    v_add_f32 v32, v32, v112
    v_add_f32 v33, v33, v113
    v_add_f32 v34, v34, v114
    v_add_f32 v35, v35, v115
    v_lshlrev_b32 v112, 16, v92
    v_and_b32 v113, v132, v92
    v_lshlrev_b32 v114, 16, v93
    v_and_b32 v115, v132, v93
    v_add_f32 v48, v48, v112
    v_add_f32 v49, v49, v113
    v_add_f32 v50, v50, v114
    v_add_f32 v51, v51, v115
    v_lshlrev_b32 v112, 16, v94
    v_and_b32 v113, v132, v94
    v_lshlrev_b32 v114, 16, v95
    v_and_b32 v115, v132, v95
    v_add_f32 v64, v64, v112
    v_add_f32 v65, v65, v113
    v_add_f32 v66, v66, v114
    v_add_f32 v67, v67, v115
    s_waitcnt vmcnt(0)
    v_add_f32 v12, v12, v136
    v_add_f32 v13, v13, v137
    v_add_f32 v14, v14, v138
    v_add_f32 v15, v15, v139
    v_cvt_pk_bf16_f32 v116, v12, v13
    v_cvt_pk_bf16_f32 v117, v14, v15
    v_add_f32 v28, v28, v144
    v_add_f32 v29, v29, v145
    v_add_f32 v30, v30, v146
    v_add_f32 v31, v31, v147
    v_cvt_pk_bf16_f32 v118, v28, v29
    v_cvt_pk_bf16_f32 v119, v30, v31
    v_add_f32 v44, v44, v152
    v_add_f32 v45, v45, v153
    v_add_f32 v46, v46, v154
    v_add_f32 v47, v47, v155
    v_cvt_pk_bf16_f32 v120, v44, v45
    v_cvt_pk_bf16_f32 v121, v46, v47
    v_add_f32 v60, v60, v160
    v_add_f32 v61, v61, v161
    v_add_f32 v62, v62, v162
    v_add_f32 v63, v63, v163
    v_cvt_pk_bf16_f32 v122, v60, v61
    v_cvt_pk_bf16_f32 v123, v62, v63
    v_permlane16_swap_b32 v116, v118
    v_permlane16_swap_b32 v117, v119
    s_add_u32 s38, s37, 0
    buffer_store_dwordx4 v[116:119], v100, s[16:19], s38 offen offset:0
    v_permlane16_swap_b32 v120, v122
    v_permlane16_swap_b32 v121, v123
    s_add_u32 s38, s37, 0
    buffer_store_dwordx4 v[120:123], v100, s[16:19], s38 offen offset:128
    v_add_f32 v16, v16, v140
    v_add_f32 v17, v17, v141
    v_add_f32 v18, v18, v142
    v_add_f32 v19, v19, v143
    v_cvt_pk_bf16_f32 v124, v16, v17
    v_cvt_pk_bf16_f32 v125, v18, v19
    v_add_f32 v32, v32, v148
    v_add_f32 v33, v33, v149
    v_add_f32 v34, v34, v150
    v_add_f32 v35, v35, v151
    v_cvt_pk_bf16_f32 v126, v32, v33
    v_cvt_pk_bf16_f32 v127, v34, v35
    v_add_f32 v48, v48, v156
    v_add_f32 v49, v49, v157
    v_add_f32 v50, v50, v158
    v_add_f32 v51, v51, v159
    v_cvt_pk_bf16_f32 v128, v48, v49
    v_cvt_pk_bf16_f32 v129, v50, v51
    v_add_f32 v64, v64, v164
    v_add_f32 v65, v65, v165
    v_add_f32 v66, v66, v166
    v_add_f32 v67, v67, v167
    v_cvt_pk_bf16_f32 v130, v64, v65
    v_cvt_pk_bf16_f32 v131, v66, v67
    v_permlane16_swap_b32 v124, v126
    v_permlane16_swap_b32 v125, v127
    s_add_u32 s38, s37, 32768
    buffer_store_dwordx4 v[124:127], v100, s[16:19], s38 offen offset:0
    v_permlane16_swap_b32 v128, v130
    v_permlane16_swap_b32 v129, v131
    s_add_u32 s38, s37, 32768
    buffer_store_dwordx4 v[128:131], v100, s[16:19], s38 offen offset:128
    s_endpgm
L_loader_2:
    s_sub_u32 s3, s3, 4
    v_and_b32 v1, 63, v0
    s_and_b32 s37, s2, 1
    s_lshl_b32 s37, s37, 3
    s_bfe_u32 s38, s2, 0x30003
    s_add_u32 s4, s37, s38
    s_bfe_u32 s37, s2, 0x20001
    s_lshl_b32 s37, s37, 2
    s_lshr_b32 s38, s2, 6
    s_add_u32 s5, s37, s38
    s_mov_b32 s8, s48
    s_mov_b32 s9, s49
    s_mov_b32 s10, 0x400000
    s_mov_b32 s11, 0x20000
    s_mov_b32 s12, s50
    s_mov_b32 s13, s51
    s_mov_b32 s14, 0x600000
    s_mov_b32 s15, 0x20000
    s_add_u32 s20, s64, 0x3c00000
    s_addc_u32 s21, s65, 0
    s_mov_b32 s22, 0x40000
    s_mov_b32 s23, 0x20000
    s_lshl_b32 s37, s3, 4
    s_mul_i32 s37, s37, 6144
    s_mul_i32 s38, s5, 128
    s_add_u32 s37, s37, s38
    v_lshrrev_b32 v2, 3, v1
    v_mul_u32_u24 v2, 6144, v2
    v_add_u32 v2, s37, v2
    v_lshrrev_b32 v3, 3, v1
    v_and_b32 v3, 2, v3
    v_xor_b32 v3, v1, v3
    v_and_b32 v3, 7, v3
    v_lshl_add_u32 v8, v3, 4, v2
    v_lshl_add_u32 v10, v3, 4, v2
    v_add_u32 v10, 0x800, v10
    v_lshl_add_u32 v12, v3, 4, v2
    v_add_u32 v12, 0x1000, v12
    v_lshrrev_b32 v3, 3, v1
    v_and_b32 v3, 2, v3
    v_add_u32 v3, 4, v3
    v_xor_b32 v3, v1, v3
    v_and_b32 v3, 7, v3
    v_lshl_add_u32 v9, v3, 4, v2
    v_add_u32 v9, 0xbc00, v9
    v_lshl_add_u32 v11, v3, 4, v2
    v_add_u32 v11, 0xc400, v11
    v_lshl_add_u32 v13, v3, 4, v2
    v_add_u32 v13, 0xcc00, v13
    s_lshl_b32 s40, s3, 12
    s_lshl_b32 s41, s3, 11
    s_add_u32 s41, s41, 16384
    s_lshl_b32 s42, s3, 11
    s_add_u32 s42, s42, 24576
    s_lshl_b32 s43, s3, 11
    s_add_u32 s43, s43, 32768
    s_add_u32 s37, s4, s5
    s_and_b32 s37, s37, 15
    s_lshl_b32 s32, s37, 7
    s_mul_i32 s33, s37, 393216
    v_mov_b32 v28, 0
    v_mov_b32 v29, 0
    v_mov_b32 v30, 0
    v_mov_b32 v31, 0
    v_lshlrev_b32 v2, 4, v1
    s_lshl_b32 s37, s2, 2
    s_add_u32 s37, s37, s3
    s_lshl_b32 s37, s37, 10
    buffer_store_dwordx4 v[28:31], v2, s[88:91], s37 offen sc1
    s_getpc_b64 s[96:97]
L_pc_41:
    s_sub_u32 s96, s96, L_pc_41-interleave_layers__linear_attn_block__dense_activation_silu__prompt_kernel
    s_subb_u32 s97, s97, 0
    s_lshr_b32 s37, s2, 3
    s_lshl_b32 s37, s37, 2
    s_add_u32 s37, s37, s3
    s_mul_i32 s37, s37, 5
    v_min_u32 v2, 4, v1
    v_add_u32 v2, s37, v2
    v_lshlrev_b32 v2, 7, v2
    v_min_u32 v2, L_kernel_end-interleave_layers__linear_attn_block__dense_activation_silu__prompt_kernel-4, v2
    v_mov_b32 v63, s97
    v_add_co_u32 v62, vcc, s96, v2
    s_nop 1
    v_addc_co_u32 v63, vcc, 0, v63, vcc
    s_mov_b64 exec, 0x1f
    global_load_dword v22, v[62:63], off
    s_mov_b64 exec, -1
    s_lshl_b32 s37, s4, 7
    s_lshl_b32 s38, s3, 5
    s_add_u32 s37, s37, s38
    s_mul_i32 s37, s37, 2048
    v_lshrrev_b32 v2, 3, v1
    v_mul_u32_u24 v2, 2048, v2
    v_add_u32 v2, s37, v2
    v_lshrrev_b32 v3, 4, v1
    v_xor_b32 v3, v1, v3
    v_and_b32 v3, 7, v3
    v_lshl_add_u32 v4, v3, 4, v2
    v_lshrrev_b32 v3, 4, v1
    v_add_u32 v3, 4, v3
    v_xor_b32 v3, v1, v3
    v_and_b32 v3, 7, v3
    v_lshl_add_u32 v5, v3, 4, v2
    v_add_u32 v5, 0x3c00, v5
    v_lshrrev_b32 v3, 4, v1
    v_xor_b32 v3, v1, v3
    v_and_b32 v3, 7, v3
    v_lshl_add_u32 v6, v3, 4, v2
    v_add_u32 v6, 0x7800, v6
    v_lshrrev_b32 v3, 4, v1
    v_add_u32 v3, 4, v3
    v_xor_b32 v3, v1, v3
    v_and_b32 v3, 7, v3
    v_lshl_add_u32 v7, v3, 4, v2
    v_add_u32 v7, 0xb400, v7
    s_barrier
    s_mov_b32 s34, 0
    s_add_u32 m0, s40, 0
    s_nop 0
    buffer_load_dwordx4 v4, s[8:11], s32 offen offset:0 sc1 lds
    buffer_load_dwordx4 v5, s[8:11], s32 offen offset:1024 sc1 lds
    buffer_load_dwordx4 v6, s[8:11], s32 offen offset:2048 sc1 lds
    buffer_load_dwordx4 v7, s[8:11], s32 offen offset:3072 sc1 lds
    s_add_u32 s32, s32, 128
    s_cmp_eq_u32 s32, 2048
    s_cselect_b32 s32, 0, s32
    s_add_u32 m0, s41, 0
    s_nop 0
    buffer_load_dwordx4 v8, s[12:15], s33 offen offset:0 lds
    buffer_load_dwordx4 v9, s[12:15], s33 offen offset:1024 lds
    s_add_u32 m0, s42, 0
    s_nop 0
    buffer_load_dwordx4 v10, s[12:15], s33 offen offset:0 lds
    buffer_load_dwordx4 v11, s[12:15], s33 offen offset:1024 lds
    s_add_u32 m0, s43, 0
    s_nop 0
    buffer_load_dwordx4 v12, s[12:15], s33 offen offset:0 lds
    buffer_load_dwordx4 v13, s[12:15], s33 offen offset:1024 lds
    s_add_u32 s33, s33, 393216
    s_cmp_eq_u32 s33, 6291456
    s_cselect_b32 s33, 0, s33
    s_add_u32 m0, s40, 40960
    s_nop 0
    buffer_load_dwordx4 v4, s[8:11], s32 offen offset:0 sc1 lds
    buffer_load_dwordx4 v5, s[8:11], s32 offen offset:1024 sc1 lds
    buffer_load_dwordx4 v6, s[8:11], s32 offen offset:2048 sc1 lds
    buffer_load_dwordx4 v7, s[8:11], s32 offen offset:3072 sc1 lds
    s_add_u32 s32, s32, 128
    s_cmp_eq_u32 s32, 2048
    s_cselect_b32 s32, 0, s32
    s_add_u32 m0, s41, 40960
    s_nop 0
    buffer_load_dwordx4 v8, s[12:15], s33 offen offset:0 lds
    buffer_load_dwordx4 v9, s[12:15], s33 offen offset:1024 lds
    s_add_u32 m0, s42, 40960
    s_nop 0
    buffer_load_dwordx4 v10, s[12:15], s33 offen offset:0 lds
    buffer_load_dwordx4 v11, s[12:15], s33 offen offset:1024 lds
    s_add_u32 m0, s43, 40960
    s_nop 0
    buffer_load_dwordx4 v12, s[12:15], s33 offen offset:0 lds
    buffer_load_dwordx4 v13, s[12:15], s33 offen offset:1024 lds
    s_add_u32 s33, s33, 393216
    s_cmp_eq_u32 s33, 6291456
    s_cselect_b32 s33, 0, s33
    s_waitcnt vmcnt(10)
    s_barrier
    s_add_u32 m0, s40, 81920
    s_nop 0
    buffer_load_dwordx4 v4, s[8:11], s32 offen offset:0 sc1 lds
    buffer_load_dwordx4 v5, s[8:11], s32 offen offset:1024 sc1 lds
    buffer_load_dwordx4 v6, s[8:11], s32 offen offset:2048 sc1 lds
    buffer_load_dwordx4 v7, s[8:11], s32 offen offset:3072 sc1 lds
    s_add_u32 s32, s32, 128
    s_cmp_eq_u32 s32, 2048
    s_cselect_b32 s32, 0, s32
    s_add_u32 m0, s41, 81920
    s_nop 0
    buffer_load_dwordx4 v8, s[12:15], s33 offen offset:0 lds
    buffer_load_dwordx4 v9, s[12:15], s33 offen offset:1024 lds
    s_add_u32 m0, s42, 81920
    s_nop 0
    buffer_load_dwordx4 v10, s[12:15], s33 offen offset:0 lds
    buffer_load_dwordx4 v11, s[12:15], s33 offen offset:1024 lds
    s_add_u32 m0, s43, 81920
    s_nop 0
    buffer_load_dwordx4 v12, s[12:15], s33 offen offset:0 lds
    buffer_load_dwordx4 v13, s[12:15], s33 offen offset:1024 lds
    s_add_u32 s33, s33, 393216
    s_cmp_eq_u32 s33, 6291456
    s_cselect_b32 s33, 0, s33
    s_waitcnt vmcnt(10)
    s_barrier
    s_add_u32 m0, s34, s40
    s_nop 0
    buffer_load_dwordx4 v4, s[8:11], s32 offen offset:0 sc1 lds
    buffer_load_dwordx4 v5, s[8:11], s32 offen offset:1024 sc1 lds
    buffer_load_dwordx4 v6, s[8:11], s32 offen offset:2048 sc1 lds
    buffer_load_dwordx4 v7, s[8:11], s32 offen offset:3072 sc1 lds
    s_add_u32 s32, s32, 128
    s_cmp_eq_u32 s32, 2048
    s_cselect_b32 s32, 0, s32
    s_add_u32 m0, s34, s41
    s_nop 0
    buffer_load_dwordx4 v8, s[12:15], s33 offen offset:0 lds
    buffer_load_dwordx4 v9, s[12:15], s33 offen offset:1024 lds
    s_add_u32 m0, s34, s42
    s_nop 0
    buffer_load_dwordx4 v10, s[12:15], s33 offen offset:0 lds
    buffer_load_dwordx4 v11, s[12:15], s33 offen offset:1024 lds
    s_add_u32 m0, s34, s43
    s_nop 0
    buffer_load_dwordx4 v12, s[12:15], s33 offen offset:0 lds
    buffer_load_dwordx4 v13, s[12:15], s33 offen offset:1024 lds
    s_add_u32 s33, s33, 393216
    s_cmp_eq_u32 s33, 6291456
    s_cselect_b32 s33, 0, s33
    s_add_u32 s34, s34, 40960
    s_cmp_eq_u32 s34, 122880
    s_cselect_b32 s34, 0, s34
    s_waitcnt vmcnt(10)
    s_barrier
    s_add_u32 m0, s34, s40
    s_nop 0
    buffer_load_dwordx4 v4, s[8:11], s32 offen offset:0 sc1 lds
    buffer_load_dwordx4 v5, s[8:11], s32 offen offset:1024 sc1 lds
    buffer_load_dwordx4 v6, s[8:11], s32 offen offset:2048 sc1 lds
    buffer_load_dwordx4 v7, s[8:11], s32 offen offset:3072 sc1 lds
    s_add_u32 s32, s32, 128
    s_cmp_eq_u32 s32, 2048
    s_cselect_b32 s32, 0, s32
    s_add_u32 m0, s34, s41
    s_nop 0
    buffer_load_dwordx4 v8, s[12:15], s33 offen offset:0 lds
    buffer_load_dwordx4 v9, s[12:15], s33 offen offset:1024 lds
    s_add_u32 m0, s34, s42
    s_nop 0
    buffer_load_dwordx4 v10, s[12:15], s33 offen offset:0 lds
    buffer_load_dwordx4 v11, s[12:15], s33 offen offset:1024 lds
    s_add_u32 m0, s34, s43
    s_nop 0
    buffer_load_dwordx4 v12, s[12:15], s33 offen offset:0 lds
    buffer_load_dwordx4 v13, s[12:15], s33 offen offset:1024 lds
    s_add_u32 s33, s33, 393216
    s_cmp_eq_u32 s33, 6291456
    s_cselect_b32 s33, 0, s33
    s_add_u32 s34, s34, 40960
    s_cmp_eq_u32 s34, 122880
    s_cselect_b32 s34, 0, s34
    s_waitcnt vmcnt(10)
    s_barrier
    s_add_u32 m0, s34, s40
    s_nop 0
    buffer_load_dwordx4 v4, s[8:11], s32 offen offset:0 sc1 lds
    buffer_load_dwordx4 v5, s[8:11], s32 offen offset:1024 sc1 lds
    buffer_load_dwordx4 v6, s[8:11], s32 offen offset:2048 sc1 lds
    buffer_load_dwordx4 v7, s[8:11], s32 offen offset:3072 sc1 lds
    s_add_u32 s32, s32, 128
    s_cmp_eq_u32 s32, 2048
    s_cselect_b32 s32, 0, s32
    s_add_u32 m0, s34, s41
    s_nop 0
    buffer_load_dwordx4 v8, s[12:15], s33 offen offset:0 lds
    buffer_load_dwordx4 v9, s[12:15], s33 offen offset:1024 lds
    s_add_u32 m0, s34, s42
    s_nop 0
    buffer_load_dwordx4 v10, s[12:15], s33 offen offset:0 lds
    buffer_load_dwordx4 v11, s[12:15], s33 offen offset:1024 lds
    s_add_u32 m0, s34, s43
    s_nop 0
    buffer_load_dwordx4 v12, s[12:15], s33 offen offset:0 lds
    buffer_load_dwordx4 v13, s[12:15], s33 offen offset:1024 lds
    s_add_u32 s33, s33, 393216
    s_cmp_eq_u32 s33, 6291456
    s_cselect_b32 s33, 0, s33
    s_add_u32 s34, s34, 40960
    s_cmp_eq_u32 s34, 122880
    s_cselect_b32 s34, 0, s34
    s_cmp_eq_u32 s3, 0
    s_cbranch_scc1 L_ar0_42
    v_mov_b32 v2, 0
    buffer_load_dword v22, v2, s[88:91], 0 offen sc1
    s_branch L_ar1_43
L_ar0_42:
    v_mov_b32 v3, 1
    s_mov_b32 s92, s62
    s_mov_b32 s93, s63
    s_mov_b32 s94, 256
    s_mov_b32 s95, 0x20000
    s_and_b32 s37, s2, 31
    s_lshl_b32 s37, s37, 2
    v_mov_b32 v2, 0
    s_mov_b64 exec, 1
    buffer_atomic_add v3, v2, s[92:95], s37 offen sc1
    s_mov_b64 exec, -1
L_ar1_43:
    s_waitcnt vmcnt(11)
    s_barrier
    s_add_u32 m0, s34, s40
    s_nop 0
    buffer_load_dwordx4 v4, s[8:11], s32 offen offset:0 sc1 lds
    buffer_load_dwordx4 v5, s[8:11], s32 offen offset:1024 sc1 lds
    buffer_load_dwordx4 v6, s[8:11], s32 offen offset:2048 sc1 lds
    buffer_load_dwordx4 v7, s[8:11], s32 offen offset:3072 sc1 lds
    s_add_u32 s32, s32, 128
    s_cmp_eq_u32 s32, 2048
    s_cselect_b32 s32, 0, s32
    s_add_u32 m0, s34, s41
    s_nop 0
    buffer_load_dwordx4 v8, s[12:15], s33 offen offset:0 lds
    buffer_load_dwordx4 v9, s[12:15], s33 offen offset:1024 lds
    s_add_u32 m0, s34, s42
    s_nop 0
    buffer_load_dwordx4 v10, s[12:15], s33 offen offset:0 lds
    buffer_load_dwordx4 v11, s[12:15], s33 offen offset:1024 lds
    s_add_u32 m0, s34, s43
    s_nop 0
    buffer_load_dwordx4 v12, s[12:15], s33 offen offset:0 lds
    buffer_load_dwordx4 v13, s[12:15], s33 offen offset:1024 lds
    s_add_u32 s33, s33, 393216
    s_cmp_eq_u32 s33, 6291456
    s_cselect_b32 s33, 0, s33
    s_add_u32 s34, s34, 40960
    s_cmp_eq_u32 s34, 122880
    s_cselect_b32 s34, 0, s34
    s_bfe_u32 s37, s2, 0x30003
    s_cmp_lg_u32 s37, 0
    s_cbranch_scc1 L_jc_44
    s_mov_b32 s28, s52
    s_mov_b32 s29, s53
    s_mov_b32 s30, 0x200000
    s_mov_b32 s31, 0x20000
    s_lshl_b32 s37, s2, 2
    s_add_u32 s37, s37, s3
    s_mul_i32 s37, s37, 2048
    v_lshrrev_b32 v2, 2, v1
    v_min_u32 v2, 15, v2
    v_lshlrev_b32 v2, 7, v2
    buffer_load_dword v22, v2, s[28:31], s37 offen
    s_mov_b32 s28, s56
    s_mov_b32 s29, s57
    s_mov_b32 s30, 0x700000
    s_mov_b32 s31, 0x20000
    s_lshl_b32 s37, s2, 2
    s_add_u32 s37, s37, s3
    s_mul_i32 s37, s37, 7168
    v_lshrrev_b32 v2, 0, v1
    v_min_u32 v2, 55, v2
    v_lshlrev_b32 v2, 7, v2
    buffer_load_dword v22, v2, s[28:31], s37 offen
L_jc_44:
    s_waitcnt vmcnt(11)
    s_barrier
    s_add_u32 m0, s34, s40
    s_nop 0
    buffer_load_dwordx4 v4, s[8:11], s32 offen offset:0 sc1 lds
    buffer_load_dwordx4 v5, s[8:11], s32 offen offset:1024 sc1 lds
    buffer_load_dwordx4 v6, s[8:11], s32 offen offset:2048 sc1 lds
    buffer_load_dwordx4 v7, s[8:11], s32 offen offset:3072 sc1 lds
    s_add_u32 s32, s32, 128
    s_cmp_eq_u32 s32, 2048
    s_cselect_b32 s32, 0, s32
    s_add_u32 m0, s34, s41
    s_nop 0
    buffer_load_dwordx4 v8, s[12:15], s33 offen offset:0 lds
    buffer_load_dwordx4 v9, s[12:15], s33 offen offset:1024 lds
    s_add_u32 m0, s34, s42
    s_nop 0
    buffer_load_dwordx4 v10, s[12:15], s33 offen offset:0 lds
    buffer_load_dwordx4 v11, s[12:15], s33 offen offset:1024 lds
    s_add_u32 m0, s34, s43
    s_nop 0
    buffer_load_dwordx4 v12, s[12:15], s33 offen offset:0 lds
    buffer_load_dwordx4 v13, s[12:15], s33 offen offset:1024 lds
    s_add_u32 s33, s33, 393216
    s_cmp_eq_u32 s33, 6291456
    s_cselect_b32 s33, 0, s33
    s_add_u32 s34, s34, 40960
    s_cmp_eq_u32 s34, 122880
    s_cselect_b32 s34, 0, s34
    s_bfe_u32 s37, s2, 0x30003
    s_cmp_lg_u32 s37, 1
    s_cbranch_scc1 L_jc_45
    s_mov_b32 s28, s52
    s_mov_b32 s29, s53
    s_mov_b32 s30, 0x200000
    s_mov_b32 s31, 0x20000
    s_lshl_b32 s37, s2, 2
    s_add_u32 s37, s37, s3
    s_mul_i32 s37, s37, 2048
    v_lshrrev_b32 v2, 2, v1
    v_min_u32 v2, 15, v2
    v_lshlrev_b32 v2, 7, v2
    buffer_load_dword v22, v2, s[28:31], s37 offen
    s_mov_b32 s28, s56
    s_mov_b32 s29, s57
    s_mov_b32 s30, 0x700000
    s_mov_b32 s31, 0x20000
    s_lshl_b32 s37, s2, 2
    s_add_u32 s37, s37, s3
    s_mul_i32 s37, s37, 7168
    v_lshrrev_b32 v2, 0, v1
    v_min_u32 v2, 55, v2
    v_lshlrev_b32 v2, 7, v2
    buffer_load_dword v22, v2, s[28:31], s37 offen
L_jc_45:
    s_waitcnt vmcnt(10)
    s_barrier
    s_add_u32 m0, s34, s40
    s_nop 0
    buffer_load_dwordx4 v4, s[8:11], s32 offen offset:0 sc1 lds
    buffer_load_dwordx4 v5, s[8:11], s32 offen offset:1024 sc1 lds
    buffer_load_dwordx4 v6, s[8:11], s32 offen offset:2048 sc1 lds
    buffer_load_dwordx4 v7, s[8:11], s32 offen offset:3072 sc1 lds
    s_add_u32 s32, s32, 128
    s_cmp_eq_u32 s32, 2048
    s_cselect_b32 s32, 0, s32
    s_add_u32 m0, s34, s41
    s_nop 0
    buffer_load_dwordx4 v8, s[12:15], s33 offen offset:0 lds
    buffer_load_dwordx4 v9, s[12:15], s33 offen offset:1024 lds
    s_add_u32 m0, s34, s42
    s_nop 0
    buffer_load_dwordx4 v10, s[12:15], s33 offen offset:0 lds
    buffer_load_dwordx4 v11, s[12:15], s33 offen offset:1024 lds
    s_add_u32 m0, s34, s43
    s_nop 0
    buffer_load_dwordx4 v12, s[12:15], s33 offen offset:0 lds
    buffer_load_dwordx4 v13, s[12:15], s33 offen offset:1024 lds
    s_add_u32 s33, s33, 393216
    s_cmp_eq_u32 s33, 6291456
    s_cselect_b32 s33, 0, s33
    s_add_u32 s34, s34, 40960
    s_cmp_eq_u32 s34, 122880
    s_cselect_b32 s34, 0, s34
    s_bfe_u32 s37, s2, 0x30003
    s_cmp_lg_u32 s37, 2
    s_cbranch_scc1 L_jc_46
    s_mov_b32 s28, s52
    s_mov_b32 s29, s53
    s_mov_b32 s30, 0x200000
    s_mov_b32 s31, 0x20000
    s_lshl_b32 s37, s2, 2
    s_add_u32 s37, s37, s3
    s_mul_i32 s37, s37, 2048
    v_lshrrev_b32 v2, 2, v1
    v_min_u32 v2, 15, v2
    v_lshlrev_b32 v2, 7, v2
    buffer_load_dword v22, v2, s[28:31], s37 offen
    s_mov_b32 s28, s56
    s_mov_b32 s29, s57
    s_mov_b32 s30, 0x700000
    s_mov_b32 s31, 0x20000
    s_lshl_b32 s37, s2, 2
    s_add_u32 s37, s37, s3
    s_mul_i32 s37, s37, 7168
    v_lshrrev_b32 v2, 0, v1
    v_min_u32 v2, 55, v2
    v_lshlrev_b32 v2, 7, v2
    buffer_load_dword v22, v2, s[28:31], s37 offen
L_jc_46:
    s_waitcnt vmcnt(10)
    s_barrier
    s_add_u32 m0, s34, s40
    s_nop 0
    buffer_load_dwordx4 v4, s[8:11], s32 offen offset:0 sc1 lds
    buffer_load_dwordx4 v5, s[8:11], s32 offen offset:1024 sc1 lds
    buffer_load_dwordx4 v6, s[8:11], s32 offen offset:2048 sc1 lds
    buffer_load_dwordx4 v7, s[8:11], s32 offen offset:3072 sc1 lds
    s_add_u32 s32, s32, 128
    s_cmp_eq_u32 s32, 2048
    s_cselect_b32 s32, 0, s32
    s_add_u32 m0, s34, s41
    s_nop 0
    buffer_load_dwordx4 v8, s[12:15], s33 offen offset:0 lds
    buffer_load_dwordx4 v9, s[12:15], s33 offen offset:1024 lds
    s_add_u32 m0, s34, s42
    s_nop 0
    buffer_load_dwordx4 v10, s[12:15], s33 offen offset:0 lds
    buffer_load_dwordx4 v11, s[12:15], s33 offen offset:1024 lds
    s_add_u32 m0, s34, s43
    s_nop 0
    buffer_load_dwordx4 v12, s[12:15], s33 offen offset:0 lds
    buffer_load_dwordx4 v13, s[12:15], s33 offen offset:1024 lds
    s_add_u32 s33, s33, 393216
    s_cmp_eq_u32 s33, 6291456
    s_cselect_b32 s33, 0, s33
    s_add_u32 s34, s34, 40960
    s_cmp_eq_u32 s34, 122880
    s_cselect_b32 s34, 0, s34
    s_bfe_u32 s37, s2, 0x30003
    s_cmp_lg_u32 s37, 3
    s_cbranch_scc1 L_jc_47
    s_mov_b32 s28, s52
    s_mov_b32 s29, s53
    s_mov_b32 s30, 0x200000
    s_mov_b32 s31, 0x20000
    s_lshl_b32 s37, s2, 2
    s_add_u32 s37, s37, s3
    s_mul_i32 s37, s37, 2048
    v_lshrrev_b32 v2, 2, v1
    v_min_u32 v2, 15, v2
    v_lshlrev_b32 v2, 7, v2
    buffer_load_dword v22, v2, s[28:31], s37 offen
    s_mov_b32 s28, s56
    s_mov_b32 s29, s57
    s_mov_b32 s30, 0x700000
    s_mov_b32 s31, 0x20000
    s_lshl_b32 s37, s2, 2
    s_add_u32 s37, s37, s3
    s_mul_i32 s37, s37, 7168
    v_lshrrev_b32 v2, 0, v1
    v_min_u32 v2, 55, v2
    v_lshlrev_b32 v2, 7, v2
    buffer_load_dword v22, v2, s[28:31], s37 offen
L_jc_47:
    s_waitcnt vmcnt(10)
    s_barrier
    s_add_u32 m0, s34, s40
    s_nop 0
    buffer_load_dwordx4 v4, s[8:11], s32 offen offset:0 sc1 lds
    buffer_load_dwordx4 v5, s[8:11], s32 offen offset:1024 sc1 lds
    buffer_load_dwordx4 v6, s[8:11], s32 offen offset:2048 sc1 lds
    buffer_load_dwordx4 v7, s[8:11], s32 offen offset:3072 sc1 lds
    s_add_u32 s32, s32, 128
    s_cmp_eq_u32 s32, 2048
    s_cselect_b32 s32, 0, s32
    s_add_u32 m0, s34, s41
    s_nop 0
    buffer_load_dwordx4 v8, s[12:15], s33 offen offset:0 lds
    buffer_load_dwordx4 v9, s[12:15], s33 offen offset:1024 lds
    s_add_u32 m0, s34, s42
    s_nop 0
    buffer_load_dwordx4 v10, s[12:15], s33 offen offset:0 lds
    buffer_load_dwordx4 v11, s[12:15], s33 offen offset:1024 lds
    s_add_u32 m0, s34, s43
    s_nop 0
    buffer_load_dwordx4 v12, s[12:15], s33 offen offset:0 lds
    buffer_load_dwordx4 v13, s[12:15], s33 offen offset:1024 lds
    s_add_u32 s33, s33, 393216
    s_cmp_eq_u32 s33, 6291456
    s_cselect_b32 s33, 0, s33
    s_add_u32 s34, s34, 40960
    s_cmp_eq_u32 s34, 122880
    s_cselect_b32 s34, 0, s34
    s_bfe_u32 s37, s2, 0x30003
    s_cmp_lg_u32 s37, 4
    s_cbranch_scc1 L_jc_48
    s_mov_b32 s28, s52
    s_mov_b32 s29, s53
    s_mov_b32 s30, 0x200000
    s_mov_b32 s31, 0x20000
    s_lshl_b32 s37, s2, 2
    s_add_u32 s37, s37, s3
    s_mul_i32 s37, s37, 2048
    v_lshrrev_b32 v2, 2, v1
    v_min_u32 v2, 15, v2
    v_lshlrev_b32 v2, 7, v2
    buffer_load_dword v22, v2, s[28:31], s37 offen
    s_mov_b32 s28, s56
    s_mov_b32 s29, s57
    s_mov_b32 s30, 0x700000
    s_mov_b32 s31, 0x20000
    s_lshl_b32 s37, s2, 2
    s_add_u32 s37, s37, s3
    s_mul_i32 s37, s37, 7168
    v_lshrrev_b32 v2, 0, v1
    v_min_u32 v2, 55, v2
    v_lshlrev_b32 v2, 7, v2
    buffer_load_dword v22, v2, s[28:31], s37 offen
L_jc_48:
    s_waitcnt vmcnt(10)
    s_barrier
    s_add_u32 m0, s34, s40
    s_nop 0
    buffer_load_dwordx4 v4, s[8:11], s32 offen offset:0 sc1 lds
    buffer_load_dwordx4 v5, s[8:11], s32 offen offset:1024 sc1 lds
    buffer_load_dwordx4 v6, s[8:11], s32 offen offset:2048 sc1 lds
    buffer_load_dwordx4 v7, s[8:11], s32 offen offset:3072 sc1 lds
    s_add_u32 s32, s32, 128
    s_cmp_eq_u32 s32, 2048
    s_cselect_b32 s32, 0, s32
    s_add_u32 m0, s34, s41
    s_nop 0
    buffer_load_dwordx4 v8, s[12:15], s33 offen offset:0 lds
    buffer_load_dwordx4 v9, s[12:15], s33 offen offset:1024 lds
    s_add_u32 m0, s34, s42
    s_nop 0
    buffer_load_dwordx4 v10, s[12:15], s33 offen offset:0 lds
    buffer_load_dwordx4 v11, s[12:15], s33 offen offset:1024 lds
    s_add_u32 m0, s34, s43
    s_nop 0
    buffer_load_dwordx4 v12, s[12:15], s33 offen offset:0 lds
    buffer_load_dwordx4 v13, s[12:15], s33 offen offset:1024 lds
    s_add_u32 s33, s33, 393216
    s_cmp_eq_u32 s33, 6291456
    s_cselect_b32 s33, 0, s33
    s_add_u32 s34, s34, 40960
    s_cmp_eq_u32 s34, 122880
    s_cselect_b32 s34, 0, s34
    s_bfe_u32 s37, s2, 0x30003
    s_cmp_lg_u32 s37, 5
    s_cbranch_scc1 L_jc_49
    s_mov_b32 s28, s52
    s_mov_b32 s29, s53
    s_mov_b32 s30, 0x200000
    s_mov_b32 s31, 0x20000
    s_lshl_b32 s37, s2, 2
    s_add_u32 s37, s37, s3
    s_mul_i32 s37, s37, 2048
    v_lshrrev_b32 v2, 2, v1
    v_min_u32 v2, 15, v2
    v_lshlrev_b32 v2, 7, v2
    buffer_load_dword v22, v2, s[28:31], s37 offen
    s_mov_b32 s28, s56
    s_mov_b32 s29, s57
    s_mov_b32 s30, 0x700000
    s_mov_b32 s31, 0x20000
    s_lshl_b32 s37, s2, 2
    s_add_u32 s37, s37, s3
    s_mul_i32 s37, s37, 7168
    v_lshrrev_b32 v2, 0, v1
    v_min_u32 v2, 55, v2
    v_lshlrev_b32 v2, 7, v2
    buffer_load_dword v22, v2, s[28:31], s37 offen
L_jc_49:
    s_mov_b32 s92, s62
    s_mov_b32 s93, s63
    s_mov_b32 s94, 256
    s_mov_b32 s95, 0x20000
    v_and_b32 v2, 31, v1
    v_lshlrev_b32 v2, 2, v2
    s_mov_b32 s67, 0
    buffer_load_dword v23, v2, s[92:95], s67 offen sc1
    s_waitcnt vmcnt(11)
    s_barrier
    s_add_u32 m0, s34, s40
    s_nop 0
    buffer_load_dwordx4 v4, s[8:11], s32 offen offset:0 sc1 lds
    buffer_load_dwordx4 v5, s[8:11], s32 offen offset:1024 sc1 lds
    buffer_load_dwordx4 v6, s[8:11], s32 offen offset:2048 sc1 lds
    buffer_load_dwordx4 v7, s[8:11], s32 offen offset:3072 sc1 lds
    s_add_u32 s32, s32, 128
    s_cmp_eq_u32 s32, 2048
    s_cselect_b32 s32, 0, s32
    s_add_u32 m0, s34, s41
    s_nop 0
    buffer_load_dwordx4 v8, s[12:15], s33 offen offset:0 lds
    buffer_load_dwordx4 v9, s[12:15], s33 offen offset:1024 lds
    s_add_u32 m0, s34, s42
    s_nop 0
    buffer_load_dwordx4 v10, s[12:15], s33 offen offset:0 lds
    buffer_load_dwordx4 v11, s[12:15], s33 offen offset:1024 lds
    s_add_u32 m0, s34, s43
    s_nop 0
    buffer_load_dwordx4 v12, s[12:15], s33 offen offset:0 lds
    buffer_load_dwordx4 v13, s[12:15], s33 offen offset:1024 lds
    s_add_u32 s33, s33, 393216
    s_cmp_eq_u32 s33, 6291456
    s_cselect_b32 s33, 0, s33
    s_add_u32 s34, s34, 40960
    s_cmp_eq_u32 s34, 122880
    s_cselect_b32 s34, 0, s34
    s_bfe_u32 s37, s2, 0x30003
    s_cmp_lg_u32 s37, 6
    s_cbranch_scc1 L_jc_50
    s_mov_b32 s28, s52
    s_mov_b32 s29, s53
    s_mov_b32 s30, 0x200000
    s_mov_b32 s31, 0x20000
    s_lshl_b32 s37, s2, 2
    s_add_u32 s37, s37, s3
    s_mul_i32 s37, s37, 2048
    v_lshrrev_b32 v2, 2, v1
    v_min_u32 v2, 15, v2
    v_lshlrev_b32 v2, 7, v2
    buffer_load_dword v22, v2, s[28:31], s37 offen
    s_mov_b32 s28, s56
    s_mov_b32 s29, s57
    s_mov_b32 s30, 0x700000
    s_mov_b32 s31, 0x20000
    s_lshl_b32 s37, s2, 2
    s_add_u32 s37, s37, s3
    s_mul_i32 s37, s37, 7168
    v_lshrrev_b32 v2, 0, v1
    v_min_u32 v2, 55, v2
    v_lshlrev_b32 v2, 7, v2
    buffer_load_dword v22, v2, s[28:31], s37 offen
L_jc_50:
    s_waitcnt vmcnt(11)
    s_barrier
    s_add_u32 m0, s34, s40
    s_nop 0
    buffer_load_dwordx4 v4, s[8:11], s32 offen offset:0 sc1 lds
    buffer_load_dwordx4 v5, s[8:11], s32 offen offset:1024 sc1 lds
    buffer_load_dwordx4 v6, s[8:11], s32 offen offset:2048 sc1 lds
    buffer_load_dwordx4 v7, s[8:11], s32 offen offset:3072 sc1 lds
    s_add_u32 s32, s32, 128
    s_cmp_eq_u32 s32, 2048
    s_cselect_b32 s32, 0, s32
    s_add_u32 m0, s34, s41
    s_nop 0
    buffer_load_dwordx4 v8, s[12:15], s33 offen offset:0 lds
    buffer_load_dwordx4 v9, s[12:15], s33 offen offset:1024 lds
    s_add_u32 m0, s34, s42
    s_nop 0
    buffer_load_dwordx4 v10, s[12:15], s33 offen offset:0 lds
    buffer_load_dwordx4 v11, s[12:15], s33 offen offset:1024 lds
    s_add_u32 m0, s34, s43
    s_nop 0
    buffer_load_dwordx4 v12, s[12:15], s33 offen offset:0 lds
    buffer_load_dwordx4 v13, s[12:15], s33 offen offset:1024 lds
    s_add_u32 s33, s33, 393216
    s_cmp_eq_u32 s33, 6291456
    s_cselect_b32 s33, 0, s33
    s_add_u32 s34, s34, 40960
    s_cmp_eq_u32 s34, 122880
    s_cselect_b32 s34, 0, s34
    s_bfe_u32 s37, s2, 0x30003
    s_cmp_lg_u32 s37, 7
    s_cbranch_scc1 L_jc_51
    s_mov_b32 s28, s52
    s_mov_b32 s29, s53
    s_mov_b32 s30, 0x200000
    s_mov_b32 s31, 0x20000
    s_lshl_b32 s37, s2, 2
    s_add_u32 s37, s37, s3
    s_mul_i32 s37, s37, 2048
    v_lshrrev_b32 v2, 2, v1
    v_min_u32 v2, 15, v2
    v_lshlrev_b32 v2, 7, v2
    buffer_load_dword v22, v2, s[28:31], s37 offen
    s_mov_b32 s28, s56
    s_mov_b32 s29, s57
    s_mov_b32 s30, 0x700000
    s_mov_b32 s31, 0x20000
    s_lshl_b32 s37, s2, 2
    s_add_u32 s37, s37, s3
    s_mul_i32 s37, s37, 7168
    v_lshrrev_b32 v2, 0, v1
    v_min_u32 v2, 55, v2
    v_lshlrev_b32 v2, 7, v2
    buffer_load_dword v22, v2, s[28:31], s37 offen
L_jc_51:
    s_waitcnt vmcnt(10)
    s_barrier
    s_add_u32 m0, s34, s40
    s_nop 0
    buffer_load_dwordx4 v4, s[8:11], s32 offen offset:0 sc1 lds
    buffer_load_dwordx4 v5, s[8:11], s32 offen offset:1024 sc1 lds
    buffer_load_dwordx4 v6, s[8:11], s32 offen offset:2048 sc1 lds
    buffer_load_dwordx4 v7, s[8:11], s32 offen offset:3072 sc1 lds
    s_add_u32 s32, s32, 128
    s_cmp_eq_u32 s32, 2048
    s_cselect_b32 s32, 0, s32
    s_add_u32 m0, s34, s41
    s_nop 0
    buffer_load_dwordx4 v8, s[12:15], s33 offen offset:0 lds
    buffer_load_dwordx4 v9, s[12:15], s33 offen offset:1024 lds
    s_add_u32 m0, s34, s42
    s_nop 0
    buffer_load_dwordx4 v10, s[12:15], s33 offen offset:0 lds
    buffer_load_dwordx4 v11, s[12:15], s33 offen offset:1024 lds
    s_add_u32 m0, s34, s43
    s_nop 0
    buffer_load_dwordx4 v12, s[12:15], s33 offen offset:0 lds
    buffer_load_dwordx4 v13, s[12:15], s33 offen offset:1024 lds
    s_add_u32 s33, s33, 393216
    s_cmp_eq_u32 s33, 6291456
    s_cselect_b32 s33, 0, s33
    s_add_u32 s34, s34, 40960
    s_cmp_eq_u32 s34, 122880
    s_cselect_b32 s34, 0, s34
    v_cmp_le_u32 vcc, 8, v23
    s_nop 0
    s_cmp_eq_u64 vcc, -1
    s_cbranch_scc1 L_lzd_52
    s_mov_b32 s92, s62
    s_mov_b32 s93, s63
    s_mov_b32 s94, 256
    s_mov_b32 s95, 0x20000
    v_and_b32 v2, 31, v1
    v_lshlrev_b32 v2, 2, v2
    s_mov_b32 s67, 0
    s_mov_b32 s68, 400000
L_lzs_53:
    buffer_load_dword v23, v2, s[92:95], s67 offen sc1
    s_waitcnt vmcnt(0)
    v_cmp_le_u32 vcc, 8, v23
    s_nop 0
    s_cmp_eq_u64 vcc, -1
    s_cbranch_scc1 L_lzd_52
    s_sleep 1
    s_sub_u32 s68, s68, 1
    s_cmp_lg_u32 s68, 0
    s_cbranch_scc1 L_lzs_53
    s_mov_b32 s92, s62
    s_mov_b32 s93, s63
    s_mov_b32 s94, 256
    s_mov_b32 s95, 0x20000
    v_mov_b32 v23, 0x300
    v_mov_b32 v2, 252
    buffer_store_dword v23, v2, s[92:95], 0 offen
L_lzd_52:
    s_add_u32 s20, s64, 0x3c00000
    s_addc_u32 s21, s65, 0
    s_mov_b32 s22, 0x40000
    s_mov_b32 s23, 0x20000
    v_and_b32 v3, 0xff, v0
    v_lshrrev_b32 v2, 1, v3
    v_lshlrev_b32 v2, 3, v2
    v_and_b32 v3, 1, v3
    v_lshl_add_u32 v2, v3, 17, v2
    s_lshl_b32 s37, s4, 10
    buffer_load_dwordx2 v[44:45], v2, s[20:23], s37 offen sc1
    s_add_u32 s37, s37, 16384
    buffer_load_dwordx2 v[46:47], v2, s[20:23], s37 offen sc1
    s_add_u32 s37, s37, 16384
    buffer_load_dwordx2 v[48:49], v2, s[20:23], s37 offen sc1
    s_add_u32 s37, s37, 16384
    buffer_load_dwordx2 v[50:51], v2, s[20:23], s37 offen sc1
    s_add_u32 s37, s37, 16384
    buffer_load_dwordx2 v[52:53], v2, s[20:23], s37 offen sc1
    s_add_u32 s37, s37, 16384
    buffer_load_dwordx2 v[54:55], v2, s[20:23], s37 offen sc1
    s_add_u32 s37, s37, 16384
    buffer_load_dwordx2 v[56:57], v2, s[20:23], s37 offen sc1
    s_add_u32 s37, s37, 16384
    buffer_load_dwordx2 v[58:59], v2, s[20:23], s37 offen sc1
    s_add_u32 s28, s64, 0x3e00000
    s_addc_u32 s29, s65, 0
    s_mov_b32 s30, 0x30000
    s_mov_b32 s31, 0x20000
    v_and_b32 v24, 0xff, v0
    v_lshrrev_b32 v2, 6, v24
    v_lshlrev_b32 v2, 10, v2
    v_and_b32 v3, 63, v24
    v_add_u32 v2, v2, v3
    s_lshl_b32 s37, s5, 6
    v_add_u32 v2, s37, v2
    v_lshlrev_b32 v2, 2, v2
    v_min_u32 v2, 12284, v2
    v_mov_b32 v60, v2
    s_mov_b32 s37, 0
    buffer_load_dword v28, v2, s[28:31], s37 offen sc1
    s_add_u32 s37, s37, 12288
    buffer_load_dword v29, v2, s[28:31], s37 offen sc1
    s_add_u32 s37, s37, 12288
    buffer_load_dword v30, v2, s[28:31], s37 offen sc1
    s_add_u32 s37, s37, 12288
    buffer_load_dword v31, v2, s[28:31], s37 offen sc1
    s_add_u32 s37, s37, 12288
    buffer_load_dword v32, v2, s[28:31], s37 offen sc1
    s_add_u32 s37, s37, 12288
    buffer_load_dword v33, v2, s[28:31], s37 offen sc1
    s_add_u32 s37, s37, 12288
    buffer_load_dword v34, v2, s[28:31], s37 offen sc1
    s_add_u32 s37, s37, 12288
    buffer_load_dword v35, v2, s[28:31], s37 offen sc1
    s_add_u32 s37, s37, 12288
    buffer_load_dword v36, v2, s[28:31], s37 offen sc1
    s_add_u32 s37, s37, 12288
    buffer_load_dword v37, v2, s[28:31], s37 offen sc1
    s_add_u32 s37, s37, 12288
    buffer_load_dword v38, v2, s[28:31], s37 offen sc1
    s_add_u32 s37, s37, 12288
    buffer_load_dword v39, v2, s[28:31], s37 offen sc1
    s_add_u32 s37, s37, 12288
    buffer_load_dword v40, v2, s[28:31], s37 offen sc1
    s_add_u32 s37, s37, 12288
    buffer_load_dword v41, v2, s[28:31], s37 offen sc1
    s_add_u32 s37, s37, 12288
    buffer_load_dword v42, v2, s[28:31], s37 offen sc1
    s_add_u32 s37, s37, 12288
    buffer_load_dword v43, v2, s[28:31], s37 offen sc1
    s_waitcnt vmcnt(34)
    s_barrier
    s_add_u32 m0, s34, s40
    s_nop 0
    buffer_load_dwordx4 v4, s[8:11], s32 offen offset:0 sc1 lds
    buffer_load_dwordx4 v5, s[8:11], s32 offen offset:1024 sc1 lds
    buffer_load_dwordx4 v6, s[8:11], s32 offen offset:2048 sc1 lds
    buffer_load_dwordx4 v7, s[8:11], s32 offen offset:3072 sc1 lds
    s_add_u32 s32, s32, 128
    s_cmp_eq_u32 s32, 2048
    s_cselect_b32 s32, 0, s32
    s_add_u32 m0, s34, s41
    s_nop 0
    buffer_load_dwordx4 v8, s[12:15], s33 offen offset:0 lds
    buffer_load_dwordx4 v9, s[12:15], s33 offen offset:1024 lds
    s_add_u32 m0, s34, s42
    s_nop 0
    buffer_load_dwordx4 v10, s[12:15], s33 offen offset:0 lds
    buffer_load_dwordx4 v11, s[12:15], s33 offen offset:1024 lds
    s_add_u32 m0, s34, s43
    s_nop 0
    buffer_load_dwordx4 v12, s[12:15], s33 offen offset:0 lds
    buffer_load_dwordx4 v13, s[12:15], s33 offen offset:1024 lds
    s_add_u32 s33, s33, 393216
    s_cmp_eq_u32 s33, 6291456
    s_cselect_b32 s33, 0, s33
    s_add_u32 s34, s34, 40960
    s_cmp_eq_u32 s34, 122880
    s_cselect_b32 s34, 0, s34
    s_waitcnt vmcnt(34)
    s_barrier
    s_waitcnt vmcnt(10)
    s_setprio 1
    v_add_f32 v44, v44, v52
    v_add_f32 v45, v45, v53
    v_add_f32 v46, v46, v54
    v_add_f32 v47, v47, v55
    v_add_f32 v48, v48, v56
    v_add_f32 v49, v49, v57
    v_add_f32 v50, v50, v58
    v_add_f32 v51, v51, v59
    v_add_f32 v44, v44, v48
    v_add_f32 v45, v45, v49
    v_add_f32 v46, v46, v50
    v_add_f32 v47, v47, v51
    v_add_f32 v44, v44, v46
    v_add_f32 v45, v45, v47
    s_nop 0
    v_add_f32_dpp v44, v44, v44 quad_perm:[1,0,3,2] row_mask:0xf bank_mask:0xf
    v_add_f32_dpp v45, v45, v45 quad_perm:[1,0,3,2] row_mask:0xf bank_mask:0xf
    v_mul_f32 v48, 0xba800000, v44
    v_mul_f32 v49, 0x3a800000, v45
    v_fma_f32 v49, -v48, v48, v49
    v_max_f32 v49, 0, v49
    v_add_f32 v49, 0x3727c5ac, v49
    v_rsq_f32 v50, v49
    v_and_b32 v2, 0xfe, v0
    v_lshlrev_b32 v2, 1, v2
    v_add_u32 v2, 151552, v2
    ds_write_b32 v2, v48
    ds_write_b32 v2, v50 offset:512
    v_add_f32 v28, v28, v36
    v_add_f32 v29, v29, v37
    v_add_f32 v30, v30, v38
    v_add_f32 v31, v31, v39
    v_add_f32 v32, v32, v40
    v_add_f32 v33, v33, v41
    v_add_f32 v34, v34, v42
    v_add_f32 v35, v35, v43
    v_add_f32 v28, v28, v32
    v_add_f32 v29, v29, v33
    v_add_f32 v30, v30, v34
    v_add_f32 v31, v31, v35
    v_add_f32 v28, v28, v30
    v_add_f32 v29, v29, v31
    v_add_f32 v28, v28, v29
    v_lshlrev_b32 v2, 2, v24
    v_add_u32 v2, 154624, v2
    ds_write_b32 v2, v28
    s_cmp_lg_u32 s4, 0
    s_cbranch_scc1 L_csf_54
    s_add_u32 s28, s64, 0x3e80000
    s_addc_u32 s29, s65, 0
    s_mov_b32 s30, 0x3000
    s_mov_b32 s31, 0x20000
    v_cmp_gt_u32 vcc, 192, v24
    s_nop 0
    s_and_saveexec_b64 s[96:97], vcc
    s_cbranch_execz L_csz_55
    buffer_store_dword v28, v60, s[28:31], 0 offen sc1
L_csz_55:
    s_mov_b64 exec, -1
L_csf_54:
    s_setprio 0
    s_waitcnt lgkmcnt(0)
    s_waitcnt vmcnt(0)
    s_barrier
    s_waitcnt vmcnt(0) lgkmcnt(0)
    s_barrier
    s_and_b32 s37, s2, 3
    s_lshl_b32 s37, s37, 2
    s_bfe_u32 s38, s2, 0x20003
    s_add_u32 s4, s37, s38
    s_bfe_u32 s37, s2, 0x10002
    s_lshl_b32 s37, s37, 3
    s_lshr_b32 s38, s2, 5
    s_add_u32 s5, s37, s38
    s_add_u32 s8, s64, 0xf00000
    s_addc_u32 s9, s65, 0
    s_mov_b32 s10, 0x400000
    s_mov_b32 s11, 0x20000
    s_mov_b32 s12, s52
    s_mov_b32 s13, s53
    s_mov_b32 s14, 0x200000
    s_mov_b32 s15, 0x20000
    s_mov_b32 s20, s48
    s_mov_b32 s21, s49
    s_mov_b32 s22, 0x400000
    s_mov_b32 s23, 0x20000
    s_lshl_b32 s37, s3, 4
    s_mul_i32 s37, s37, 2048
    s_mul_i32 s38, s5, 128
    s_add_u32 s37, s37, s38
    v_lshrrev_b32 v2, 3, v1
    v_mul_u32_u24 v2, 2048, v2
    v_add_u32 v2, s37, v2
    v_lshrrev_b32 v3, 3, v1
    v_and_b32 v3, 2, v3
    v_xor_b32 v3, v1, v3
    v_and_b32 v3, 7, v3
    v_lshl_add_u32 v8, v3, 4, v2
    v_lshrrev_b32 v3, 3, v1
    v_and_b32 v3, 2, v3
    v_add_u32 v3, 4, v3
    v_xor_b32 v3, v1, v3
    v_and_b32 v3, 7, v3
    v_lshl_add_u32 v9, v3, 4, v2
    v_add_u32 v9, 0x3c00, v9
    s_lshl_b32 s40, s3, 12
    s_lshl_b32 s41, s3, 11
    s_add_u32 s41, s41, 16384
    s_mov_b32 s32, 0
    s_mov_b32 s33, 0
    s_add_u32 m0, s41, 0
    s_nop 0
    buffer_load_dwordx4 v8, s[12:15], s33 offen offset:0 lds
    buffer_load_dwordx4 v9, s[12:15], s33 offen offset:1024 lds
    s_add_u32 s33, s33, 131072
    s_add_u32 m0, s41, 24576
    s_nop 0
    buffer_load_dwordx4 v8, s[12:15], s33 offen offset:0 lds
    buffer_load_dwordx4 v9, s[12:15], s33 offen offset:1024 lds
    s_add_u32 s33, s33, 131072
    s_add_u32 m0, s41, 49152
    s_nop 0
    buffer_load_dwordx4 v8, s[12:15], s33 offen offset:0 lds
    buffer_load_dwordx4 v9, s[12:15], s33 offen offset:1024 lds
    s_add_u32 s33, s33, 131072
    s_add_u32 m0, s41, 73728
    s_nop 0
    buffer_load_dwordx4 v8, s[12:15], s33 offen offset:0 lds
    buffer_load_dwordx4 v9, s[12:15], s33 offen offset:1024 lds
    s_add_u32 s33, s33, 131072
    s_add_u32 m0, s41, 98304
    s_nop 0
    buffer_load_dwordx4 v8, s[12:15], s33 offen offset:0 lds
    buffer_load_dwordx4 v9, s[12:15], s33 offen offset:1024 lds
    s_add_u32 s33, s33, 131072
    s_bfe_u32 s37, s2, 0x20003
    s_lshl_b32 s37, s37, 8
    s_lshl_b32 s38, s3, 6
    s_add_u32 s37, s37, s38
    v_add_u32 v21, s37, v1
    v_lshlrev_b32 v21, 11, v21
    s_lshl_b32 s37, s5, 7
    buffer_load_dword v22, v21, s[12:15], s37 offen
    s_lshl_b32 s37, s4, 7
    s_lshl_b32 s38, s3, 5
    s_add_u32 s37, s37, s38
    s_mul_i32 s37, s37, 2048
    v_lshrrev_b32 v2, 3, v1
    v_mul_u32_u24 v2, 2048, v2
    v_add_u32 v2, s37, v2
    v_lshrrev_b32 v3, 4, v1
    v_xor_b32 v3, v1, v3
    v_and_b32 v3, 7, v3
    v_lshl_add_u32 v4, v3, 4, v2
    v_lshrrev_b32 v3, 4, v1
    v_add_u32 v3, 4, v3
    v_xor_b32 v3, v1, v3
    v_and_b32 v3, 7, v3
    v_lshl_add_u32 v5, v3, 4, v2
    v_add_u32 v5, 0x3c00, v5
    v_lshrrev_b32 v3, 4, v1
    v_xor_b32 v3, v1, v3
    v_and_b32 v3, 7, v3
    v_lshl_add_u32 v6, v3, 4, v2
    v_add_u32 v6, 0x7800, v6
    v_lshrrev_b32 v3, 4, v1
    v_add_u32 v3, 4, v3
    v_xor_b32 v3, v1, v3
    v_and_b32 v3, 7, v3
    v_lshl_add_u32 v7, v3, 4, v2
    v_add_u32 v7, 0xb400, v7
    s_lshl_b32 s37, s4, 7
    s_lshl_b32 s38, s3, 5
    s_add_u32 s37, s37, s38
    s_mul_i32 s37, s37, 2048
    v_lshrrev_b32 v2, 3, v1
    v_mul_u32_u24 v2, 2048, v2
    v_add_u32 v2, s37, v2
    v_lshrrev_b32 v3, 4, v1
    v_xor_b32 v3, v1, v3
    v_and_b32 v3, 7, v3
    v_lshl_add_u32 v15, v3, 4, v2
    v_lshrrev_b32 v3, 4, v1
    v_add_u32 v3, 4, v3
    v_xor_b32 v3, v1, v3
    v_and_b32 v3, 7, v3
    v_lshl_add_u32 v16, v3, 4, v2
    v_add_u32 v16, 0x3c00, v16
    v_lshrrev_b32 v3, 4, v1
    v_xor_b32 v3, v1, v3
    v_and_b32 v3, 7, v3
    v_lshl_add_u32 v17, v3, 4, v2
    v_add_u32 v17, 0x7800, v17
    v_lshrrev_b32 v3, 4, v1
    v_add_u32 v3, 4, v3
    v_xor_b32 v3, v1, v3
    v_and_b32 v3, 7, v3
    v_lshl_add_u32 v18, v3, 4, v2
    v_add_u32 v18, 0xb400, v18
    s_barrier
    s_cmp_lg_u32 s3, 0
    s_cbranch_scc1 L_np_56
    s_bfe_u32 s69, s2, 0x20001
    s_lshl_b32 s69, s69, 2
    s_lshr_b32 s67, s2, 6
    s_add_u32 s69, s69, s67
    s_lshl_b32 s67, s69, 12
    s_add_u32 s67, s67, 0
    v_and_b32 v19, 31, v1
    v_lshlrev_b32 v19, 7, v19
    s_mov_b32 s68, 400000
L_poll_57:
    buffer_load_dword v20, v19, s[88:91], s67 offen sc1
    s_waitcnt vmcnt(0)
    v_cmp_ne_u32 vcc, 0, v20
    s_nop 0
    s_cmp_eq_u64 vcc, -1
    s_cbranch_scc1 L_polld_58
    s_sleep 1
    s_sub_u32 s68, s68, 1
    s_cmp_lg_u32 s68, 0
    s_cbranch_scc1 L_poll_57
    s_mov_b32 s92, s62
    s_mov_b32 s93, s63
    s_mov_b32 s94, 256
    s_mov_b32 s95, 0x20000
    v_mov_b32 v20, 512
    v_mov_b32 v19, 0
    buffer_store_dword v20, v19, s[92:95], 0 offen
L_polld_58:
L_np_56:
    s_barrier
    s_barrier
    s_cmp_lg_u32 s3, 0
    s_cbranch_scc1 L_np_59
    s_lshl_b32 s67, s4, 12
    s_add_u32 s67, s67, 65536
    v_and_b32 v19, 15, v1
    v_lshlrev_b32 v19, 7, v19
    s_mov_b32 s68, 400000
L_poll_60:
    buffer_load_dword v20, v19, s[88:91], s67 offen sc1
    s_waitcnt vmcnt(0)
    v_cmp_ne_u32 vcc, 0, v20
    s_nop 0
    s_cmp_eq_u64 vcc, -1
    s_cbranch_scc1 L_polld_61
    s_sleep 1
    s_sub_u32 s68, s68, 1
    s_cmp_lg_u32 s68, 0
    s_cbranch_scc1 L_poll_60
    s_mov_b32 s92, s62
    s_mov_b32 s93, s63
    s_mov_b32 s94, 256
    s_mov_b32 s95, 0x20000
    v_mov_b32 v20, 257
    v_mov_b32 v19, 0
    buffer_store_dword v20, v19, s[92:95], 0 offen
L_polld_61:
L_np_59:
    s_barrier
    s_mov_b32 s34, 0
    s_add_u32 m0, s40, 0
    s_nop 0
    buffer_load_dwordx4 v4, s[8:11], s32 offen offset:0 sc1 lds
    buffer_load_dwordx4 v5, s[8:11], s32 offen offset:1024 sc1 lds
    buffer_load_dwordx4 v6, s[8:11], s32 offen offset:2048 sc1 lds
    buffer_load_dwordx4 v7, s[8:11], s32 offen offset:3072 sc1 lds
    s_add_u32 s32, s32, 128
    s_add_u32 m0, s40, 24576
    s_nop 0
    buffer_load_dwordx4 v4, s[8:11], s32 offen offset:0 sc1 lds
    buffer_load_dwordx4 v5, s[8:11], s32 offen offset:1024 sc1 lds
    buffer_load_dwordx4 v6, s[8:11], s32 offen offset:2048 sc1 lds
    buffer_load_dwordx4 v7, s[8:11], s32 offen offset:3072 sc1 lds
    s_add_u32 s32, s32, 128
    s_waitcnt vmcnt(4)
    s_barrier
    s_add_u32 m0, s40, 49152
    s_nop 0
    buffer_load_dwordx4 v4, s[8:11], s32 offen offset:0 sc1 lds
    buffer_load_dwordx4 v5, s[8:11], s32 offen offset:1024 sc1 lds
    buffer_load_dwordx4 v6, s[8:11], s32 offen offset:2048 sc1 lds
    buffer_load_dwordx4 v7, s[8:11], s32 offen offset:3072 sc1 lds
    s_add_u32 s32, s32, 128
    s_add_u32 m0, s40, 73728
    s_nop 0
    buffer_load_dwordx4 v4, s[8:11], s32 offen offset:0 sc1 lds
    buffer_load_dwordx4 v5, s[8:11], s32 offen offset:1024 sc1 lds
    buffer_load_dwordx4 v6, s[8:11], s32 offen offset:2048 sc1 lds
    buffer_load_dwordx4 v7, s[8:11], s32 offen offset:3072 sc1 lds
    s_add_u32 s32, s32, 128
    s_waitcnt vmcnt(8)
    s_barrier
    s_add_u32 m0, s40, 98304
    s_nop 0
    buffer_load_dwordx4 v4, s[8:11], s32 offen offset:0 sc1 lds
    buffer_load_dwordx4 v5, s[8:11], s32 offen offset:1024 sc1 lds
    buffer_load_dwordx4 v6, s[8:11], s32 offen offset:2048 sc1 lds
    buffer_load_dwordx4 v7, s[8:11], s32 offen offset:3072 sc1 lds
    s_add_u32 s32, s32, 128
    s_add_u32 m0, s34, s40
    s_nop 0
    buffer_load_dwordx4 v4, s[8:11], s32 offen offset:0 sc1 lds
    buffer_load_dwordx4 v5, s[8:11], s32 offen offset:1024 sc1 lds
    buffer_load_dwordx4 v6, s[8:11], s32 offen offset:2048 sc1 lds
    buffer_load_dwordx4 v7, s[8:11], s32 offen offset:3072 sc1 lds
    s_add_u32 s32, s32, 128
    s_add_u32 m0, s34, s41
    s_nop 0
    buffer_load_dwordx4 v8, s[12:15], s33 offen offset:0 lds
    buffer_load_dwordx4 v9, s[12:15], s33 offen offset:1024 lds
    s_add_u32 s33, s33, 131072
    s_add_u32 s34, s34, 24576
    s_cmp_eq_u32 s34, 122880
    s_cselect_b32 s34, 0, s34
    s_waitcnt vmcnt(14)
    s_barrier
    s_add_u32 m0, s34, s40
    s_nop 0
    buffer_load_dwordx4 v4, s[8:11], s32 offen offset:0 sc1 lds
    buffer_load_dwordx4 v5, s[8:11], s32 offen offset:1024 sc1 lds
    buffer_load_dwordx4 v6, s[8:11], s32 offen offset:2048 sc1 lds
    buffer_load_dwordx4 v7, s[8:11], s32 offen offset:3072 sc1 lds
    s_add_u32 s32, s32, 128
    s_add_u32 m0, s34, s41
    s_nop 0
    buffer_load_dwordx4 v8, s[12:15], s33 offen offset:0 lds
    buffer_load_dwordx4 v9, s[12:15], s33 offen offset:1024 lds
    s_add_u32 s33, s33, 131072
    s_add_u32 s34, s34, 24576
    s_cmp_eq_u32 s34, 122880
    s_cselect_b32 s34, 0, s34
    s_waitcnt vmcnt(16)
    s_barrier
    s_mov_b32 s35, 8
L_ld_62:
    s_add_u32 m0, s34, s40
    s_nop 0
    buffer_load_dwordx4 v4, s[8:11], s32 offen offset:0 sc1 lds
    buffer_load_dwordx4 v5, s[8:11], s32 offen offset:1024 sc1 lds
    buffer_load_dwordx4 v6, s[8:11], s32 offen offset:2048 sc1 lds
    buffer_load_dwordx4 v7, s[8:11], s32 offen offset:3072 sc1 lds
    s_add_u32 s32, s32, 128
    s_add_u32 m0, s34, s41
    s_nop 0
    buffer_load_dwordx4 v8, s[12:15], s33 offen offset:0 lds
    buffer_load_dwordx4 v9, s[12:15], s33 offen offset:1024 lds
    s_add_u32 s33, s33, 131072
    s_add_u32 s34, s34, 24576
    s_cmp_eq_u32 s34, 122880
    s_cselect_b32 s34, 0, s34
    s_waitcnt vmcnt(18)
    s_barrier
    s_sub_u32 s35, s35, 1
    s_cmp_lg_u32 s35, 0
    s_cbranch_scc1 L_ld_62
    s_add_u32 m0, s34, s40
    s_nop 0
    buffer_load_dwordx4 v4, s[8:11], s32 offen offset:0 sc1 lds
    buffer_load_dwordx4 v5, s[8:11], s32 offen offset:1024 sc1 lds
    buffer_load_dwordx4 v6, s[8:11], s32 offen offset:2048 sc1 lds
    buffer_load_dwordx4 v7, s[8:11], s32 offen offset:3072 sc1 lds
    s_add_u32 s32, s32, 128
    s_add_u32 m0, s34, s41
    s_nop 0
    buffer_load_dwordx4 v8, s[12:15], s33 offen offset:0 lds
    buffer_load_dwordx4 v9, s[12:15], s33 offen offset:1024 lds
    s_add_u32 s33, s33, 131072
    s_add_u32 s34, s34, 24576
    s_cmp_eq_u32 s34, 122880
    s_cselect_b32 s34, 0, s34
    s_lshl_b32 s37, s5, 7
    s_lshl_b32 s38, s3, 12
    s_add_u32 m0, s38, 135168
    s_nop 0
    buffer_load_dwordx4 v15, s[20:23], s37 offen offset:0 sc1 lds
    buffer_load_dwordx4 v16, s[20:23], s37 offen offset:1024 sc1 lds
    buffer_load_dwordx4 v17, s[20:23], s37 offen offset:2048 sc1 lds
    buffer_load_dwordx4 v18, s[20:23], s37 offen offset:3072 sc1 lds
    s_waitcnt vmcnt(22)
    s_barrier
    s_waitcnt vmcnt(16)
    s_barrier
    s_waitcnt vmcnt(10)
    s_barrier
    s_waitcnt vmcnt(4)
    s_barrier
    s_waitcnt vmcnt(0) lgkmcnt(0)
    s_barrier
    s_barrier
    s_and_b32 s37, s2, 1
    s_lshl_b32 s37, s37, 3
    s_bfe_u32 s38, s2, 0x30003
    s_add_u32 s4, s37, s38
    s_bfe_u32 s37, s2, 0x20001
    s_lshl_b32 s37, s37, 2
    s_lshr_b32 s38, s2, 6
    s_add_u32 s5, s37, s38
    s_mov_b32 s8, s64
    s_mov_b32 s9, s65
    s_mov_b32 s10, 0x400000
    s_mov_b32 s11, 0x20000
    s_mov_b32 s12, s56
    s_mov_b32 s13, s57
    s_mov_b32 s14, 0x700000
    s_mov_b32 s15, 0x20000
    s_add_u32 s20, s64, 0x3c40000
    s_addc_u32 s21, s65, 0
    s_mov_b32 s22, 0x40000
    s_mov_b32 s23, 0x20000
    s_lshl_b32 s37, s3, 4
    s_mul_i32 s37, s37, 7168
    s_lshr_b32 s38, s5, 1
    s_mul_i32 s38, s38, 896
    s_and_b32 s66, s5, 1
    s_lshl_b32 s66, s66, 9
    s_add_u32 s38, s38, s66
    s_and_b32 s66, s5, 1
    s_mul_i32 s66, s66, -448
    s_add_u32 s66, s66, 384
    s_add_u32 s37, s37, s38
    v_lshrrev_b32 v2, 3, v1
    v_mul_u32_u24 v2, 7168, v2
    v_add_u32 v2, s37, v2
    v_lshrrev_b32 v3, 3, v1
    v_and_b32 v3, 2, v3
    v_xor_b32 v3, v1, v3
    v_and_b32 v3, 7, v3
    v_lshl_add_u32 v8, v3, 4, v2
    v_lshl_add_u32 v10, v3, 4, v2
    v_add_u32 v10, 0x80, v10
    v_lshl_add_u32 v12, v3, 4, v2
    v_add_u32 v12, 0x100, v12
    v_lshrrev_b32 v3, 3, v1
    v_and_b32 v3, 2, v3
    v_add_u32 v3, 4, v3
    v_xor_b32 v3, v1, v3
    v_and_b32 v3, 7, v3
    v_lshl_add_u32 v9, v3, 4, v2
    v_add_u32 v9, 0xdc00, v9
    v_lshl_add_u32 v11, v3, 4, v2
    v_add_u32 v11, 0xdc80, v11
    v_lshl_add_u32 v13, v3, 4, v2
    v_add_u32 v13, 0xdd00, v13
    v_lshrrev_b32 v2, 2, v1
    v_mul_u32_u24 v2, 7168, v2
    v_add_u32 v2, s37, v2
    v_lshrrev_b32 v3, 4, v1
    v_and_b32 v3, 2, v3
    v_xor_b32 v3, v1, v3
    v_and_b32 v3, 3, v3
    v_lshl_add_u32 v14, v3, 4, v2
    v_add_u32 v14, s66, v14
    s_lshl_b32 s40, s3, 12
    s_lshl_b32 s41, s3, 11
    s_add_u32 s41, s41, 16384
    s_lshl_b32 s42, s3, 11
    s_add_u32 s42, s42, 24576
    s_lshl_b32 s43, s3, 11
    s_add_u32 s43, s43, 32768
    s_lshl_b32 s44, s3, 10
    s_add_u32 s44, s44, 40960
    s_add_u32 s37, s4, s5
    s_and_b32 s37, s37, 15
    s_lshl_b32 s32, s37, 7
    s_mul_i32 s33, s37, 458752
    s_add_u32 m0, s41, 0
    s_nop 0
    buffer_load_dwordx4 v8, s[12:15], s33 offen offset:0 lds
    buffer_load_dwordx4 v9, s[12:15], s33 offen offset:1024 lds
    s_add_u32 m0, s42, 0
    s_nop 0
    buffer_load_dwordx4 v10, s[12:15], s33 offen offset:0 lds
    buffer_load_dwordx4 v11, s[12:15], s33 offen offset:1024 lds
    s_add_u32 m0, s43, 0
    s_nop 0
    buffer_load_dwordx4 v12, s[12:15], s33 offen offset:0 lds
    buffer_load_dwordx4 v13, s[12:15], s33 offen offset:1024 lds
    s_add_u32 m0, s44, 0
    s_nop 0
    buffer_load_dwordx4 v14, s[12:15], s33 offen lds
    s_add_u32 s33, s33, 458752
    s_cmp_eq_u32 s33, 7340032
    s_cselect_b32 s33, 0, s33
    s_add_u32 m0, s41, 45056
    s_nop 0
    buffer_load_dwordx4 v8, s[12:15], s33 offen offset:0 lds
    buffer_load_dwordx4 v9, s[12:15], s33 offen offset:1024 lds
    s_add_u32 m0, s42, 45056
    s_nop 0
    buffer_load_dwordx4 v10, s[12:15], s33 offen offset:0 lds
    buffer_load_dwordx4 v11, s[12:15], s33 offen offset:1024 lds
    s_add_u32 m0, s43, 45056
    s_nop 0
    buffer_load_dwordx4 v12, s[12:15], s33 offen offset:0 lds
    buffer_load_dwordx4 v13, s[12:15], s33 offen offset:1024 lds
    s_add_u32 m0, s44, 45056
    s_nop 0
    buffer_load_dwordx4 v14, s[12:15], s33 offen lds
    s_add_u32 s33, s33, 458752
    s_cmp_eq_u32 s33, 7340032
    s_cselect_b32 s33, 0, s33
    s_add_u32 m0, s41, 90112
    s_nop 0
    buffer_load_dwordx4 v8, s[12:15], s33 offen offset:0 lds
    buffer_load_dwordx4 v9, s[12:15], s33 offen offset:1024 lds
    s_add_u32 m0, s42, 90112
    s_nop 0
    buffer_load_dwordx4 v10, s[12:15], s33 offen offset:0 lds
    buffer_load_dwordx4 v11, s[12:15], s33 offen offset:1024 lds
    s_add_u32 m0, s43, 90112
    s_nop 0
    buffer_load_dwordx4 v12, s[12:15], s33 offen offset:0 lds
    buffer_load_dwordx4 v13, s[12:15], s33 offen offset:1024 lds
    s_add_u32 m0, s44, 90112
    s_nop 0
    buffer_load_dwordx4 v14, s[12:15], s33 offen lds
    s_add_u32 s33, s33, 458752
    s_cmp_eq_u32 s33, 7340032
    s_cselect_b32 s33, 0, s33
    s_lshl_b32 s37, s4, 7
    s_lshl_b32 s38, s3, 5
    s_add_u32 s37, s37, s38
    s_mul_i32 s37, s37, 2048
    v_lshrrev_b32 v2, 3, v1
    v_mul_u32_u24 v2, 2048, v2
    v_add_u32 v2, s37, v2
    v_lshrrev_b32 v3, 4, v1
    v_xor_b32 v3, v1, v3
    v_and_b32 v3, 7, v3
    v_lshl_add_u32 v4, v3, 4, v2
    v_lshrrev_b32 v3, 4, v1
    v_add_u32 v3, 4, v3
    v_xor_b32 v3, v1, v3
    v_and_b32 v3, 7, v3
    v_lshl_add_u32 v5, v3, 4, v2
    v_add_u32 v5, 0x3c00, v5
    v_lshrrev_b32 v3, 4, v1
    v_xor_b32 v3, v1, v3
    v_and_b32 v3, 7, v3
    v_lshl_add_u32 v6, v3, 4, v2
    v_add_u32 v6, 0x7800, v6
    v_lshrrev_b32 v3, 4, v1
    v_add_u32 v3, 4, v3
    v_xor_b32 v3, v1, v3
    v_and_b32 v3, 7, v3
    v_lshl_add_u32 v7, v3, 4, v2
    v_add_u32 v7, 0xb400, v7
    s_cmp_lg_u32 s3, 0
    s_cbranch_scc1 L_np_63
    s_lshl_b32 s67, s4, 12
    s_add_u32 s67, s67, 131072
    v_and_b32 v19, 15, v1
    v_lshlrev_b32 v19, 7, v19
    s_mov_b32 s68, 400000
L_poll_64:
    buffer_load_dword v20, v19, s[88:91], s67 offen sc1
    s_waitcnt vmcnt(0)
    v_cmp_ne_u32 vcc, 0, v20
    s_nop 0
    s_cmp_eq_u64 vcc, -1
    s_cbranch_scc1 L_polld_65
    s_sleep 1
    s_sub_u32 s68, s68, 1
    s_cmp_lg_u32 s68, 0
    s_cbranch_scc1 L_poll_64
    s_mov_b32 s92, s62
    s_mov_b32 s93, s63
    s_mov_b32 s94, 256
    s_mov_b32 s95, 0x20000
    v_mov_b32 v20, 258
    v_mov_b32 v19, 0
    buffer_store_dword v20, v19, s[92:95], 0 offen
L_polld_65:
L_np_63:
    s_barrier
    s_mov_b32 s34, 0
    s_add_u32 m0, s40, 0
    s_nop 0
    buffer_load_dwordx4 v4, s[8:11], s32 offen offset:0 sc1 lds
    buffer_load_dwordx4 v5, s[8:11], s32 offen offset:1024 sc1 lds
    buffer_load_dwordx4 v6, s[8:11], s32 offen offset:2048 sc1 lds
    buffer_load_dwordx4 v7, s[8:11], s32 offen offset:3072 sc1 lds
    s_add_u32 s32, s32, 128
    s_cmp_eq_u32 s32, 2048
    s_cselect_b32 s32, 0, s32
    s_add_u32 m0, s40, 45056
    s_nop 0
    buffer_load_dwordx4 v4, s[8:11], s32 offen offset:0 sc1 lds
    buffer_load_dwordx4 v5, s[8:11], s32 offen offset:1024 sc1 lds
    buffer_load_dwordx4 v6, s[8:11], s32 offen offset:2048 sc1 lds
    buffer_load_dwordx4 v7, s[8:11], s32 offen offset:3072 sc1 lds
    s_add_u32 s32, s32, 128
    s_cmp_eq_u32 s32, 2048
    s_cselect_b32 s32, 0, s32
    s_waitcnt vmcnt(4)
    s_barrier
    s_add_u32 m0, s40, 90112
    s_nop 0
    buffer_load_dwordx4 v4, s[8:11], s32 offen offset:0 sc1 lds
    buffer_load_dwordx4 v5, s[8:11], s32 offen offset:1024 sc1 lds
    buffer_load_dwordx4 v6, s[8:11], s32 offen offset:2048 sc1 lds
    buffer_load_dwordx4 v7, s[8:11], s32 offen offset:3072 sc1 lds
    s_add_u32 s32, s32, 128
    s_cmp_eq_u32 s32, 2048
    s_cselect_b32 s32, 0, s32
    s_waitcnt vmcnt(4)
    s_barrier
    s_add_u32 m0, s34, s40
    s_nop 0
    buffer_load_dwordx4 v4, s[8:11], s32 offen offset:0 sc1 lds
    buffer_load_dwordx4 v5, s[8:11], s32 offen offset:1024 sc1 lds
    buffer_load_dwordx4 v6, s[8:11], s32 offen offset:2048 sc1 lds
    buffer_load_dwordx4 v7, s[8:11], s32 offen offset:3072 sc1 lds
    s_add_u32 s32, s32, 128
    s_cmp_eq_u32 s32, 2048
    s_cselect_b32 s32, 0, s32
    s_add_u32 m0, s34, s41
    s_nop 0
    buffer_load_dwordx4 v8, s[12:15], s33 offen offset:0 lds
    buffer_load_dwordx4 v9, s[12:15], s33 offen offset:1024 lds
    s_add_u32 m0, s34, s42
    s_nop 0
    buffer_load_dwordx4 v10, s[12:15], s33 offen offset:0 lds
    buffer_load_dwordx4 v11, s[12:15], s33 offen offset:1024 lds
    s_add_u32 m0, s34, s43
    s_nop 0
    buffer_load_dwordx4 v12, s[12:15], s33 offen offset:0 lds
    buffer_load_dwordx4 v13, s[12:15], s33 offen offset:1024 lds
    s_add_u32 m0, s34, s44
    s_nop 0
    buffer_load_dwordx4 v14, s[12:15], s33 offen lds
    s_add_u32 s33, s33, 458752
    s_cmp_eq_u32 s33, 7340032
    s_cselect_b32 s33, 0, s33
    s_add_u32 s34, s34, 45056
    s_cmp_eq_u32 s34, 135168
    s_cselect_b32 s34, 0, s34
    s_waitcnt vmcnt(11)
    s_barrier
    s_add_u32 m0, s34, s40
    s_nop 0
    buffer_load_dwordx4 v4, s[8:11], s32 offen offset:0 sc1 lds
    buffer_load_dwordx4 v5, s[8:11], s32 offen offset:1024 sc1 lds
    buffer_load_dwordx4 v6, s[8:11], s32 offen offset:2048 sc1 lds
    buffer_load_dwordx4 v7, s[8:11], s32 offen offset:3072 sc1 lds
    s_add_u32 s32, s32, 128
    s_cmp_eq_u32 s32, 2048
    s_cselect_b32 s32, 0, s32
    s_add_u32 m0, s34, s41
    s_nop 0
    buffer_load_dwordx4 v8, s[12:15], s33 offen offset:0 lds
    buffer_load_dwordx4 v9, s[12:15], s33 offen offset:1024 lds
    s_add_u32 m0, s34, s42
    s_nop 0
    buffer_load_dwordx4 v10, s[12:15], s33 offen offset:0 lds
    buffer_load_dwordx4 v11, s[12:15], s33 offen offset:1024 lds
    s_add_u32 m0, s34, s43
    s_nop 0
    buffer_load_dwordx4 v12, s[12:15], s33 offen offset:0 lds
    buffer_load_dwordx4 v13, s[12:15], s33 offen offset:1024 lds
    s_add_u32 m0, s34, s44
    s_nop 0
    buffer_load_dwordx4 v14, s[12:15], s33 offen lds
    s_add_u32 s33, s33, 458752
    s_cmp_eq_u32 s33, 7340032
    s_cselect_b32 s33, 0, s33
    s_add_u32 s34, s34, 45056
    s_cmp_eq_u32 s34, 135168
    s_cselect_b32 s34, 0, s34
    s_bfe_u32 s37, s2, 0x30003
    s_cmp_lg_u32 s37, 0
    s_cbranch_scc1 L_jc_66
    s_mov_b32 s28, s58
    s_mov_b32 s29, s59
    s_mov_b32 s30, 0x700000
    s_mov_b32 s31, 0x20000
    s_lshl_b32 s37, s2, 2
    s_add_u32 s37, s37, s3
    s_mul_i32 s37, s37, 7168
    v_lshrrev_b32 v2, 0, v1
    v_min_u32 v2, 55, v2
    v_lshlrev_b32 v2, 7, v2
    buffer_load_dword v22, v2, s[28:31], s37 offen
L_jc_66:
    s_waitcnt vmcnt(11)
    s_barrier
    s_add_u32 m0, s34, s40
    s_nop 0
    buffer_load_dwordx4 v4, s[8:11], s32 offen offset:0 sc1 lds
    buffer_load_dwordx4 v5, s[8:11], s32 offen offset:1024 sc1 lds
    buffer_load_dwordx4 v6, s[8:11], s32 offen offset:2048 sc1 lds
    buffer_load_dwordx4 v7, s[8:11], s32 offen offset:3072 sc1 lds
    s_add_u32 s32, s32, 128
    s_cmp_eq_u32 s32, 2048
    s_cselect_b32 s32, 0, s32
    s_add_u32 m0, s34, s41
    s_nop 0
    buffer_load_dwordx4 v8, s[12:15], s33 offen offset:0 lds
    buffer_load_dwordx4 v9, s[12:15], s33 offen offset:1024 lds
    s_add_u32 m0, s34, s42
    s_nop 0
    buffer_load_dwordx4 v10, s[12:15], s33 offen offset:0 lds
    buffer_load_dwordx4 v11, s[12:15], s33 offen offset:1024 lds
    s_add_u32 m0, s34, s43
    s_nop 0
    buffer_load_dwordx4 v12, s[12:15], s33 offen offset:0 lds
    buffer_load_dwordx4 v13, s[12:15], s33 offen offset:1024 lds
    s_add_u32 m0, s34, s44
    s_nop 0
    buffer_load_dwordx4 v14, s[12:15], s33 offen lds
    s_add_u32 s33, s33, 458752
    s_cmp_eq_u32 s33, 7340032
    s_cselect_b32 s33, 0, s33
    s_add_u32 s34, s34, 45056
    s_cmp_eq_u32 s34, 135168
    s_cselect_b32 s34, 0, s34
    s_bfe_u32 s37, s2, 0x30003
    s_cmp_lg_u32 s37, 1
    s_cbranch_scc1 L_jc_67
    s_mov_b32 s28, s58
    s_mov_b32 s29, s59
    s_mov_b32 s30, 0x700000
    s_mov_b32 s31, 0x20000
    s_lshl_b32 s37, s2, 2
    s_add_u32 s37, s37, s3
    s_mul_i32 s37, s37, 7168
    v_lshrrev_b32 v2, 0, v1
    v_min_u32 v2, 55, v2
    v_lshlrev_b32 v2, 7, v2
    buffer_load_dword v22, v2, s[28:31], s37 offen
L_jc_67:
    s_cmp_eq_u32 s3, 0
    s_cbranch_scc1 L_ar0_68
    v_mov_b32 v2, 0
    buffer_load_dword v22, v2, s[88:91], 0 offen sc1
    s_branch L_ar1_69
L_ar0_68:
    v_mov_b32 v3, 1
    s_lshl_b32 s37, s5, 8
    s_lshl_b32 s38, s4, 2
    s_add_u32 s37, s37, s38
    s_add_u32 s37, s37, 655360
    v_mov_b32 v2, 0
    s_mov_b64 exec, 1
    buffer_store_dword v3, v2, s[88:91], s37 offen sc1
    s_mov_b64 exec, -1
L_ar1_69:
    s_waitcnt vmcnt(12)
    s_barrier
    s_add_u32 m0, s34, s40
    s_nop 0
    buffer_load_dwordx4 v4, s[8:11], s32 offen offset:0 sc1 lds
    buffer_load_dwordx4 v5, s[8:11], s32 offen offset:1024 sc1 lds
    buffer_load_dwordx4 v6, s[8:11], s32 offen offset:2048 sc1 lds
    buffer_load_dwordx4 v7, s[8:11], s32 offen offset:3072 sc1 lds
    s_add_u32 s32, s32, 128
    s_cmp_eq_u32 s32, 2048
    s_cselect_b32 s32, 0, s32
    s_add_u32 m0, s34, s41
    s_nop 0
    buffer_load_dwordx4 v8, s[12:15], s33 offen offset:0 lds
    buffer_load_dwordx4 v9, s[12:15], s33 offen offset:1024 lds
    s_add_u32 m0, s34, s42
    s_nop 0
    buffer_load_dwordx4 v10, s[12:15], s33 offen offset:0 lds
    buffer_load_dwordx4 v11, s[12:15], s33 offen offset:1024 lds
    s_add_u32 m0, s34, s43
    s_nop 0
    buffer_load_dwordx4 v12, s[12:15], s33 offen offset:0 lds
    buffer_load_dwordx4 v13, s[12:15], s33 offen offset:1024 lds
    s_add_u32 m0, s34, s44
    s_nop 0
    buffer_load_dwordx4 v14, s[12:15], s33 offen lds
    s_add_u32 s33, s33, 458752
    s_cmp_eq_u32 s33, 7340032
    s_cselect_b32 s33, 0, s33
    s_add_u32 s34, s34, 45056
    s_cmp_eq_u32 s34, 135168
    s_cselect_b32 s34, 0, s34
    s_bfe_u32 s37, s2, 0x30003
    s_cmp_lg_u32 s37, 2
    s_cbranch_scc1 L_jc_70
    s_mov_b32 s28, s58
    s_mov_b32 s29, s59
    s_mov_b32 s30, 0x700000
    s_mov_b32 s31, 0x20000
    s_lshl_b32 s37, s2, 2
    s_add_u32 s37, s37, s3
    s_mul_i32 s37, s37, 7168
    v_lshrrev_b32 v2, 0, v1
    v_min_u32 v2, 55, v2
    v_lshlrev_b32 v2, 7, v2
    buffer_load_dword v22, v2, s[28:31], s37 offen
L_jc_70:
    s_waitcnt vmcnt(12)
    s_barrier
    s_add_u32 m0, s34, s40
    s_nop 0
    buffer_load_dwordx4 v4, s[8:11], s32 offen offset:0 sc1 lds
    buffer_load_dwordx4 v5, s[8:11], s32 offen offset:1024 sc1 lds
    buffer_load_dwordx4 v6, s[8:11], s32 offen offset:2048 sc1 lds
    buffer_load_dwordx4 v7, s[8:11], s32 offen offset:3072 sc1 lds
    s_add_u32 s32, s32, 128
    s_cmp_eq_u32 s32, 2048
    s_cselect_b32 s32, 0, s32
    s_add_u32 m0, s34, s41
    s_nop 0
    buffer_load_dwordx4 v8, s[12:15], s33 offen offset:0 lds
    buffer_load_dwordx4 v9, s[12:15], s33 offen offset:1024 lds
    s_add_u32 m0, s34, s42
    s_nop 0
    buffer_load_dwordx4 v10, s[12:15], s33 offen offset:0 lds
    buffer_load_dwordx4 v11, s[12:15], s33 offen offset:1024 lds
    s_add_u32 m0, s34, s43
    s_nop 0
    buffer_load_dwordx4 v12, s[12:15], s33 offen offset:0 lds
    buffer_load_dwordx4 v13, s[12:15], s33 offen offset:1024 lds
    s_add_u32 m0, s34, s44
    s_nop 0
    buffer_load_dwordx4 v14, s[12:15], s33 offen lds
    s_add_u32 s33, s33, 458752
    s_cmp_eq_u32 s33, 7340032
    s_cselect_b32 s33, 0, s33
    s_add_u32 s34, s34, 45056
    s_cmp_eq_u32 s34, 135168
    s_cselect_b32 s34, 0, s34
    s_bfe_u32 s37, s2, 0x30003
    s_cmp_lg_u32 s37, 3
    s_cbranch_scc1 L_jc_71
    s_mov_b32 s28, s58
    s_mov_b32 s29, s59
    s_mov_b32 s30, 0x700000
    s_mov_b32 s31, 0x20000
    s_lshl_b32 s37, s2, 2
    s_add_u32 s37, s37, s3
    s_mul_i32 s37, s37, 7168
    v_lshrrev_b32 v2, 0, v1
    v_min_u32 v2, 55, v2
    v_lshlrev_b32 v2, 7, v2
    buffer_load_dword v22, v2, s[28:31], s37 offen
L_jc_71:
    s_waitcnt vmcnt(11)
    s_barrier
    s_add_u32 m0, s34, s40
    s_nop 0
    buffer_load_dwordx4 v4, s[8:11], s32 offen offset:0 sc1 lds
    buffer_load_dwordx4 v5, s[8:11], s32 offen offset:1024 sc1 lds
    buffer_load_dwordx4 v6, s[8:11], s32 offen offset:2048 sc1 lds
    buffer_load_dwordx4 v7, s[8:11], s32 offen offset:3072 sc1 lds
    s_add_u32 s32, s32, 128
    s_cmp_eq_u32 s32, 2048
    s_cselect_b32 s32, 0, s32
    s_add_u32 m0, s34, s41
    s_nop 0
    buffer_load_dwordx4 v8, s[12:15], s33 offen offset:0 lds
    buffer_load_dwordx4 v9, s[12:15], s33 offen offset:1024 lds
    s_add_u32 m0, s34, s42
    s_nop 0
    buffer_load_dwordx4 v10, s[12:15], s33 offen offset:0 lds
    buffer_load_dwordx4 v11, s[12:15], s33 offen offset:1024 lds
    s_add_u32 m0, s34, s43
    s_nop 0
    buffer_load_dwordx4 v12, s[12:15], s33 offen offset:0 lds
    buffer_load_dwordx4 v13, s[12:15], s33 offen offset:1024 lds
    s_add_u32 m0, s34, s44
    s_nop 0
    buffer_load_dwordx4 v14, s[12:15], s33 offen lds
    s_add_u32 s33, s33, 458752
    s_cmp_eq_u32 s33, 7340032
    s_cselect_b32 s33, 0, s33
    s_add_u32 s34, s34, 45056
    s_cmp_eq_u32 s34, 135168
    s_cselect_b32 s34, 0, s34
    s_bfe_u32 s37, s2, 0x30003
    s_cmp_lg_u32 s37, 4
    s_cbranch_scc1 L_jc_72
    s_mov_b32 s28, s58
    s_mov_b32 s29, s59
    s_mov_b32 s30, 0x700000
    s_mov_b32 s31, 0x20000
    s_lshl_b32 s37, s2, 2
    s_add_u32 s37, s37, s3
    s_mul_i32 s37, s37, 7168
    v_lshrrev_b32 v2, 0, v1
    v_min_u32 v2, 55, v2
    v_lshlrev_b32 v2, 7, v2
    buffer_load_dword v22, v2, s[28:31], s37 offen
L_jc_72:
    s_waitcnt vmcnt(11)
    s_barrier
    s_add_u32 m0, s34, s40
    s_nop 0
    buffer_load_dwordx4 v4, s[8:11], s32 offen offset:0 sc1 lds
    buffer_load_dwordx4 v5, s[8:11], s32 offen offset:1024 sc1 lds
    buffer_load_dwordx4 v6, s[8:11], s32 offen offset:2048 sc1 lds
    buffer_load_dwordx4 v7, s[8:11], s32 offen offset:3072 sc1 lds
    s_add_u32 s32, s32, 128
    s_cmp_eq_u32 s32, 2048
    s_cselect_b32 s32, 0, s32
    s_add_u32 m0, s34, s41
    s_nop 0
    buffer_load_dwordx4 v8, s[12:15], s33 offen offset:0 lds
    buffer_load_dwordx4 v9, s[12:15], s33 offen offset:1024 lds
    s_add_u32 m0, s34, s42
    s_nop 0
    buffer_load_dwordx4 v10, s[12:15], s33 offen offset:0 lds
    buffer_load_dwordx4 v11, s[12:15], s33 offen offset:1024 lds
    s_add_u32 m0, s34, s43
    s_nop 0
    buffer_load_dwordx4 v12, s[12:15], s33 offen offset:0 lds
    buffer_load_dwordx4 v13, s[12:15], s33 offen offset:1024 lds
    s_add_u32 m0, s34, s44
    s_nop 0
    buffer_load_dwordx4 v14, s[12:15], s33 offen lds
    s_add_u32 s33, s33, 458752
    s_cmp_eq_u32 s33, 7340032
    s_cselect_b32 s33, 0, s33
    s_add_u32 s34, s34, 45056
    s_cmp_eq_u32 s34, 135168
    s_cselect_b32 s34, 0, s34
    s_bfe_u32 s37, s2, 0x30003
    s_cmp_lg_u32 s37, 5
    s_cbranch_scc1 L_jc_73
    s_mov_b32 s28, s58
    s_mov_b32 s29, s59
    s_mov_b32 s30, 0x700000
    s_mov_b32 s31, 0x20000
    s_lshl_b32 s37, s2, 2
    s_add_u32 s37, s37, s3
    s_mul_i32 s37, s37, 7168
    v_lshrrev_b32 v2, 0, v1
    v_min_u32 v2, 55, v2
    v_lshlrev_b32 v2, 7, v2
    buffer_load_dword v22, v2, s[28:31], s37 offen
L_jc_73:
    s_waitcnt vmcnt(11)
    s_barrier
    s_add_u32 m0, s34, s40
    s_nop 0
    buffer_load_dwordx4 v4, s[8:11], s32 offen offset:0 sc1 lds
    buffer_load_dwordx4 v5, s[8:11], s32 offen offset:1024 sc1 lds
    buffer_load_dwordx4 v6, s[8:11], s32 offen offset:2048 sc1 lds
    buffer_load_dwordx4 v7, s[8:11], s32 offen offset:3072 sc1 lds
    s_add_u32 s32, s32, 128
    s_cmp_eq_u32 s32, 2048
    s_cselect_b32 s32, 0, s32
    s_add_u32 m0, s34, s41
    s_nop 0
    buffer_load_dwordx4 v8, s[12:15], s33 offen offset:0 lds
    buffer_load_dwordx4 v9, s[12:15], s33 offen offset:1024 lds
    s_add_u32 m0, s34, s42
    s_nop 0
    buffer_load_dwordx4 v10, s[12:15], s33 offen offset:0 lds
    buffer_load_dwordx4 v11, s[12:15], s33 offen offset:1024 lds
    s_add_u32 m0, s34, s43
    s_nop 0
    buffer_load_dwordx4 v12, s[12:15], s33 offen offset:0 lds
    buffer_load_dwordx4 v13, s[12:15], s33 offen offset:1024 lds
    s_add_u32 m0, s34, s44
    s_nop 0
    buffer_load_dwordx4 v14, s[12:15], s33 offen lds
    s_add_u32 s33, s33, 458752
    s_cmp_eq_u32 s33, 7340032
    s_cselect_b32 s33, 0, s33
    s_add_u32 s34, s34, 45056
    s_cmp_eq_u32 s34, 135168
    s_cselect_b32 s34, 0, s34
    s_bfe_u32 s37, s2, 0x30003
    s_cmp_lg_u32 s37, 6
    s_cbranch_scc1 L_jc_74
    s_mov_b32 s28, s58
    s_mov_b32 s29, s59
    s_mov_b32 s30, 0x700000
    s_mov_b32 s31, 0x20000
    s_lshl_b32 s37, s2, 2
    s_add_u32 s37, s37, s3
    s_mul_i32 s37, s37, 7168
    v_lshrrev_b32 v2, 0, v1
    v_min_u32 v2, 55, v2
    v_lshlrev_b32 v2, 7, v2
    buffer_load_dword v22, v2, s[28:31], s37 offen
L_jc_74:
    s_waitcnt vmcnt(11)
    s_barrier
    s_add_u32 m0, s34, s40
    s_nop 0
    buffer_load_dwordx4 v4, s[8:11], s32 offen offset:0 sc1 lds
    buffer_load_dwordx4 v5, s[8:11], s32 offen offset:1024 sc1 lds
    buffer_load_dwordx4 v6, s[8:11], s32 offen offset:2048 sc1 lds
    buffer_load_dwordx4 v7, s[8:11], s32 offen offset:3072 sc1 lds
    s_add_u32 s32, s32, 128
    s_cmp_eq_u32 s32, 2048
    s_cselect_b32 s32, 0, s32
    s_add_u32 m0, s34, s41
    s_nop 0
    buffer_load_dwordx4 v8, s[12:15], s33 offen offset:0 lds
    buffer_load_dwordx4 v9, s[12:15], s33 offen offset:1024 lds
    s_add_u32 m0, s34, s42
    s_nop 0
    buffer_load_dwordx4 v10, s[12:15], s33 offen offset:0 lds
    buffer_load_dwordx4 v11, s[12:15], s33 offen offset:1024 lds
    s_add_u32 m0, s34, s43
    s_nop 0
    buffer_load_dwordx4 v12, s[12:15], s33 offen offset:0 lds
    buffer_load_dwordx4 v13, s[12:15], s33 offen offset:1024 lds
    s_add_u32 m0, s34, s44
    s_nop 0
    buffer_load_dwordx4 v14, s[12:15], s33 offen lds
    s_add_u32 s33, s33, 458752
    s_cmp_eq_u32 s33, 7340032
    s_cselect_b32 s33, 0, s33
    s_add_u32 s34, s34, 45056
    s_cmp_eq_u32 s34, 135168
    s_cselect_b32 s34, 0, s34
    s_bfe_u32 s37, s2, 0x30003
    s_cmp_lg_u32 s37, 7
    s_cbranch_scc1 L_jc_75
    s_mov_b32 s28, s58
    s_mov_b32 s29, s59
    s_mov_b32 s30, 0x700000
    s_mov_b32 s31, 0x20000
    s_lshl_b32 s37, s2, 2
    s_add_u32 s37, s37, s3
    s_mul_i32 s37, s37, 7168
    v_lshrrev_b32 v2, 0, v1
    v_min_u32 v2, 55, v2
    v_lshlrev_b32 v2, 7, v2
    buffer_load_dword v22, v2, s[28:31], s37 offen
L_jc_75:
    v_and_b32 v2, 15, v1
    v_lshlrev_b32 v2, 2, v2
    s_lshl_b32 s67, s5, 8
    s_add_u32 s67, s67, 655360
    buffer_load_dword v23, v2, s[88:91], s67 offen sc1
    s_waitcnt vmcnt(12)
    s_barrier
    s_add_u32 m0, s34, s40
    s_nop 0
    buffer_load_dwordx4 v4, s[8:11], s32 offen offset:0 sc1 lds
    buffer_load_dwordx4 v5, s[8:11], s32 offen offset:1024 sc1 lds
    buffer_load_dwordx4 v6, s[8:11], s32 offen offset:2048 sc1 lds
    buffer_load_dwordx4 v7, s[8:11], s32 offen offset:3072 sc1 lds
    s_add_u32 s32, s32, 128
    s_cmp_eq_u32 s32, 2048
    s_cselect_b32 s32, 0, s32
    s_add_u32 m0, s34, s41
    s_nop 0
    buffer_load_dwordx4 v8, s[12:15], s33 offen offset:0 lds
    buffer_load_dwordx4 v9, s[12:15], s33 offen offset:1024 lds
    s_add_u32 m0, s34, s42
    s_nop 0
    buffer_load_dwordx4 v10, s[12:15], s33 offen offset:0 lds
    buffer_load_dwordx4 v11, s[12:15], s33 offen offset:1024 lds
    s_add_u32 m0, s34, s43
    s_nop 0
    buffer_load_dwordx4 v12, s[12:15], s33 offen offset:0 lds
    buffer_load_dwordx4 v13, s[12:15], s33 offen offset:1024 lds
    s_add_u32 m0, s34, s44
    s_nop 0
    buffer_load_dwordx4 v14, s[12:15], s33 offen lds
    s_add_u32 s33, s33, 458752
    s_cmp_eq_u32 s33, 7340032
    s_cselect_b32 s33, 0, s33
    s_add_u32 s34, s34, 45056
    s_cmp_eq_u32 s34, 135168
    s_cselect_b32 s34, 0, s34
    s_add_u32 s20, s64, 0x3c40000
    s_addc_u32 s21, s65, 0
    s_mov_b32 s22, 0x40000
    s_mov_b32 s23, 0x20000
    v_and_b32 v3, 0xff, v0
    v_lshrrev_b32 v2, 1, v3
    v_lshlrev_b32 v2, 3, v2
    v_and_b32 v3, 1, v3
    v_lshl_add_u32 v2, v3, 17, v2
    s_lshl_b32 s37, s4, 10
    buffer_load_dwordx2 v[44:45], v2, s[20:23], s37 offen sc1
    s_add_u32 s37, s37, 16384
    buffer_load_dwordx2 v[46:47], v2, s[20:23], s37 offen sc1
    s_add_u32 s37, s37, 16384
    buffer_load_dwordx2 v[48:49], v2, s[20:23], s37 offen sc1
    s_add_u32 s37, s37, 16384
    buffer_load_dwordx2 v[50:51], v2, s[20:23], s37 offen sc1
    s_add_u32 s37, s37, 16384
    buffer_load_dwordx2 v[52:53], v2, s[20:23], s37 offen sc1
    s_add_u32 s37, s37, 16384
    buffer_load_dwordx2 v[54:55], v2, s[20:23], s37 offen sc1
    s_add_u32 s37, s37, 16384
    buffer_load_dwordx2 v[56:57], v2, s[20:23], s37 offen sc1
    s_add_u32 s37, s37, 16384
    buffer_load_dwordx2 v[58:59], v2, s[20:23], s37 offen sc1
    s_waitcnt vmcnt(20)
    s_barrier
    s_add_u32 m0, s34, s40
    s_nop 0
    buffer_load_dwordx4 v4, s[8:11], s32 offen offset:0 sc1 lds
    buffer_load_dwordx4 v5, s[8:11], s32 offen offset:1024 sc1 lds
    buffer_load_dwordx4 v6, s[8:11], s32 offen offset:2048 sc1 lds
    buffer_load_dwordx4 v7, s[8:11], s32 offen offset:3072 sc1 lds
    s_add_u32 s32, s32, 128
    s_cmp_eq_u32 s32, 2048
    s_cselect_b32 s32, 0, s32
    s_add_u32 m0, s34, s41
    s_nop 0
    buffer_load_dwordx4 v8, s[12:15], s33 offen offset:0 lds
    buffer_load_dwordx4 v9, s[12:15], s33 offen offset:1024 lds
    s_add_u32 m0, s34, s42
    s_nop 0
    buffer_load_dwordx4 v10, s[12:15], s33 offen offset:0 lds
    buffer_load_dwordx4 v11, s[12:15], s33 offen offset:1024 lds
    s_add_u32 m0, s34, s43
    s_nop 0
    buffer_load_dwordx4 v12, s[12:15], s33 offen offset:0 lds
    buffer_load_dwordx4 v13, s[12:15], s33 offen offset:1024 lds
    s_add_u32 m0, s34, s44
    s_nop 0
    buffer_load_dwordx4 v14, s[12:15], s33 offen lds
    s_add_u32 s33, s33, 458752
    s_cmp_eq_u32 s33, 7340032
    s_cselect_b32 s33, 0, s33
    s_add_u32 s34, s34, 45056
    s_cmp_eq_u32 s34, 135168
    s_cselect_b32 s34, 0, s34
    s_waitcnt vmcnt(19)
    s_barrier
    s_add_u32 m0, s34, s40
    s_nop 0
    buffer_load_dwordx4 v4, s[8:11], s32 offen offset:0 sc1 lds
    buffer_load_dwordx4 v5, s[8:11], s32 offen offset:1024 sc1 lds
    buffer_load_dwordx4 v6, s[8:11], s32 offen offset:2048 sc1 lds
    buffer_load_dwordx4 v7, s[8:11], s32 offen offset:3072 sc1 lds
    s_add_u32 s32, s32, 128
    s_cmp_eq_u32 s32, 2048
    s_cselect_b32 s32, 0, s32
    s_add_u32 m0, s34, s41
    s_nop 0
    buffer_load_dwordx4 v8, s[12:15], s33 offen offset:0 lds
    buffer_load_dwordx4 v9, s[12:15], s33 offen offset:1024 lds
    s_add_u32 m0, s34, s42
    s_nop 0
    buffer_load_dwordx4 v10, s[12:15], s33 offen offset:0 lds
    buffer_load_dwordx4 v11, s[12:15], s33 offen offset:1024 lds
    s_add_u32 m0, s34, s43
    s_nop 0
    buffer_load_dwordx4 v12, s[12:15], s33 offen offset:0 lds
    buffer_load_dwordx4 v13, s[12:15], s33 offen offset:1024 lds
    s_add_u32 m0, s34, s44
    s_nop 0
    buffer_load_dwordx4 v14, s[12:15], s33 offen lds
    s_add_u32 s33, s33, 458752
    s_cmp_eq_u32 s33, 7340032
    s_cselect_b32 s33, 0, s33
    s_add_u32 s34, s34, 45056
    s_cmp_eq_u32 s34, 135168
    s_cselect_b32 s34, 0, s34
    v_cmp_ne_u32 vcc, 0, v23
    s_nop 0
    s_cmp_eq_u64 vcc, -1
    s_cbranch_scc1 L_lzd_76
    v_and_b32 v2, 15, v1
    v_lshlrev_b32 v2, 2, v2
    s_lshl_b32 s67, s5, 8
    s_add_u32 s67, s67, 655360
    s_mov_b32 s68, 400000
L_lzs_77:
    buffer_load_dword v23, v2, s[88:91], s67 offen sc1
    s_waitcnt vmcnt(0)
    v_cmp_ne_u32 vcc, 0, v23
    s_nop 0
    s_cmp_eq_u64 vcc, -1
    s_cbranch_scc1 L_lzd_76
    s_sleep 1
    s_sub_u32 s68, s68, 1
    s_cmp_lg_u32 s68, 0
    s_cbranch_scc1 L_lzs_77
    s_mov_b32 s92, s62
    s_mov_b32 s93, s63
    s_mov_b32 s94, 256
    s_mov_b32 s95, 0x20000
    v_mov_b32 v23, 0x300
    v_mov_b32 v2, 252
    buffer_store_dword v23, v2, s[92:95], 0 offen
L_lzd_76:
    s_add_u32 s28, s64, 0x3e40000
    s_addc_u32 s29, s65, 0
    s_mov_b32 s30, 0x38000
    s_mov_b32 s31, 0x20000
    v_and_b32 v24, 0xff, v0
    s_lshr_b32 s37, s5, 1
    s_mul_i32 s37, s37, 896
    s_and_b32 s66, s5, 1
    s_lshl_b32 s66, s66, 9
    s_add_u32 s37, s37, s66
    s_and_b32 s66, s5, 1
    s_mul_i32 s66, s66, -448
    s_add_u32 s66, s66, 384
    s_add_u32 s38, s37, s66
    s_sub_u32 s38, s38, 384
    v_mov_b32 v2, s37
    v_mov_b32 v3, s38
    v_cmp_le_u32 vcc, 192, v24
    s_nop 1
    v_cndmask_b32 v2, v2, v3, vcc
    v_lshl_add_u32 v2, v24, 1, v2
    v_lshlrev_b32 v2, 1, v2
    v_min_u32 v2, 14332, v2
    v_mov_b32 v60, v2
    s_mov_b32 s37, 0
    buffer_load_dword v28, v2, s[28:31], s37 offen sc1
    s_add_u32 s37, s37, 14336
    buffer_load_dword v29, v2, s[28:31], s37 offen sc1
    s_add_u32 s37, s37, 14336
    buffer_load_dword v30, v2, s[28:31], s37 offen sc1
    s_add_u32 s37, s37, 14336
    buffer_load_dword v31, v2, s[28:31], s37 offen sc1
    s_add_u32 s37, s37, 14336
    buffer_load_dword v32, v2, s[28:31], s37 offen sc1
    s_add_u32 s37, s37, 14336
    buffer_load_dword v33, v2, s[28:31], s37 offen sc1
    s_add_u32 s37, s37, 14336
    buffer_load_dword v34, v2, s[28:31], s37 offen sc1
    s_add_u32 s37, s37, 14336
    buffer_load_dword v35, v2, s[28:31], s37 offen sc1
    s_add_u32 s37, s37, 14336
    buffer_load_dword v36, v2, s[28:31], s37 offen sc1
    s_add_u32 s37, s37, 14336
    buffer_load_dword v37, v2, s[28:31], s37 offen sc1
    s_add_u32 s37, s37, 14336
    buffer_load_dword v38, v2, s[28:31], s37 offen sc1
    s_add_u32 s37, s37, 14336
    buffer_load_dword v39, v2, s[28:31], s37 offen sc1
    s_add_u32 s37, s37, 14336
    buffer_load_dword v40, v2, s[28:31], s37 offen sc1
    s_add_u32 s37, s37, 14336
    buffer_load_dword v41, v2, s[28:31], s37 offen sc1
    s_add_u32 s37, s37, 14336
    buffer_load_dword v42, v2, s[28:31], s37 offen sc1
    s_add_u32 s37, s37, 14336
    buffer_load_dword v43, v2, s[28:31], s37 offen sc1
    s_waitcnt vmcnt(27)
    s_barrier
    s_add_u32 m0, s34, s40
    s_nop 0
    buffer_load_dwordx4 v4, s[8:11], s32 offen offset:0 sc1 lds
    buffer_load_dwordx4 v5, s[8:11], s32 offen offset:1024 sc1 lds
    buffer_load_dwordx4 v6, s[8:11], s32 offen offset:2048 sc1 lds
    buffer_load_dwordx4 v7, s[8:11], s32 offen offset:3072 sc1 lds
    s_add_u32 s32, s32, 128
    s_cmp_eq_u32 s32, 2048
    s_cselect_b32 s32, 0, s32
    s_add_u32 m0, s34, s41
    s_nop 0
    buffer_load_dwordx4 v8, s[12:15], s33 offen offset:0 lds
    buffer_load_dwordx4 v9, s[12:15], s33 offen offset:1024 lds
    s_add_u32 m0, s34, s42
    s_nop 0
    buffer_load_dwordx4 v10, s[12:15], s33 offen offset:0 lds
    buffer_load_dwordx4 v11, s[12:15], s33 offen offset:1024 lds
    s_add_u32 m0, s34, s43
    s_nop 0
    buffer_load_dwordx4 v12, s[12:15], s33 offen offset:0 lds
    buffer_load_dwordx4 v13, s[12:15], s33 offen offset:1024 lds
    s_add_u32 m0, s34, s44
    s_nop 0
    buffer_load_dwordx4 v14, s[12:15], s33 offen lds
    s_add_u32 s33, s33, 458752
    s_cmp_eq_u32 s33, 7340032
    s_cselect_b32 s33, 0, s33
    s_add_u32 s34, s34, 45056
    s_cmp_eq_u32 s34, 135168
    s_cselect_b32 s34, 0, s34
    s_waitcnt vmcnt(27)
    s_barrier
    s_waitcnt vmcnt(11)
    s_setprio 1
    v_add_f32 v44, v44, v52
    v_add_f32 v45, v45, v53
    v_add_f32 v46, v46, v54
    v_add_f32 v47, v47, v55
    v_add_f32 v48, v48, v56
    v_add_f32 v49, v49, v57
    v_add_f32 v50, v50, v58
    v_add_f32 v51, v51, v59
    v_add_f32 v44, v44, v48
    v_add_f32 v45, v45, v49
    v_add_f32 v46, v46, v50
    v_add_f32 v47, v47, v51
    v_add_f32 v44, v44, v46
    v_add_f32 v45, v45, v47
    s_nop 0
    v_add_f32_dpp v44, v44, v44 quad_perm:[1,0,3,2] row_mask:0xf bank_mask:0xf
    v_add_f32_dpp v45, v45, v45 quad_perm:[1,0,3,2] row_mask:0xf bank_mask:0xf
    v_mul_f32 v48, 0xba800000, v44
    v_mul_f32 v49, 0x3a800000, v45
    v_fma_f32 v49, -v48, v48, v49
    v_max_f32 v49, 0, v49
    v_add_f32 v49, 0x3727c5ac, v49
    v_rsq_f32 v50, v49
    v_and_b32 v2, 0xfe, v0
    v_lshlrev_b32 v2, 1, v2
    v_add_u32 v2, 151552, v2
    ds_write_b32 v2, v48
    v_sqrt_f32 v51, v49
    v_mul_f32 v50, 0xbfb8aa3b, v50
    ds_write_b32 v2, v50 offset:512
    ds_write_b32 v2, v51 offset:1024
    v_add_f32 v28, v28, v36
    v_add_f32 v29, v29, v37
    v_add_f32 v30, v30, v38
    v_add_f32 v31, v31, v39
    v_add_f32 v32, v32, v40
    v_add_f32 v33, v33, v41
    v_add_f32 v34, v34, v42
    v_add_f32 v35, v35, v43
    v_add_f32 v28, v28, v32
    v_add_f32 v29, v29, v33
    v_add_f32 v30, v30, v34
    v_add_f32 v31, v31, v35
    v_add_f32 v28, v28, v30
    v_add_f32 v29, v29, v31
    v_add_f32 v28, v28, v29
    v_lshlrev_b32 v2, 2, v24
    v_add_u32 v2, 154624, v2
    ds_write_b32 v2, v28
    s_cmp_lg_u32 s4, 0
    s_cbranch_scc1 L_csf_78
    s_add_u32 s28, s64, 0x3e84000
    s_addc_u32 s29, s65, 0
    s_mov_b32 s30, 0x3800
    s_mov_b32 s31, 0x20000
    v_cmp_gt_u32 vcc, 224, v24
    s_nop 0
    s_and_saveexec_b64 s[96:97], vcc
    s_cbranch_execz L_csz_79
    buffer_store_dword v28, v60, s[28:31], 0 offen sc1
L_csz_79:
    s_mov_b64 exec, -1
L_csf_78:
    s_setprio 0
    s_waitcnt lgkmcnt(0)
    s_waitcnt vmcnt(0)
    s_barrier
    s_waitcnt vmcnt(0) lgkmcnt(0)
    s_barrier
    s_and_b32 s86, s2, 1
    s_bfe_u32 s37, s2, 0x10001
    s_lshl_b32 s37, s37, 3
    s_bfe_u32 s38, s2, 0x30003
    s_add_u32 s4, s37, s38
    s_bfe_u32 s37, s2, 0x10002
    s_lshl_b32 s37, s37, 2
    s_lshr_b32 s38, s2, 6
    s_add_u32 s5, s37, s38
    s_add_u32 s8, s64, 0x4200000
    s_addc_u32 s9, s65, 0
    s_mov_b32 s10, 0xe00000
    s_mov_b32 s11, 0x20000
    s_mov_b32 s12, s58
    s_mov_b32 s13, s59
    s_mov_b32 s14, 0x700000
    s_mov_b32 s15, 0x20000
    s_mov_b32 s20, s64
    s_mov_b32 s21, s65
    s_mov_b32 s22, 0x400000
    s_mov_b32 s23, 0x20000
    s_lshl_b32 s37, s3, 4
    s_mul_i32 s37, s37, 2048
    s_mul_i32 s38, s5, 256
    s_add_u32 s37, s37, s38
    v_lshrrev_b32 v2, 3, v1
    v_mul_u32_u24 v2, 2048, v2
    v_add_u32 v2, s37, v2
    v_lshrrev_b32 v3, 3, v1
    v_and_b32 v3, 2, v3
    v_xor_b32 v3, v1, v3
    v_and_b32 v3, 7, v3
    v_lshl_add_u32 v8, v3, 4, v2
    v_lshl_add_u32 v10, v3, 4, v2
    v_add_u32 v10, 0x80, v10
    v_lshrrev_b32 v3, 3, v1
    v_and_b32 v3, 2, v3
    v_add_u32 v3, 4, v3
    v_xor_b32 v3, v1, v3
    v_and_b32 v3, 7, v3
    v_lshl_add_u32 v9, v3, 4, v2
    v_add_u32 v9, 0x3c00, v9
    v_lshl_add_u32 v11, v3, 4, v2
    v_add_u32 v11, 0x3c80, v11
    s_lshl_b32 s40, s3, 12
    s_lshl_b32 s41, s3, 11
    s_add_u32 s41, s41, 16384
    s_lshl_b32 s42, s3, 11
    s_add_u32 s42, s42, 24576
    s_mul_i32 s32, s86, 3584
    s_mul_i32 s33, s86, 3670016
    s_add_u32 m0, s41, 0
    s_nop 0
    buffer_load_dwordx4 v8, s[12:15], s33 offen offset:0 lds
    buffer_load_dwordx4 v9, s[12:15], s33 offen offset:1024 lds
    s_add_u32 m0, s42, 0
    s_nop 0
    buffer_load_dwordx4 v10, s[12:15], s33 offen offset:0 lds
    buffer_load_dwordx4 v11, s[12:15], s33 offen offset:1024 lds
    s_add_u32 s33, s33, 131072
    s_add_u32 m0, s41, 32768
    s_nop 0
    buffer_load_dwordx4 v8, s[12:15], s33 offen offset:0 lds
    buffer_load_dwordx4 v9, s[12:15], s33 offen offset:1024 lds
    s_add_u32 m0, s42, 32768
    s_nop 0
    buffer_load_dwordx4 v10, s[12:15], s33 offen offset:0 lds
    buffer_load_dwordx4 v11, s[12:15], s33 offen offset:1024 lds
    s_add_u32 s33, s33, 131072
    s_add_u32 m0, s41, 65536
    s_nop 0
    buffer_load_dwordx4 v8, s[12:15], s33 offen offset:0 lds
    buffer_load_dwordx4 v9, s[12:15], s33 offen offset:1024 lds
    s_add_u32 m0, s42, 65536
    s_nop 0
    buffer_load_dwordx4 v10, s[12:15], s33 offen offset:0 lds
    buffer_load_dwordx4 v11, s[12:15], s33 offen offset:1024 lds
    s_add_u32 s33, s33, 131072
    s_lshl_b32 s37, s4, 7
    s_lshl_b32 s38, s3, 5
    s_add_u32 s37, s37, s38
    s_mul_i32 s37, s37, 7168
    v_lshrrev_b32 v2, 3, v1
    v_mul_u32_u24 v2, 7168, v2
    v_add_u32 v2, s37, v2
    v_lshrrev_b32 v3, 4, v1
    v_xor_b32 v3, v1, v3
    v_and_b32 v3, 7, v3
    v_lshl_add_u32 v4, v3, 4, v2
    v_lshrrev_b32 v3, 4, v1
    v_add_u32 v3, 4, v3
    v_xor_b32 v3, v1, v3
    v_and_b32 v3, 7, v3
    v_lshl_add_u32 v5, v3, 4, v2
    v_add_u32 v5, 0xdc00, v5
    v_lshrrev_b32 v3, 4, v1
    v_xor_b32 v3, v1, v3
    v_and_b32 v3, 7, v3
    v_lshl_add_u32 v6, v3, 4, v2
    v_add_u32 v6, 0x1b800, v6
    v_lshrrev_b32 v3, 4, v1
    v_add_u32 v3, 4, v3
    v_xor_b32 v3, v1, v3
    v_and_b32 v3, 7, v3
    v_lshl_add_u32 v7, v3, 4, v2
    v_add_u32 v7, 0x29400, v7
    s_lshl_b32 s37, s4, 7
    s_and_b32 s38, s3, 1
    s_lshl_b32 s38, s38, 6
    s_add_u32 s37, s37, s38
    s_lshl_b32 s38, s86, 5
    s_add_u32 s37, s37, s38
    s_mul_i32 s37, s37, 2048
    v_lshrrev_b32 v2, 3, v1
    v_mul_u32_u24 v2, 2048, v2
    v_add_u32 v2, s37, v2
    v_lshrrev_b32 v3, 4, v1
    v_xor_b32 v3, v1, v3
    v_and_b32 v3, 7, v3
    v_lshl_add_u32 v15, v3, 4, v2
    v_lshrrev_b32 v3, 4, v1
    v_add_u32 v3, 4, v3
    v_xor_b32 v3, v1, v3
    v_and_b32 v3, 7, v3
    v_lshl_add_u32 v16, v3, 4, v2
    v_add_u32 v16, 0x3c00, v16
    v_lshrrev_b32 v3, 4, v1
    v_xor_b32 v3, v1, v3
    v_and_b32 v3, 7, v3
    v_lshl_add_u32 v17, v3, 4, v2
    v_add_u32 v17, 0x7800, v17
    v_lshrrev_b32 v3, 4, v1
    v_add_u32 v3, 4, v3
    v_xor_b32 v3, v1, v3
    v_and_b32 v3, 7, v3
    v_lshl_add_u32 v18, v3, 4, v2
    v_add_u32 v18, 0xb400, v18
    s_barrier
    s_cmp_lg_u32 s3, 0
    s_cbranch_scc1 L_np_80
    s_lshl_b32 s67, s4, 12
    s_add_u32 s67, s67, 196608
    v_and_b32 v19, 15, v1
    v_lshlrev_b32 v19, 7, v19
    s_mov_b32 s68, 400000
L_poll_81:
    buffer_load_dword v20, v19, s[88:91], s67 offen sc1
    s_waitcnt vmcnt(0)
    v_cmp_ne_u32 vcc, 0, v20
    s_nop 0
    s_cmp_eq_u64 vcc, -1
    s_cbranch_scc1 L_polld_82
    s_sleep 1
    s_sub_u32 s68, s68, 1
    s_cmp_lg_u32 s68, 0
    s_cbranch_scc1 L_poll_81
    s_mov_b32 s92, s62
    s_mov_b32 s93, s63
    s_mov_b32 s94, 256
    s_mov_b32 s95, 0x20000
    v_mov_b32 v20, 259
    v_mov_b32 v19, 0
    buffer_store_dword v20, v19, s[92:95], 0 offen
L_polld_82:
L_np_80:
    s_barrier
    s_mov_b32 s34, 0
    s_add_u32 m0, s40, 0
    s_nop 0
    buffer_load_dwordx4 v4, s[8:11], s32 offen offset:0 sc1 lds
    buffer_load_dwordx4 v5, s[8:11], s32 offen offset:1024 sc1 lds
    buffer_load_dwordx4 v6, s[8:11], s32 offen offset:2048 sc1 lds
    buffer_load_dwordx4 v7, s[8:11], s32 offen offset:3072 sc1 lds
    s_add_u32 s32, s32, 128
    s_add_u32 m0, s40, 32768
    s_nop 0
    buffer_load_dwordx4 v4, s[8:11], s32 offen offset:0 sc1 lds
    buffer_load_dwordx4 v5, s[8:11], s32 offen offset:1024 sc1 lds
    buffer_load_dwordx4 v6, s[8:11], s32 offen offset:2048 sc1 lds
    buffer_load_dwordx4 v7, s[8:11], s32 offen offset:3072 sc1 lds
    s_add_u32 s32, s32, 128
    s_waitcnt vmcnt(4)
    s_barrier
    s_add_u32 m0, s40, 65536
    s_nop 0
    buffer_load_dwordx4 v4, s[8:11], s32 offen offset:0 sc1 lds
    buffer_load_dwordx4 v5, s[8:11], s32 offen offset:1024 sc1 lds
    buffer_load_dwordx4 v6, s[8:11], s32 offen offset:2048 sc1 lds
    buffer_load_dwordx4 v7, s[8:11], s32 offen offset:3072 sc1 lds
    s_add_u32 s32, s32, 128
    s_waitcnt vmcnt(4)
    s_barrier
    s_mov_b32 s35, 24
L_ld_83:
    s_add_u32 m0, s34, s40
    s_nop 0
    buffer_load_dwordx4 v4, s[8:11], s32 offen offset:0 sc1 lds
    buffer_load_dwordx4 v5, s[8:11], s32 offen offset:1024 sc1 lds
    buffer_load_dwordx4 v6, s[8:11], s32 offen offset:2048 sc1 lds
    buffer_load_dwordx4 v7, s[8:11], s32 offen offset:3072 sc1 lds
    s_add_u32 s32, s32, 128
    s_add_u32 m0, s34, s41
    s_nop 0
    buffer_load_dwordx4 v8, s[12:15], s33 offen offset:0 lds
    buffer_load_dwordx4 v9, s[12:15], s33 offen offset:1024 lds
    s_add_u32 m0, s34, s42
    s_nop 0
    buffer_load_dwordx4 v10, s[12:15], s33 offen offset:0 lds
    buffer_load_dwordx4 v11, s[12:15], s33 offen offset:1024 lds
    s_add_u32 s33, s33, 131072
    s_add_u32 s34, s34, 32768
    s_cmp_eq_u32 s34, 98304
    s_cselect_b32 s34, 0, s34
    s_waitcnt vmcnt(8)
    s_barrier
    s_sub_u32 s35, s35, 1
    s_cmp_lg_u32 s35, 0
    s_cbranch_scc1 L_ld_83
    s_add_u32 m0, s34, s40
    s_nop 0
    buffer_load_dwordx4 v4, s[8:11], s32 offen offset:0 sc1 lds
    buffer_load_dwordx4 v5, s[8:11], s32 offen offset:1024 sc1 lds
    buffer_load_dwordx4 v6, s[8:11], s32 offen offset:2048 sc1 lds
    buffer_load_dwordx4 v7, s[8:11], s32 offen offset:3072 sc1 lds
    s_add_u32 s32, s32, 128
    s_add_u32 m0, s34, s41
    s_nop 0
    buffer_load_dwordx4 v8, s[12:15], s33 offen offset:0 lds
    buffer_load_dwordx4 v9, s[12:15], s33 offen offset:1024 lds
    s_add_u32 m0, s34, s42
    s_nop 0
    buffer_load_dwordx4 v10, s[12:15], s33 offen offset:0 lds
    buffer_load_dwordx4 v11, s[12:15], s33 offen offset:1024 lds
    s_add_u32 s33, s33, 131072
    s_add_u32 s34, s34, 32768
    s_cmp_eq_u32 s34, 98304
    s_cselect_b32 s34, 0, s34
    s_lshl_b32 s37, s5, 8
    s_lshr_b32 s38, s3, 1
    s_lshl_b32 s38, s38, 7
    s_add_u32 s37, s37, s38
    s_lshl_b32 s38, s3, 12
    s_add_u32 m0, s38, 135168
    s_nop 0
    buffer_load_dwordx4 v15, s[20:23], s37 offen offset:0 sc1 lds
    buffer_load_dwordx4 v16, s[20:23], s37 offen offset:1024 sc1 lds
    buffer_load_dwordx4 v17, s[20:23], s37 offen offset:2048 sc1 lds
    buffer_load_dwordx4 v18, s[20:23], s37 offen offset:3072 sc1 lds
    s_waitcnt vmcnt(12)
    s_barrier
    s_waitcnt vmcnt(4)
    s_barrier
    s_waitcnt vmcnt(0) lgkmcnt(0)
    s_barrier
    s_barrier
    s_and_b32 s37, s2, 1
    s_lshl_b32 s37, s37, 3
    s_bfe_u32 s38, s2, 0x30003
    s_add_u32 s4, s37, s38
    s_bfe_u32 s37, s2, 0x20001
    s_lshl_b32 s37, s37, 2
    s_lshr_b32 s38, s2, 6
    s_add_u32 s5, s37, s38
    s_add_u32 s8, s64, 0x500000
    s_addc_u32 s9, s65, 0
    s_mov_b32 s10, 0x400000
    s_mov_b32 s11, 0x20000
    s_mov_b32 s12, s50
    s_mov_b32 s13, s51
    s_mov_b32 s14, 0x600000
    s_mov_b32 s15, 0x20000
    s_add_u32 s20, s64, 0x3c80000
    s_addc_u32 s21, s65, 0
    s_mov_b32 s22, 0x40000
    s_mov_b32 s23, 0x20000
    s_lshl_b32 s37, s3, 4
    s_mul_i32 s37, s37, 6144
    s_mul_i32 s38, s5, 128
    s_add_u32 s37, s37, s38
    v_lshrrev_b32 v2, 3, v1
    v_mul_u32_u24 v2, 6144, v2
    v_add_u32 v2, s37, v2
    v_lshrrev_b32 v3, 3, v1
    v_and_b32 v3, 2, v3
    v_xor_b32 v3, v1, v3
    v_and_b32 v3, 7, v3
    v_lshl_add_u32 v8, v3, 4, v2
    v_lshl_add_u32 v10, v3, 4, v2
    v_add_u32 v10, 0x800, v10
    v_lshl_add_u32 v12, v3, 4, v2
    v_add_u32 v12, 0x1000, v12
    v_lshrrev_b32 v3, 3, v1
    v_and_b32 v3, 2, v3
    v_add_u32 v3, 4, v3
    v_xor_b32 v3, v1, v3
    v_and_b32 v3, 7, v3
    v_lshl_add_u32 v9, v3, 4, v2
    v_add_u32 v9, 0xbc00, v9
    v_lshl_add_u32 v11, v3, 4, v2
    v_add_u32 v11, 0xc400, v11
    v_lshl_add_u32 v13, v3, 4, v2
    v_add_u32 v13, 0xcc00, v13
    s_lshl_b32 s40, s3, 12
    s_lshl_b32 s41, s3, 11
    s_add_u32 s41, s41, 16384
    s_lshl_b32 s42, s3, 11
    s_add_u32 s42, s42, 24576
    s_lshl_b32 s43, s3, 11
    s_add_u32 s43, s43, 32768
    s_mov_b32 s32, 0
    s_mov_b32 s33, 0
    s_add_u32 m0, s41, 0
    s_nop 0
    buffer_load_dwordx4 v8, s[12:15], s33 offen offset:0 lds
    buffer_load_dwordx4 v9, s[12:15], s33 offen offset:1024 lds
    s_add_u32 m0, s42, 0
    s_nop 0
    buffer_load_dwordx4 v10, s[12:15], s33 offen offset:0 lds
    buffer_load_dwordx4 v11, s[12:15], s33 offen offset:1024 lds
    s_add_u32 m0, s43, 0
    s_nop 0
    buffer_load_dwordx4 v12, s[12:15], s33 offen offset:0 lds
    buffer_load_dwordx4 v13, s[12:15], s33 offen offset:1024 lds
    s_add_u32 s33, s33, 393216
    s_add_u32 m0, s41, 40960
    s_nop 0
    buffer_load_dwordx4 v8, s[12:15], s33 offen offset:0 lds
    buffer_load_dwordx4 v9, s[12:15], s33 offen offset:1024 lds
    s_add_u32 m0, s42, 40960
    s_nop 0
    buffer_load_dwordx4 v10, s[12:15], s33 offen offset:0 lds
    buffer_load_dwordx4 v11, s[12:15], s33 offen offset:1024 lds
    s_add_u32 m0, s43, 40960
    s_nop 0
    buffer_load_dwordx4 v12, s[12:15], s33 offen offset:0 lds
    buffer_load_dwordx4 v13, s[12:15], s33 offen offset:1024 lds
    s_add_u32 s33, s33, 393216
    s_add_u32 m0, s41, 81920
    s_nop 0
    buffer_load_dwordx4 v8, s[12:15], s33 offen offset:0 lds
    buffer_load_dwordx4 v9, s[12:15], s33 offen offset:1024 lds
    s_add_u32 m0, s42, 81920
    s_nop 0
    buffer_load_dwordx4 v10, s[12:15], s33 offen offset:0 lds
    buffer_load_dwordx4 v11, s[12:15], s33 offen offset:1024 lds
    s_add_u32 m0, s43, 81920
    s_nop 0
    buffer_load_dwordx4 v12, s[12:15], s33 offen offset:0 lds
    buffer_load_dwordx4 v13, s[12:15], s33 offen offset:1024 lds
    s_add_u32 s33, s33, 393216
    s_lshl_b32 s37, s4, 7
    s_lshl_b32 s38, s3, 5
    s_add_u32 s37, s37, s38
    s_mul_i32 s37, s37, 2048
    v_lshrrev_b32 v2, 3, v1
    v_mul_u32_u24 v2, 2048, v2
    v_add_u32 v2, s37, v2
    v_lshrrev_b32 v3, 4, v1
    v_xor_b32 v3, v1, v3
    v_and_b32 v3, 7, v3
    v_lshl_add_u32 v4, v3, 4, v2
    v_lshrrev_b32 v3, 4, v1
    v_add_u32 v3, 4, v3
    v_xor_b32 v3, v1, v3
    v_and_b32 v3, 7, v3
    v_lshl_add_u32 v5, v3, 4, v2
    v_add_u32 v5, 0x3c00, v5
    v_lshrrev_b32 v3, 4, v1
    v_xor_b32 v3, v1, v3
    v_and_b32 v3, 7, v3
    v_lshl_add_u32 v6, v3, 4, v2
    v_add_u32 v6, 0x7800, v6
    v_lshrrev_b32 v3, 4, v1
    v_add_u32 v3, 4, v3
    v_xor_b32 v3, v1, v3
    v_and_b32 v3, 7, v3
    v_lshl_add_u32 v7, v3, 4, v2
    v_add_u32 v7, 0xb400, v7
    s_cmp_lg_u32 s3, 0
    s_cbranch_scc1 L_np_84
    s_lshl_b32 s67, s4, 12
    s_add_u32 s67, s67, 589824
    v_and_b32 v19, 15, v1
    v_lshlrev_b32 v19, 7, v19
    s_mov_b32 s68, 400000
L_poll_85:
    buffer_load_dword v20, v19, s[88:91], s67 offen sc1
    s_waitcnt vmcnt(0)
    v_cmp_ne_u32 vcc, 0, v20
    s_nop 0
    s_cmp_eq_u64 vcc, -1
    s_cbranch_scc1 L_polld_86
    s_sleep 1
    s_sub_u32 s68, s68, 1
    s_cmp_lg_u32 s68, 0
    s_cbranch_scc1 L_poll_85
    s_mov_b32 s92, s62
    s_mov_b32 s93, s63
    s_mov_b32 s94, 256
    s_mov_b32 s95, 0x20000
    v_mov_b32 v20, 276
    v_mov_b32 v19, 0
    buffer_store_dword v20, v19, s[92:95], 0 offen
L_polld_86:
L_np_84:
    s_barrier
    s_mov_b32 s34, 0
    s_add_u32 m0, s40, 0
    s_nop 0
    buffer_load_dwordx4 v4, s[8:11], s32 offen offset:0 sc1 lds
    buffer_load_dwordx4 v5, s[8:11], s32 offen offset:1024 sc1 lds
    buffer_load_dwordx4 v6, s[8:11], s32 offen offset:2048 sc1 lds
    buffer_load_dwordx4 v7, s[8:11], s32 offen offset:3072 sc1 lds
    s_add_u32 s32, s32, 128
    s_add_u32 m0, s40, 40960
    s_nop 0
    buffer_load_dwordx4 v4, s[8:11], s32 offen offset:0 sc1 lds
    buffer_load_dwordx4 v5, s[8:11], s32 offen offset:1024 sc1 lds
    buffer_load_dwordx4 v6, s[8:11], s32 offen offset:2048 sc1 lds
    buffer_load_dwordx4 v7, s[8:11], s32 offen offset:3072 sc1 lds
    s_add_u32 s32, s32, 128
    s_waitcnt vmcnt(4)
    s_barrier
    s_add_u32 m0, s40, 81920
    s_nop 0
    buffer_load_dwordx4 v4, s[8:11], s32 offen offset:0 sc1 lds
    buffer_load_dwordx4 v5, s[8:11], s32 offen offset:1024 sc1 lds
    buffer_load_dwordx4 v6, s[8:11], s32 offen offset:2048 sc1 lds
    buffer_load_dwordx4 v7, s[8:11], s32 offen offset:3072 sc1 lds
    s_add_u32 s32, s32, 128
    s_waitcnt vmcnt(4)
    s_barrier
    s_mov_b32 s35, 9
L_ld_87:
    s_add_u32 m0, s34, s40
    s_nop 0
    buffer_load_dwordx4 v4, s[8:11], s32 offen offset:0 sc1 lds
    buffer_load_dwordx4 v5, s[8:11], s32 offen offset:1024 sc1 lds
    buffer_load_dwordx4 v6, s[8:11], s32 offen offset:2048 sc1 lds
    buffer_load_dwordx4 v7, s[8:11], s32 offen offset:3072 sc1 lds
    s_add_u32 s32, s32, 128
    s_add_u32 m0, s34, s41
    s_nop 0
    buffer_load_dwordx4 v8, s[12:15], s33 offen offset:0 lds
    buffer_load_dwordx4 v9, s[12:15], s33 offen offset:1024 lds
    s_add_u32 m0, s34, s42
    s_nop 0
    buffer_load_dwordx4 v10, s[12:15], s33 offen offset:0 lds
    buffer_load_dwordx4 v11, s[12:15], s33 offen offset:1024 lds
    s_add_u32 m0, s34, s43
    s_nop 0
    buffer_load_dwordx4 v12, s[12:15], s33 offen offset:0 lds
    buffer_load_dwordx4 v13, s[12:15], s33 offen offset:1024 lds
    s_add_u32 s33, s33, 393216
    s_add_u32 s34, s34, 40960
    s_cmp_eq_u32 s34, 122880
    s_cselect_b32 s34, 0, s34
    s_waitcnt vmcnt(10)
    s_barrier
    s_sub_u32 s35, s35, 1
    s_cmp_lg_u32 s35, 0
    s_cbranch_scc1 L_ld_87
    s_add_u32 m0, s34, s40
    s_nop 0
    buffer_load_dwordx4 v4, s[8:11], s32 offen offset:0 sc1 lds
    buffer_load_dwordx4 v5, s[8:11], s32 offen offset:1024 sc1 lds
    buffer_load_dwordx4 v6, s[8:11], s32 offen offset:2048 sc1 lds
    buffer_load_dwordx4 v7, s[8:11], s32 offen offset:3072 sc1 lds
    s_add_u32 s32, s32, 128
    s_add_u32 m0, s34, s41
    s_nop 0
    buffer_load_dwordx4 v8, s[12:15], s33 offen offset:0 lds
    buffer_load_dwordx4 v9, s[12:15], s33 offen offset:1024 lds
    s_add_u32 m0, s34, s42
    s_nop 0
    buffer_load_dwordx4 v10, s[12:15], s33 offen offset:0 lds
    buffer_load_dwordx4 v11, s[12:15], s33 offen offset:1024 lds
    s_add_u32 m0, s34, s43
    s_nop 0
    buffer_load_dwordx4 v12, s[12:15], s33 offen offset:0 lds
    buffer_load_dwordx4 v13, s[12:15], s33 offen offset:1024 lds
    s_add_u32 s33, s33, 393216
    s_add_u32 s34, s34, 40960
    s_cmp_eq_u32 s34, 122880
    s_cselect_b32 s34, 0, s34
    s_add_u32 s20, s64, 0x3c80000
    s_addc_u32 s21, s65, 0
    s_mov_b32 s22, 0x40000
    s_mov_b32 s23, 0x20000
    v_and_b32 v3, 0xff, v0
    v_lshrrev_b32 v2, 1, v3
    v_lshlrev_b32 v2, 3, v2
    v_and_b32 v3, 1, v3
    v_lshl_add_u32 v2, v3, 17, v2
    s_lshl_b32 s37, s4, 10
    buffer_load_dwordx2 v[44:45], v2, s[20:23], s37 offen sc1
    s_add_u32 s37, s37, 16384
    buffer_load_dwordx2 v[46:47], v2, s[20:23], s37 offen sc1
    s_add_u32 s37, s37, 16384
    buffer_load_dwordx2 v[48:49], v2, s[20:23], s37 offen sc1
    s_add_u32 s37, s37, 16384
    buffer_load_dwordx2 v[50:51], v2, s[20:23], s37 offen sc1
    s_add_u32 s37, s37, 16384
    buffer_load_dwordx2 v[52:53], v2, s[20:23], s37 offen sc1
    s_add_u32 s37, s37, 16384
    buffer_load_dwordx2 v[54:55], v2, s[20:23], s37 offen sc1
    s_add_u32 s37, s37, 16384
    buffer_load_dwordx2 v[56:57], v2, s[20:23], s37 offen sc1
    s_add_u32 s37, s37, 16384
    buffer_load_dwordx2 v[58:59], v2, s[20:23], s37 offen sc1
    s_waitcnt vmcnt(18)
    s_barrier
    s_add_u32 m0, s34, s40
    s_nop 0
    buffer_load_dwordx4 v4, s[8:11], s32 offen offset:0 sc1 lds
    buffer_load_dwordx4 v5, s[8:11], s32 offen offset:1024 sc1 lds
    buffer_load_dwordx4 v6, s[8:11], s32 offen offset:2048 sc1 lds
    buffer_load_dwordx4 v7, s[8:11], s32 offen offset:3072 sc1 lds
    s_add_u32 s32, s32, 128
    s_add_u32 m0, s34, s41
    s_nop 0
    buffer_load_dwordx4 v8, s[12:15], s33 offen offset:0 lds
    buffer_load_dwordx4 v9, s[12:15], s33 offen offset:1024 lds
    s_add_u32 m0, s34, s42
    s_nop 0
    buffer_load_dwordx4 v10, s[12:15], s33 offen offset:0 lds
    buffer_load_dwordx4 v11, s[12:15], s33 offen offset:1024 lds
    s_add_u32 m0, s34, s43
    s_nop 0
    buffer_load_dwordx4 v12, s[12:15], s33 offen offset:0 lds
    buffer_load_dwordx4 v13, s[12:15], s33 offen offset:1024 lds
    s_add_u32 s33, s33, 393216
    s_add_u32 s34, s34, 40960
    s_cmp_eq_u32 s34, 122880
    s_cselect_b32 s34, 0, s34
    s_waitcnt vmcnt(18)
    s_barrier
    s_add_u32 m0, s34, s40
    s_nop 0
    buffer_load_dwordx4 v4, s[8:11], s32 offen offset:0 sc1 lds
    buffer_load_dwordx4 v5, s[8:11], s32 offen offset:1024 sc1 lds
    buffer_load_dwordx4 v6, s[8:11], s32 offen offset:2048 sc1 lds
    buffer_load_dwordx4 v7, s[8:11], s32 offen offset:3072 sc1 lds
    s_add_u32 s32, s32, 128
    s_add_u32 m0, s34, s41
    s_nop 0
    buffer_load_dwordx4 v8, s[12:15], s33 offen offset:0 lds
    buffer_load_dwordx4 v9, s[12:15], s33 offen offset:1024 lds
    s_add_u32 m0, s34, s42
    s_nop 0
    buffer_load_dwordx4 v10, s[12:15], s33 offen offset:0 lds
    buffer_load_dwordx4 v11, s[12:15], s33 offen offset:1024 lds
    s_add_u32 m0, s34, s43
    s_nop 0
    buffer_load_dwordx4 v12, s[12:15], s33 offen offset:0 lds
    buffer_load_dwordx4 v13, s[12:15], s33 offen offset:1024 lds
    s_add_u32 s33, s33, 393216
    s_add_u32 s34, s34, 40960
    s_cmp_eq_u32 s34, 122880
    s_cselect_b32 s34, 0, s34
    s_add_u32 s28, s64, 0x3e80000
    s_addc_u32 s29, s65, 0
    s_mov_b32 s30, 0x3000
    s_mov_b32 s31, 0x20000
    v_and_b32 v24, 0xff, v0
    v_lshrrev_b32 v2, 6, v24
    v_lshlrev_b32 v2, 10, v2
    v_and_b32 v3, 63, v24
    v_add_u32 v2, v2, v3
    s_lshl_b32 s37, s5, 6
    v_add_u32 v2, s37, v2
    v_lshlrev_b32 v2, 2, v2
    v_min_u32 v2, 12284, v2
    v_mov_b32 v60, v2
    buffer_load_dword v28, v2, s[28:31], 0 offen sc1
    s_waitcnt vmcnt(11)
    s_barrier
    s_add_u32 m0, s34, s40
    s_nop 0
    buffer_load_dwordx4 v4, s[8:11], s32 offen offset:0 sc1 lds
    buffer_load_dwordx4 v5, s[8:11], s32 offen offset:1024 sc1 lds
    buffer_load_dwordx4 v6, s[8:11], s32 offen offset:2048 sc1 lds
    buffer_load_dwordx4 v7, s[8:11], s32 offen offset:3072 sc1 lds
    s_add_u32 s32, s32, 128
    s_add_u32 m0, s34, s41
    s_nop 0
    buffer_load_dwordx4 v8, s[12:15], s33 offen offset:0 lds
    buffer_load_dwordx4 v9, s[12:15], s33 offen offset:1024 lds
    s_add_u32 m0, s34, s42
    s_nop 0
    buffer_load_dwordx4 v10, s[12:15], s33 offen offset:0 lds
    buffer_load_dwordx4 v11, s[12:15], s33 offen offset:1024 lds
    s_add_u32 m0, s34, s43
    s_nop 0
    buffer_load_dwordx4 v12, s[12:15], s33 offen offset:0 lds
    buffer_load_dwordx4 v13, s[12:15], s33 offen offset:1024 lds
    s_add_u32 s33, s33, 393216
    s_add_u32 s34, s34, 40960
    s_cmp_eq_u32 s34, 122880
    s_cselect_b32 s34, 0, s34
    s_waitcnt vmcnt(11)
    s_barrier
    s_waitcnt vmcnt(10)
    s_setprio 1
    v_add_f32 v44, v44, v52
    v_add_f32 v45, v45, v53
    v_add_f32 v46, v46, v54
    v_add_f32 v47, v47, v55
    v_add_f32 v48, v48, v56
    v_add_f32 v49, v49, v57
    v_add_f32 v50, v50, v58
    v_add_f32 v51, v51, v59
    v_add_f32 v44, v44, v48
    v_add_f32 v45, v45, v49
    v_add_f32 v46, v46, v50
    v_add_f32 v47, v47, v51
    v_add_f32 v44, v44, v46
    v_add_f32 v45, v45, v47
    s_nop 0
    v_add_f32_dpp v44, v44, v44 quad_perm:[1,0,3,2] row_mask:0xf bank_mask:0xf
    v_add_f32_dpp v45, v45, v45 quad_perm:[1,0,3,2] row_mask:0xf bank_mask:0xf
    v_mul_f32 v48, 0xba800000, v44
    v_mul_f32 v49, 0x3a800000, v45
    v_fma_f32 v49, -v48, v48, v49
    v_max_f32 v49, 0, v49
    v_add_f32 v49, 0x3727c5ac, v49
    v_rsq_f32 v50, v49
    v_and_b32 v2, 0xfe, v0
    v_lshlrev_b32 v2, 1, v2
    v_add_u32 v2, 151552, v2
    ds_write_b32 v2, v48
    ds_write_b32 v2, v50 offset:512
    v_lshlrev_b32 v2, 2, v24
    v_add_u32 v2, 154624, v2
    ds_write_b32 v2, v28
    s_setprio 0
    s_waitcnt lgkmcnt(0)
    s_waitcnt vmcnt(0)
    s_barrier
    s_waitcnt vmcnt(0) lgkmcnt(0)
    s_barrier
    s_and_b32 s37, s2, 3
    s_lshl_b32 s37, s37, 2
    s_bfe_u32 s38, s2, 0x20003
    s_add_u32 s4, s37, s38
    s_bfe_u32 s37, s2, 0x10002
    s_lshl_b32 s37, s37, 3
    s_lshr_b32 s38, s2, 5
    s_add_u32 s5, s37, s38
    s_add_u32 s8, s64, 0xf00000
    s_addc_u32 s9, s65, 0
    s_mov_b32 s10, 0x400000
    s_mov_b32 s11, 0x20000
    s_mov_b32 s12, s52
    s_mov_b32 s13, s53
    s_mov_b32 s14, 0x200000
    s_mov_b32 s15, 0x20000
    s_add_u32 s20, s64, 0x500000
    s_addc_u32 s21, s65, 0
    s_mov_b32 s22, 0x400000
    s_mov_b32 s23, 0x20000
    s_lshl_b32 s37, s3, 4
    s_mul_i32 s37, s37, 2048
    s_mul_i32 s38, s5, 128
    s_add_u32 s37, s37, s38
    v_lshrrev_b32 v2, 3, v1
    v_mul_u32_u24 v2, 2048, v2
    v_add_u32 v2, s37, v2
    v_lshrrev_b32 v3, 3, v1
    v_and_b32 v3, 2, v3
    v_xor_b32 v3, v1, v3
    v_and_b32 v3, 7, v3
    v_lshl_add_u32 v8, v3, 4, v2
    v_lshrrev_b32 v3, 3, v1
    v_and_b32 v3, 2, v3
    v_add_u32 v3, 4, v3
    v_xor_b32 v3, v1, v3
    v_and_b32 v3, 7, v3
    v_lshl_add_u32 v9, v3, 4, v2
    v_add_u32 v9, 0x3c00, v9
    s_lshl_b32 s40, s3, 12
    s_lshl_b32 s41, s3, 11
    s_add_u32 s41, s41, 16384
    s_mov_b32 s32, 0
    s_mov_b32 s33, 0
    s_add_u32 m0, s41, 0
    s_nop 0
    buffer_load_dwordx4 v8, s[12:15], s33 offen offset:0 lds
    buffer_load_dwordx4 v9, s[12:15], s33 offen offset:1024 lds
    s_add_u32 s33, s33, 131072
    s_add_u32 m0, s41, 24576
    s_nop 0
    buffer_load_dwordx4 v8, s[12:15], s33 offen offset:0 lds
    buffer_load_dwordx4 v9, s[12:15], s33 offen offset:1024 lds
    s_add_u32 s33, s33, 131072
    s_add_u32 m0, s41, 49152
    s_nop 0
    buffer_load_dwordx4 v8, s[12:15], s33 offen offset:0 lds
    buffer_load_dwordx4 v9, s[12:15], s33 offen offset:1024 lds
    s_add_u32 s33, s33, 131072
    s_add_u32 m0, s41, 73728
    s_nop 0
    buffer_load_dwordx4 v8, s[12:15], s33 offen offset:0 lds
    buffer_load_dwordx4 v9, s[12:15], s33 offen offset:1024 lds
    s_add_u32 s33, s33, 131072
    s_add_u32 m0, s41, 98304
    s_nop 0
    buffer_load_dwordx4 v8, s[12:15], s33 offen offset:0 lds
    buffer_load_dwordx4 v9, s[12:15], s33 offen offset:1024 lds
    s_add_u32 s33, s33, 131072
    s_bfe_u32 s37, s2, 0x20003
    s_lshl_b32 s37, s37, 8
    s_lshl_b32 s38, s3, 6
    s_add_u32 s37, s37, s38
    v_add_u32 v21, s37, v1
    v_lshlrev_b32 v21, 11, v21
    s_lshl_b32 s37, s5, 7
    buffer_load_dword v22, v21, s[12:15], s37 offen
    s_lshl_b32 s37, s4, 7
    s_lshl_b32 s38, s3, 5
    s_add_u32 s37, s37, s38
    s_mul_i32 s37, s37, 2048
    v_lshrrev_b32 v2, 3, v1
    v_mul_u32_u24 v2, 2048, v2
    v_add_u32 v2, s37, v2
    v_lshrrev_b32 v3, 4, v1
    v_xor_b32 v3, v1, v3
    v_and_b32 v3, 7, v3
    v_lshl_add_u32 v4, v3, 4, v2
    v_lshrrev_b32 v3, 4, v1
    v_add_u32 v3, 4, v3
    v_xor_b32 v3, v1, v3
    v_and_b32 v3, 7, v3
    v_lshl_add_u32 v5, v3, 4, v2
    v_add_u32 v5, 0x3c00, v5
    v_lshrrev_b32 v3, 4, v1
    v_xor_b32 v3, v1, v3
    v_and_b32 v3, 7, v3
    v_lshl_add_u32 v6, v3, 4, v2
    v_add_u32 v6, 0x7800, v6
    v_lshrrev_b32 v3, 4, v1
    v_add_u32 v3, 4, v3
    v_xor_b32 v3, v1, v3
    v_and_b32 v3, 7, v3
    v_lshl_add_u32 v7, v3, 4, v2
    v_add_u32 v7, 0xb400, v7
    s_lshl_b32 s37, s4, 7
    s_lshl_b32 s38, s3, 5
    s_add_u32 s37, s37, s38
    s_mul_i32 s37, s37, 2048
    v_lshrrev_b32 v2, 3, v1
    v_mul_u32_u24 v2, 2048, v2
    v_add_u32 v2, s37, v2
    v_lshrrev_b32 v3, 4, v1
    v_xor_b32 v3, v1, v3
    v_and_b32 v3, 7, v3
    v_lshl_add_u32 v15, v3, 4, v2
    v_lshrrev_b32 v3, 4, v1
    v_add_u32 v3, 4, v3
    v_xor_b32 v3, v1, v3
    v_and_b32 v3, 7, v3
    v_lshl_add_u32 v16, v3, 4, v2
    v_add_u32 v16, 0x3c00, v16
    v_lshrrev_b32 v3, 4, v1
    v_xor_b32 v3, v1, v3
    v_and_b32 v3, 7, v3
    v_lshl_add_u32 v17, v3, 4, v2
    v_add_u32 v17, 0x7800, v17
    v_lshrrev_b32 v3, 4, v1
    v_add_u32 v3, 4, v3
    v_xor_b32 v3, v1, v3
    v_and_b32 v3, 7, v3
    v_lshl_add_u32 v18, v3, 4, v2
    v_add_u32 v18, 0xb400, v18
    s_barrier
    s_cmp_lg_u32 s3, 0
    s_cbranch_scc1 L_np_88
    s_bfe_u32 s69, s2, 0x20001
    s_lshl_b32 s69, s69, 2
    s_lshr_b32 s67, s2, 6
    s_add_u32 s69, s69, s67
    s_lshl_b32 s67, s69, 12
    s_add_u32 s67, s67, 327680
    v_and_b32 v19, 31, v1
    v_lshlrev_b32 v19, 7, v19
    s_mov_b32 s68, 400000
L_poll_89:
    buffer_load_dword v20, v19, s[88:91], s67 offen sc1
    s_waitcnt vmcnt(0)
    v_cmp_ne_u32 vcc, 0, v20
    s_nop 0
    s_cmp_eq_u64 vcc, -1
    s_cbranch_scc1 L_polld_90
    s_sleep 1
    s_sub_u32 s68, s68, 1
    s_cmp_lg_u32 s68, 0
    s_cbranch_scc1 L_poll_89
    s_mov_b32 s92, s62
    s_mov_b32 s93, s63
    s_mov_b32 s94, 256
    s_mov_b32 s95, 0x20000
    v_mov_b32 v20, 513
    v_mov_b32 v19, 0
    buffer_store_dword v20, v19, s[92:95], 0 offen
L_polld_90:
L_np_88:
    s_barrier
    s_barrier
    s_cmp_lg_u32 s3, 0
    s_cbranch_scc1 L_np_91
    s_lshl_b32 s67, s4, 12
    s_add_u32 s67, s67, 393216
    v_and_b32 v19, 15, v1
    v_lshlrev_b32 v19, 7, v19
    s_mov_b32 s68, 400000
L_poll_92:
    buffer_load_dword v20, v19, s[88:91], s67 offen sc1
    s_waitcnt vmcnt(0)
    v_cmp_ne_u32 vcc, 0, v20
    s_nop 0
    s_cmp_eq_u64 vcc, -1
    s_cbranch_scc1 L_polld_93
    s_sleep 1
    s_sub_u32 s68, s68, 1
    s_cmp_lg_u32 s68, 0
    s_cbranch_scc1 L_poll_92
    s_mov_b32 s92, s62
    s_mov_b32 s93, s63
    s_mov_b32 s94, 256
    s_mov_b32 s95, 0x20000
    v_mov_b32 v20, 273
    v_mov_b32 v19, 0
    buffer_store_dword v20, v19, s[92:95], 0 offen
L_polld_93:
L_np_91:
    s_barrier
    s_mov_b32 s34, 0
    s_add_u32 m0, s40, 0
    s_nop 0
    buffer_load_dwordx4 v4, s[8:11], s32 offen offset:0 sc1 lds
    buffer_load_dwordx4 v5, s[8:11], s32 offen offset:1024 sc1 lds
    buffer_load_dwordx4 v6, s[8:11], s32 offen offset:2048 sc1 lds
    buffer_load_dwordx4 v7, s[8:11], s32 offen offset:3072 sc1 lds
    s_add_u32 s32, s32, 128
    s_add_u32 m0, s40, 24576
    s_nop 0
    buffer_load_dwordx4 v4, s[8:11], s32 offen offset:0 sc1 lds
    buffer_load_dwordx4 v5, s[8:11], s32 offen offset:1024 sc1 lds
    buffer_load_dwordx4 v6, s[8:11], s32 offen offset:2048 sc1 lds
    buffer_load_dwordx4 v7, s[8:11], s32 offen offset:3072 sc1 lds
    s_add_u32 s32, s32, 128
    s_waitcnt vmcnt(4)
    s_barrier
    s_add_u32 m0, s40, 49152
    s_nop 0
    buffer_load_dwordx4 v4, s[8:11], s32 offen offset:0 sc1 lds
    buffer_load_dwordx4 v5, s[8:11], s32 offen offset:1024 sc1 lds
    buffer_load_dwordx4 v6, s[8:11], s32 offen offset:2048 sc1 lds
    buffer_load_dwordx4 v7, s[8:11], s32 offen offset:3072 sc1 lds
    s_add_u32 s32, s32, 128
    s_add_u32 m0, s40, 73728
    s_nop 0
    buffer_load_dwordx4 v4, s[8:11], s32 offen offset:0 sc1 lds
    buffer_load_dwordx4 v5, s[8:11], s32 offen offset:1024 sc1 lds
    buffer_load_dwordx4 v6, s[8:11], s32 offen offset:2048 sc1 lds
    buffer_load_dwordx4 v7, s[8:11], s32 offen offset:3072 sc1 lds
    s_add_u32 s32, s32, 128
    s_waitcnt vmcnt(8)
    s_barrier
    s_add_u32 m0, s40, 98304
    s_nop 0
    buffer_load_dwordx4 v4, s[8:11], s32 offen offset:0 sc1 lds
    buffer_load_dwordx4 v5, s[8:11], s32 offen offset:1024 sc1 lds
    buffer_load_dwordx4 v6, s[8:11], s32 offen offset:2048 sc1 lds
    buffer_load_dwordx4 v7, s[8:11], s32 offen offset:3072 sc1 lds
    s_add_u32 s32, s32, 128
    s_add_u32 m0, s34, s40
    s_nop 0
    buffer_load_dwordx4 v4, s[8:11], s32 offen offset:0 sc1 lds
    buffer_load_dwordx4 v5, s[8:11], s32 offen offset:1024 sc1 lds
    buffer_load_dwordx4 v6, s[8:11], s32 offen offset:2048 sc1 lds
    buffer_load_dwordx4 v7, s[8:11], s32 offen offset:3072 sc1 lds
    s_add_u32 s32, s32, 128
    s_add_u32 m0, s34, s41
    s_nop 0
    buffer_load_dwordx4 v8, s[12:15], s33 offen offset:0 lds
    buffer_load_dwordx4 v9, s[12:15], s33 offen offset:1024 lds
    s_add_u32 s33, s33, 131072
    s_add_u32 s34, s34, 24576
    s_cmp_eq_u32 s34, 122880
    s_cselect_b32 s34, 0, s34
    s_waitcnt vmcnt(14)
    s_barrier
    s_add_u32 m0, s34, s40
    s_nop 0
    buffer_load_dwordx4 v4, s[8:11], s32 offen offset:0 sc1 lds
    buffer_load_dwordx4 v5, s[8:11], s32 offen offset:1024 sc1 lds
    buffer_load_dwordx4 v6, s[8:11], s32 offen offset:2048 sc1 lds
    buffer_load_dwordx4 v7, s[8:11], s32 offen offset:3072 sc1 lds
    s_add_u32 s32, s32, 128
    s_add_u32 m0, s34, s41
    s_nop 0
    buffer_load_dwordx4 v8, s[12:15], s33 offen offset:0 lds
    buffer_load_dwordx4 v9, s[12:15], s33 offen offset:1024 lds
    s_add_u32 s33, s33, 131072
    s_add_u32 s34, s34, 24576
    s_cmp_eq_u32 s34, 122880
    s_cselect_b32 s34, 0, s34
    s_waitcnt vmcnt(16)
    s_barrier
    s_mov_b32 s35, 8
L_ld_94:
    s_add_u32 m0, s34, s40
    s_nop 0
    buffer_load_dwordx4 v4, s[8:11], s32 offen offset:0 sc1 lds
    buffer_load_dwordx4 v5, s[8:11], s32 offen offset:1024 sc1 lds
    buffer_load_dwordx4 v6, s[8:11], s32 offen offset:2048 sc1 lds
    buffer_load_dwordx4 v7, s[8:11], s32 offen offset:3072 sc1 lds
    s_add_u32 s32, s32, 128
    s_add_u32 m0, s34, s41
    s_nop 0
    buffer_load_dwordx4 v8, s[12:15], s33 offen offset:0 lds
    buffer_load_dwordx4 v9, s[12:15], s33 offen offset:1024 lds
    s_add_u32 s33, s33, 131072
    s_add_u32 s34, s34, 24576
    s_cmp_eq_u32 s34, 122880
    s_cselect_b32 s34, 0, s34
    s_waitcnt vmcnt(18)
    s_barrier
    s_sub_u32 s35, s35, 1
    s_cmp_lg_u32 s35, 0
    s_cbranch_scc1 L_ld_94
    s_add_u32 m0, s34, s40
    s_nop 0
    buffer_load_dwordx4 v4, s[8:11], s32 offen offset:0 sc1 lds
    buffer_load_dwordx4 v5, s[8:11], s32 offen offset:1024 sc1 lds
    buffer_load_dwordx4 v6, s[8:11], s32 offen offset:2048 sc1 lds
    buffer_load_dwordx4 v7, s[8:11], s32 offen offset:3072 sc1 lds
    s_add_u32 s32, s32, 128
    s_add_u32 m0, s34, s41
    s_nop 0
    buffer_load_dwordx4 v8, s[12:15], s33 offen offset:0 lds
    buffer_load_dwordx4 v9, s[12:15], s33 offen offset:1024 lds
    s_add_u32 s33, s33, 131072
    s_add_u32 s34, s34, 24576
    s_cmp_eq_u32 s34, 122880
    s_cselect_b32 s34, 0, s34
    s_lshl_b32 s37, s5, 7
    s_lshl_b32 s38, s3, 12
    s_add_u32 m0, s38, 135168
    s_nop 0
    buffer_load_dwordx4 v15, s[20:23], s37 offen offset:0 sc1 lds
    buffer_load_dwordx4 v16, s[20:23], s37 offen offset:1024 sc1 lds
    buffer_load_dwordx4 v17, s[20:23], s37 offen offset:2048 sc1 lds
    buffer_load_dwordx4 v18, s[20:23], s37 offen offset:3072 sc1 lds
    s_waitcnt vmcnt(22)
    s_barrier
    s_waitcnt vmcnt(16)
    s_barrier
    s_waitcnt vmcnt(10)
    s_barrier
    s_waitcnt vmcnt(4)
    s_barrier
    s_waitcnt vmcnt(0) lgkmcnt(0)
    s_barrier
    s_barrier
    s_and_b32 s37, s2, 1
    s_lshl_b32 s37, s37, 3
    s_bfe_u32 s38, s2, 0x30003
    s_add_u32 s4, s37, s38
    s_bfe_u32 s37, s2, 0x20001
    s_lshl_b32 s37, s37, 2
    s_lshr_b32 s38, s2, 6
    s_add_u32 s5, s37, s38
    s_mov_b32 s8, s64
    s_mov_b32 s9, s65
    s_mov_b32 s10, 0x400000
    s_mov_b32 s11, 0x20000
    s_mov_b32 s12, s56
    s_mov_b32 s13, s57
    s_mov_b32 s14, 0x700000
    s_mov_b32 s15, 0x20000
    s_add_u32 s20, s64, 0x3cc0000
    s_addc_u32 s21, s65, 0
    s_mov_b32 s22, 0x40000
    s_mov_b32 s23, 0x20000
    s_lshl_b32 s37, s3, 4
    s_mul_i32 s37, s37, 7168
    s_lshr_b32 s38, s5, 1
    s_mul_i32 s38, s38, 896
    s_and_b32 s66, s5, 1
    s_lshl_b32 s66, s66, 9
    s_add_u32 s38, s38, s66
    s_and_b32 s66, s5, 1
    s_mul_i32 s66, s66, -448
    s_add_u32 s66, s66, 384
    s_add_u32 s37, s37, s38
    v_lshrrev_b32 v2, 3, v1
    v_mul_u32_u24 v2, 7168, v2
    v_add_u32 v2, s37, v2
    v_lshrrev_b32 v3, 3, v1
    v_and_b32 v3, 2, v3
    v_xor_b32 v3, v1, v3
    v_and_b32 v3, 7, v3
    v_lshl_add_u32 v8, v3, 4, v2
    v_lshl_add_u32 v10, v3, 4, v2
    v_add_u32 v10, 0x80, v10
    v_lshl_add_u32 v12, v3, 4, v2
    v_add_u32 v12, 0x100, v12
    v_lshrrev_b32 v3, 3, v1
    v_and_b32 v3, 2, v3
    v_add_u32 v3, 4, v3
    v_xor_b32 v3, v1, v3
    v_and_b32 v3, 7, v3
    v_lshl_add_u32 v9, v3, 4, v2
    v_add_u32 v9, 0xdc00, v9
    v_lshl_add_u32 v11, v3, 4, v2
    v_add_u32 v11, 0xdc80, v11
    v_lshl_add_u32 v13, v3, 4, v2
    v_add_u32 v13, 0xdd00, v13
    v_lshrrev_b32 v2, 2, v1
    v_mul_u32_u24 v2, 7168, v2
    v_add_u32 v2, s37, v2
    v_lshrrev_b32 v3, 4, v1
    v_and_b32 v3, 2, v3
    v_xor_b32 v3, v1, v3
    v_and_b32 v3, 3, v3
    v_lshl_add_u32 v14, v3, 4, v2
    v_add_u32 v14, s66, v14
    s_lshl_b32 s40, s3, 12
    s_lshl_b32 s41, s3, 11
    s_add_u32 s41, s41, 16384
    s_lshl_b32 s42, s3, 11
    s_add_u32 s42, s42, 24576
    s_lshl_b32 s43, s3, 11
    s_add_u32 s43, s43, 32768
    s_lshl_b32 s44, s3, 10
    s_add_u32 s44, s44, 40960
    s_mov_b32 s32, 0
    s_mov_b32 s33, 0
    s_add_u32 m0, s41, 0
    s_nop 0
    buffer_load_dwordx4 v8, s[12:15], s33 offen offset:0 lds
    buffer_load_dwordx4 v9, s[12:15], s33 offen offset:1024 lds
    s_add_u32 m0, s42, 0
    s_nop 0
    buffer_load_dwordx4 v10, s[12:15], s33 offen offset:0 lds
    buffer_load_dwordx4 v11, s[12:15], s33 offen offset:1024 lds
    s_add_u32 m0, s43, 0
    s_nop 0
    buffer_load_dwordx4 v12, s[12:15], s33 offen offset:0 lds
    buffer_load_dwordx4 v13, s[12:15], s33 offen offset:1024 lds
    s_add_u32 m0, s44, 0
    s_nop 0
    buffer_load_dwordx4 v14, s[12:15], s33 offen lds
    s_add_u32 s33, s33, 458752
    s_add_u32 m0, s41, 45056
    s_nop 0
    buffer_load_dwordx4 v8, s[12:15], s33 offen offset:0 lds
    buffer_load_dwordx4 v9, s[12:15], s33 offen offset:1024 lds
    s_add_u32 m0, s42, 45056
    s_nop 0
    buffer_load_dwordx4 v10, s[12:15], s33 offen offset:0 lds
    buffer_load_dwordx4 v11, s[12:15], s33 offen offset:1024 lds
    s_add_u32 m0, s43, 45056
    s_nop 0
    buffer_load_dwordx4 v12, s[12:15], s33 offen offset:0 lds
    buffer_load_dwordx4 v13, s[12:15], s33 offen offset:1024 lds
    s_add_u32 m0, s44, 45056
    s_nop 0
    buffer_load_dwordx4 v14, s[12:15], s33 offen lds
    s_add_u32 s33, s33, 458752
    s_add_u32 m0, s41, 90112
    s_nop 0
    buffer_load_dwordx4 v8, s[12:15], s33 offen offset:0 lds
    buffer_load_dwordx4 v9, s[12:15], s33 offen offset:1024 lds
    s_add_u32 m0, s42, 90112
    s_nop 0
    buffer_load_dwordx4 v10, s[12:15], s33 offen offset:0 lds
    buffer_load_dwordx4 v11, s[12:15], s33 offen offset:1024 lds
    s_add_u32 m0, s43, 90112
    s_nop 0
    buffer_load_dwordx4 v12, s[12:15], s33 offen offset:0 lds
    buffer_load_dwordx4 v13, s[12:15], s33 offen offset:1024 lds
    s_add_u32 m0, s44, 90112
    s_nop 0
    buffer_load_dwordx4 v14, s[12:15], s33 offen lds
    s_add_u32 s33, s33, 458752
    s_lshl_b32 s37, s4, 7
    s_lshl_b32 s38, s3, 5
    s_add_u32 s37, s37, s38
    s_mul_i32 s37, s37, 2048
    v_lshrrev_b32 v2, 3, v1
    v_mul_u32_u24 v2, 2048, v2
    v_add_u32 v2, s37, v2
    v_lshrrev_b32 v3, 4, v1
    v_xor_b32 v3, v1, v3
    v_and_b32 v3, 7, v3
    v_lshl_add_u32 v4, v3, 4, v2
    v_lshrrev_b32 v3, 4, v1
    v_add_u32 v3, 4, v3
    v_xor_b32 v3, v1, v3
    v_and_b32 v3, 7, v3
    v_lshl_add_u32 v5, v3, 4, v2
    v_add_u32 v5, 0x3c00, v5
    v_lshrrev_b32 v3, 4, v1
    v_xor_b32 v3, v1, v3
    v_and_b32 v3, 7, v3
    v_lshl_add_u32 v6, v3, 4, v2
    v_add_u32 v6, 0x7800, v6
    v_lshrrev_b32 v3, 4, v1
    v_add_u32 v3, 4, v3
    v_xor_b32 v3, v1, v3
    v_and_b32 v3, 7, v3
    v_lshl_add_u32 v7, v3, 4, v2
    v_add_u32 v7, 0xb400, v7
    s_cmp_lg_u32 s3, 0
    s_cbranch_scc1 L_np_95
    s_lshl_b32 s67, s4, 12
    s_add_u32 s67, s67, 458752
    v_and_b32 v19, 15, v1
    v_lshlrev_b32 v19, 7, v19
    s_mov_b32 s68, 400000
L_poll_96:
    buffer_load_dword v20, v19, s[88:91], s67 offen sc1
    s_waitcnt vmcnt(0)
    v_cmp_ne_u32 vcc, 0, v20
    s_nop 0
    s_cmp_eq_u64 vcc, -1
    s_cbranch_scc1 L_polld_97
    s_sleep 1
    s_sub_u32 s68, s68, 1
    s_cmp_lg_u32 s68, 0
    s_cbranch_scc1 L_poll_96
    s_mov_b32 s92, s62
    s_mov_b32 s93, s63
    s_mov_b32 s94, 256
    s_mov_b32 s95, 0x20000
    v_mov_b32 v20, 274
    v_mov_b32 v19, 0
    buffer_store_dword v20, v19, s[92:95], 0 offen
L_polld_97:
L_np_95:
    s_barrier
    s_mov_b32 s34, 0
    s_add_u32 m0, s40, 0
    s_nop 0
    buffer_load_dwordx4 v4, s[8:11], s32 offen offset:0 sc1 lds
    buffer_load_dwordx4 v5, s[8:11], s32 offen offset:1024 sc1 lds
    buffer_load_dwordx4 v6, s[8:11], s32 offen offset:2048 sc1 lds
    buffer_load_dwordx4 v7, s[8:11], s32 offen offset:3072 sc1 lds
    s_add_u32 s32, s32, 128
    s_add_u32 m0, s40, 45056
    s_nop 0
    buffer_load_dwordx4 v4, s[8:11], s32 offen offset:0 sc1 lds
    buffer_load_dwordx4 v5, s[8:11], s32 offen offset:1024 sc1 lds
    buffer_load_dwordx4 v6, s[8:11], s32 offen offset:2048 sc1 lds
    buffer_load_dwordx4 v7, s[8:11], s32 offen offset:3072 sc1 lds
    s_add_u32 s32, s32, 128
    s_waitcnt vmcnt(4)
    s_barrier
    s_add_u32 m0, s40, 90112
    s_nop 0
    buffer_load_dwordx4 v4, s[8:11], s32 offen offset:0 sc1 lds
    buffer_load_dwordx4 v5, s[8:11], s32 offen offset:1024 sc1 lds
    buffer_load_dwordx4 v6, s[8:11], s32 offen offset:2048 sc1 lds
    buffer_load_dwordx4 v7, s[8:11], s32 offen offset:3072 sc1 lds
    s_add_u32 s32, s32, 128
    s_waitcnt vmcnt(4)
    s_barrier
    s_mov_b32 s35, 9
L_ld_98:
    s_add_u32 m0, s34, s40
    s_nop 0
    buffer_load_dwordx4 v4, s[8:11], s32 offen offset:0 sc1 lds
    buffer_load_dwordx4 v5, s[8:11], s32 offen offset:1024 sc1 lds
    buffer_load_dwordx4 v6, s[8:11], s32 offen offset:2048 sc1 lds
    buffer_load_dwordx4 v7, s[8:11], s32 offen offset:3072 sc1 lds
    s_add_u32 s32, s32, 128
    s_add_u32 m0, s34, s41
    s_nop 0
    buffer_load_dwordx4 v8, s[12:15], s33 offen offset:0 lds
    buffer_load_dwordx4 v9, s[12:15], s33 offen offset:1024 lds
    s_add_u32 m0, s34, s42
    s_nop 0
    buffer_load_dwordx4 v10, s[12:15], s33 offen offset:0 lds
    buffer_load_dwordx4 v11, s[12:15], s33 offen offset:1024 lds
    s_add_u32 m0, s34, s43
    s_nop 0
    buffer_load_dwordx4 v12, s[12:15], s33 offen offset:0 lds
    buffer_load_dwordx4 v13, s[12:15], s33 offen offset:1024 lds
    s_add_u32 m0, s34, s44
    s_nop 0
    buffer_load_dwordx4 v14, s[12:15], s33 offen lds
    s_add_u32 s33, s33, 458752
    s_add_u32 s34, s34, 45056
    s_cmp_eq_u32 s34, 135168
    s_cselect_b32 s34, 0, s34
    s_waitcnt vmcnt(11)
    s_barrier
    s_sub_u32 s35, s35, 1
    s_cmp_lg_u32 s35, 0
    s_cbranch_scc1 L_ld_98
    s_add_u32 m0, s34, s40
    s_nop 0
    buffer_load_dwordx4 v4, s[8:11], s32 offen offset:0 sc1 lds
    buffer_load_dwordx4 v5, s[8:11], s32 offen offset:1024 sc1 lds
    buffer_load_dwordx4 v6, s[8:11], s32 offen offset:2048 sc1 lds
    buffer_load_dwordx4 v7, s[8:11], s32 offen offset:3072 sc1 lds
    s_add_u32 s32, s32, 128
    s_add_u32 m0, s34, s41
    s_nop 0
    buffer_load_dwordx4 v8, s[12:15], s33 offen offset:0 lds
    buffer_load_dwordx4 v9, s[12:15], s33 offen offset:1024 lds
    s_add_u32 m0, s34, s42
    s_nop 0
    buffer_load_dwordx4 v10, s[12:15], s33 offen offset:0 lds
    buffer_load_dwordx4 v11, s[12:15], s33 offen offset:1024 lds
    s_add_u32 m0, s34, s43
    s_nop 0
    buffer_load_dwordx4 v12, s[12:15], s33 offen offset:0 lds
    buffer_load_dwordx4 v13, s[12:15], s33 offen offset:1024 lds
    s_add_u32 m0, s34, s44
    s_nop 0
    buffer_load_dwordx4 v14, s[12:15], s33 offen lds
    s_add_u32 s33, s33, 458752
    s_add_u32 s34, s34, 45056
    s_cmp_eq_u32 s34, 135168
    s_cselect_b32 s34, 0, s34
    s_add_u32 s20, s64, 0x3cc0000
    s_addc_u32 s21, s65, 0
    s_mov_b32 s22, 0x40000
    s_mov_b32 s23, 0x20000
    v_and_b32 v3, 0xff, v0
    v_lshrrev_b32 v2, 1, v3
    v_lshlrev_b32 v2, 3, v2
    v_and_b32 v3, 1, v3
    v_lshl_add_u32 v2, v3, 17, v2
    s_lshl_b32 s37, s4, 10
    buffer_load_dwordx2 v[44:45], v2, s[20:23], s37 offen sc1
    s_add_u32 s37, s37, 16384
    buffer_load_dwordx2 v[46:47], v2, s[20:23], s37 offen sc1
    s_add_u32 s37, s37, 16384
    buffer_load_dwordx2 v[48:49], v2, s[20:23], s37 offen sc1
    s_add_u32 s37, s37, 16384
    buffer_load_dwordx2 v[50:51], v2, s[20:23], s37 offen sc1
    s_add_u32 s37, s37, 16384
    buffer_load_dwordx2 v[52:53], v2, s[20:23], s37 offen sc1
    s_add_u32 s37, s37, 16384
    buffer_load_dwordx2 v[54:55], v2, s[20:23], s37 offen sc1
    s_add_u32 s37, s37, 16384
    buffer_load_dwordx2 v[56:57], v2, s[20:23], s37 offen sc1
    s_add_u32 s37, s37, 16384
    buffer_load_dwordx2 v[58:59], v2, s[20:23], s37 offen sc1
    s_waitcnt vmcnt(19)
    s_barrier
    s_add_u32 m0, s34, s40
    s_nop 0
    buffer_load_dwordx4 v4, s[8:11], s32 offen offset:0 sc1 lds
    buffer_load_dwordx4 v5, s[8:11], s32 offen offset:1024 sc1 lds
    buffer_load_dwordx4 v6, s[8:11], s32 offen offset:2048 sc1 lds
    buffer_load_dwordx4 v7, s[8:11], s32 offen offset:3072 sc1 lds
    s_add_u32 s32, s32, 128
    s_add_u32 m0, s34, s41
    s_nop 0
    buffer_load_dwordx4 v8, s[12:15], s33 offen offset:0 lds
    buffer_load_dwordx4 v9, s[12:15], s33 offen offset:1024 lds
    s_add_u32 m0, s34, s42
    s_nop 0
    buffer_load_dwordx4 v10, s[12:15], s33 offen offset:0 lds
    buffer_load_dwordx4 v11, s[12:15], s33 offen offset:1024 lds
    s_add_u32 m0, s34, s43
    s_nop 0
    buffer_load_dwordx4 v12, s[12:15], s33 offen offset:0 lds
    buffer_load_dwordx4 v13, s[12:15], s33 offen offset:1024 lds
    s_add_u32 m0, s34, s44
    s_nop 0
    buffer_load_dwordx4 v14, s[12:15], s33 offen lds
    s_add_u32 s33, s33, 458752
    s_add_u32 s34, s34, 45056
    s_cmp_eq_u32 s34, 135168
    s_cselect_b32 s34, 0, s34
    s_waitcnt vmcnt(19)
    s_barrier
    s_add_u32 m0, s34, s40
    s_nop 0
    buffer_load_dwordx4 v4, s[8:11], s32 offen offset:0 sc1 lds
    buffer_load_dwordx4 v5, s[8:11], s32 offen offset:1024 sc1 lds
    buffer_load_dwordx4 v6, s[8:11], s32 offen offset:2048 sc1 lds
    buffer_load_dwordx4 v7, s[8:11], s32 offen offset:3072 sc1 lds
    s_add_u32 s32, s32, 128
    s_add_u32 m0, s34, s41
    s_nop 0
    buffer_load_dwordx4 v8, s[12:15], s33 offen offset:0 lds
    buffer_load_dwordx4 v9, s[12:15], s33 offen offset:1024 lds
    s_add_u32 m0, s34, s42
    s_nop 0
    buffer_load_dwordx4 v10, s[12:15], s33 offen offset:0 lds
    buffer_load_dwordx4 v11, s[12:15], s33 offen offset:1024 lds
    s_add_u32 m0, s34, s43
    s_nop 0
    buffer_load_dwordx4 v12, s[12:15], s33 offen offset:0 lds
    buffer_load_dwordx4 v13, s[12:15], s33 offen offset:1024 lds
    s_add_u32 m0, s34, s44
    s_nop 0
    buffer_load_dwordx4 v14, s[12:15], s33 offen lds
    s_add_u32 s33, s33, 458752
    s_add_u32 s34, s34, 45056
    s_cmp_eq_u32 s34, 135168
    s_cselect_b32 s34, 0, s34
    s_add_u32 s28, s64, 0x3e84000
    s_addc_u32 s29, s65, 0
    s_mov_b32 s30, 0x3800
    s_mov_b32 s31, 0x20000
    v_and_b32 v24, 0xff, v0
    s_lshr_b32 s37, s5, 1
    s_mul_i32 s37, s37, 896
    s_and_b32 s66, s5, 1
    s_lshl_b32 s66, s66, 9
    s_add_u32 s37, s37, s66
    s_and_b32 s66, s5, 1
    s_mul_i32 s66, s66, -448
    s_add_u32 s66, s66, 384
    s_add_u32 s38, s37, s66
    s_sub_u32 s38, s38, 384
    v_mov_b32 v2, s37
    v_mov_b32 v3, s38
    v_cmp_le_u32 vcc, 192, v24
    s_nop 1
    v_cndmask_b32 v2, v2, v3, vcc
    v_lshl_add_u32 v2, v24, 1, v2
    v_lshlrev_b32 v2, 1, v2
    v_min_u32 v2, 14332, v2
    v_mov_b32 v60, v2
    buffer_load_dword v28, v2, s[28:31], 0 offen sc1
    s_waitcnt vmcnt(12)
    s_barrier
    s_add_u32 m0, s34, s40
    s_nop 0
    buffer_load_dwordx4 v4, s[8:11], s32 offen offset:0 sc1 lds
    buffer_load_dwordx4 v5, s[8:11], s32 offen offset:1024 sc1 lds
    buffer_load_dwordx4 v6, s[8:11], s32 offen offset:2048 sc1 lds
    buffer_load_dwordx4 v7, s[8:11], s32 offen offset:3072 sc1 lds
    s_add_u32 s32, s32, 128
    s_add_u32 m0, s34, s41
    s_nop 0
    buffer_load_dwordx4 v8, s[12:15], s33 offen offset:0 lds
    buffer_load_dwordx4 v9, s[12:15], s33 offen offset:1024 lds
    s_add_u32 m0, s34, s42
    s_nop 0
    buffer_load_dwordx4 v10, s[12:15], s33 offen offset:0 lds
    buffer_load_dwordx4 v11, s[12:15], s33 offen offset:1024 lds
    s_add_u32 m0, s34, s43
    s_nop 0
    buffer_load_dwordx4 v12, s[12:15], s33 offen offset:0 lds
    buffer_load_dwordx4 v13, s[12:15], s33 offen offset:1024 lds
    s_add_u32 m0, s34, s44
    s_nop 0
    buffer_load_dwordx4 v14, s[12:15], s33 offen lds
    s_add_u32 s33, s33, 458752
    s_add_u32 s34, s34, 45056
    s_cmp_eq_u32 s34, 135168
    s_cselect_b32 s34, 0, s34
    s_waitcnt vmcnt(12)
    s_barrier
    s_waitcnt vmcnt(11)
    s_setprio 1
    v_add_f32 v44, v44, v52
    v_add_f32 v45, v45, v53
    v_add_f32 v46, v46, v54
    v_add_f32 v47, v47, v55
    v_add_f32 v48, v48, v56
    v_add_f32 v49, v49, v57
    v_add_f32 v50, v50, v58
    v_add_f32 v51, v51, v59
    v_add_f32 v44, v44, v48
    v_add_f32 v45, v45, v49
    v_add_f32 v46, v46, v50
    v_add_f32 v47, v47, v51
    v_add_f32 v44, v44, v46
    v_add_f32 v45, v45, v47
    s_nop 0
    v_add_f32_dpp v44, v44, v44 quad_perm:[1,0,3,2] row_mask:0xf bank_mask:0xf
    v_add_f32_dpp v45, v45, v45 quad_perm:[1,0,3,2] row_mask:0xf bank_mask:0xf
    v_mul_f32 v48, 0xba800000, v44
    v_mul_f32 v49, 0x3a800000, v45
    v_fma_f32 v49, -v48, v48, v49
    v_max_f32 v49, 0, v49
    v_add_f32 v49, 0x3727c5ac, v49
    v_rsq_f32 v50, v49
    v_and_b32 v2, 0xfe, v0
    v_lshlrev_b32 v2, 1, v2
    v_add_u32 v2, 151552, v2
    ds_write_b32 v2, v48
    v_sqrt_f32 v51, v49
    v_mul_f32 v50, 0xbfb8aa3b, v50
    ds_write_b32 v2, v50 offset:512
    ds_write_b32 v2, v51 offset:1024
    v_lshlrev_b32 v2, 2, v24
    v_add_u32 v2, 154624, v2
    ds_write_b32 v2, v28
    s_setprio 0
    s_waitcnt lgkmcnt(0)
    s_waitcnt vmcnt(0)
    s_barrier
    s_waitcnt vmcnt(0) lgkmcnt(0)
    s_barrier
    s_and_b32 s86, s2, 1
    s_bfe_u32 s37, s2, 0x10001
    s_lshl_b32 s37, s37, 3
    s_bfe_u32 s38, s2, 0x30003
    s_add_u32 s4, s37, s38
    s_bfe_u32 s37, s2, 0x10002
    s_lshl_b32 s37, s37, 2
    s_lshr_b32 s38, s2, 6
    s_add_u32 s5, s37, s38
    s_add_u32 s8, s64, 0x4200000
    s_addc_u32 s9, s65, 0
    s_mov_b32 s10, 0xe00000
    s_mov_b32 s11, 0x20000
    s_mov_b32 s12, s58
    s_mov_b32 s13, s59
    s_mov_b32 s14, 0x700000
    s_mov_b32 s15, 0x20000
    s_mov_b32 s20, s64
    s_mov_b32 s21, s65
    s_mov_b32 s22, 0x400000
    s_mov_b32 s23, 0x20000
    s_lshl_b32 s37, s3, 4
    s_mul_i32 s37, s37, 2048
    s_mul_i32 s38, s5, 256
    s_add_u32 s37, s37, s38
    v_lshrrev_b32 v2, 3, v1
    v_mul_u32_u24 v2, 2048, v2
    v_add_u32 v2, s37, v2
    v_lshrrev_b32 v3, 3, v1
    v_and_b32 v3, 2, v3
    v_xor_b32 v3, v1, v3
    v_and_b32 v3, 7, v3
    v_lshl_add_u32 v8, v3, 4, v2
    v_lshl_add_u32 v10, v3, 4, v2
    v_add_u32 v10, 0x80, v10
    v_lshrrev_b32 v3, 3, v1
    v_and_b32 v3, 2, v3
    v_add_u32 v3, 4, v3
    v_xor_b32 v3, v1, v3
    v_and_b32 v3, 7, v3
    v_lshl_add_u32 v9, v3, 4, v2
    v_add_u32 v9, 0x3c00, v9
    v_lshl_add_u32 v11, v3, 4, v2
    v_add_u32 v11, 0x3c80, v11
    s_lshl_b32 s40, s3, 12
    s_lshl_b32 s41, s3, 11
    s_add_u32 s41, s41, 16384
    s_lshl_b32 s42, s3, 11
    s_add_u32 s42, s42, 24576
    s_mul_i32 s32, s86, 3584
    s_mul_i32 s33, s86, 3670016
    s_add_u32 m0, s41, 0
    s_nop 0
    buffer_load_dwordx4 v8, s[12:15], s33 offen offset:0 lds
    buffer_load_dwordx4 v9, s[12:15], s33 offen offset:1024 lds
    s_add_u32 m0, s42, 0
    s_nop 0
    buffer_load_dwordx4 v10, s[12:15], s33 offen offset:0 lds
    buffer_load_dwordx4 v11, s[12:15], s33 offen offset:1024 lds
    s_add_u32 s33, s33, 131072
    s_add_u32 m0, s41, 32768
    s_nop 0
    buffer_load_dwordx4 v8, s[12:15], s33 offen offset:0 lds
    buffer_load_dwordx4 v9, s[12:15], s33 offen offset:1024 lds
    s_add_u32 m0, s42, 32768
    s_nop 0
    buffer_load_dwordx4 v10, s[12:15], s33 offen offset:0 lds
    buffer_load_dwordx4 v11, s[12:15], s33 offen offset:1024 lds
    s_add_u32 s33, s33, 131072
    s_add_u32 m0, s41, 65536
    s_nop 0
    buffer_load_dwordx4 v8, s[12:15], s33 offen offset:0 lds
    buffer_load_dwordx4 v9, s[12:15], s33 offen offset:1024 lds
    s_add_u32 m0, s42, 65536
    s_nop 0
    buffer_load_dwordx4 v10, s[12:15], s33 offen offset:0 lds
    buffer_load_dwordx4 v11, s[12:15], s33 offen offset:1024 lds
    s_add_u32 s33, s33, 131072
    s_lshl_b32 s37, s4, 7
    s_lshl_b32 s38, s3, 5
    s_add_u32 s37, s37, s38
    s_mul_i32 s37, s37, 7168
    v_lshrrev_b32 v2, 3, v1
    v_mul_u32_u24 v2, 7168, v2
    v_add_u32 v2, s37, v2
    v_lshrrev_b32 v3, 4, v1
    v_xor_b32 v3, v1, v3
    v_and_b32 v3, 7, v3
    v_lshl_add_u32 v4, v3, 4, v2
    v_lshrrev_b32 v3, 4, v1
    v_add_u32 v3, 4, v3
    v_xor_b32 v3, v1, v3
    v_and_b32 v3, 7, v3
    v_lshl_add_u32 v5, v3, 4, v2
    v_add_u32 v5, 0xdc00, v5
    v_lshrrev_b32 v3, 4, v1
    v_xor_b32 v3, v1, v3
    v_and_b32 v3, 7, v3
    v_lshl_add_u32 v6, v3, 4, v2
    v_add_u32 v6, 0x1b800, v6
    v_lshrrev_b32 v3, 4, v1
    v_add_u32 v3, 4, v3
    v_xor_b32 v3, v1, v3
    v_and_b32 v3, 7, v3
    v_lshl_add_u32 v7, v3, 4, v2
    v_add_u32 v7, 0x29400, v7
    s_lshl_b32 s37, s4, 7
    s_and_b32 s38, s3, 1
    s_lshl_b32 s38, s38, 6
    s_add_u32 s37, s37, s38
    s_lshl_b32 s38, s86, 5
    s_add_u32 s37, s37, s38
    s_mul_i32 s37, s37, 2048
    v_lshrrev_b32 v2, 3, v1
    v_mul_u32_u24 v2, 2048, v2
    v_add_u32 v2, s37, v2
    v_lshrrev_b32 v3, 4, v1
    v_xor_b32 v3, v1, v3
    v_and_b32 v3, 7, v3
    v_lshl_add_u32 v15, v3, 4, v2
    v_lshrrev_b32 v3, 4, v1
    v_add_u32 v3, 4, v3
    v_xor_b32 v3, v1, v3
    v_and_b32 v3, 7, v3
    v_lshl_add_u32 v16, v3, 4, v2
    v_add_u32 v16, 0x3c00, v16
    v_lshrrev_b32 v3, 4, v1
    v_xor_b32 v3, v1, v3
    v_and_b32 v3, 7, v3
    v_lshl_add_u32 v17, v3, 4, v2
    v_add_u32 v17, 0x7800, v17
    v_lshrrev_b32 v3, 4, v1
    v_add_u32 v3, 4, v3
    v_xor_b32 v3, v1, v3
    v_and_b32 v3, 7, v3
    v_lshl_add_u32 v18, v3, 4, v2
    v_add_u32 v18, 0xb400, v18
    s_barrier
    s_cmp_lg_u32 s3, 0
    s_cbranch_scc1 L_np_99
    s_lshl_b32 s67, s4, 12
    s_add_u32 s67, s67, 524288
    v_and_b32 v19, 15, v1
    v_lshlrev_b32 v19, 7, v19
    s_mov_b32 s68, 400000
L_poll_100:
    buffer_load_dword v20, v19, s[88:91], s67 offen sc1
    s_waitcnt vmcnt(0)
    v_cmp_ne_u32 vcc, 0, v20
    s_nop 0
    s_cmp_eq_u64 vcc, -1
    s_cbranch_scc1 L_polld_101
    s_sleep 1
    s_sub_u32 s68, s68, 1
    s_cmp_lg_u32 s68, 0
    s_cbranch_scc1 L_poll_100
    s_mov_b32 s92, s62
    s_mov_b32 s93, s63
    s_mov_b32 s94, 256
    s_mov_b32 s95, 0x20000
    v_mov_b32 v20, 275
    v_mov_b32 v19, 0
    buffer_store_dword v20, v19, s[92:95], 0 offen
L_polld_101:
L_np_99:
    s_barrier
    s_mov_b32 s34, 0
    s_add_u32 m0, s40, 0
    s_nop 0
    buffer_load_dwordx4 v4, s[8:11], s32 offen offset:0 sc1 lds
    buffer_load_dwordx4 v5, s[8:11], s32 offen offset:1024 sc1 lds
    buffer_load_dwordx4 v6, s[8:11], s32 offen offset:2048 sc1 lds
    buffer_load_dwordx4 v7, s[8:11], s32 offen offset:3072 sc1 lds
    s_add_u32 s32, s32, 128
    s_add_u32 m0, s40, 32768
    s_nop 0
    buffer_load_dwordx4 v4, s[8:11], s32 offen offset:0 sc1 lds
    buffer_load_dwordx4 v5, s[8:11], s32 offen offset:1024 sc1 lds
    buffer_load_dwordx4 v6, s[8:11], s32 offen offset:2048 sc1 lds
    buffer_load_dwordx4 v7, s[8:11], s32 offen offset:3072 sc1 lds
    s_add_u32 s32, s32, 128
    s_waitcnt vmcnt(4)
    s_barrier
    s_add_u32 m0, s40, 65536
    s_nop 0
    buffer_load_dwordx4 v4, s[8:11], s32 offen offset:0 sc1 lds
    buffer_load_dwordx4 v5, s[8:11], s32 offen offset:1024 sc1 lds
    buffer_load_dwordx4 v6, s[8:11], s32 offen offset:2048 sc1 lds
    buffer_load_dwordx4 v7, s[8:11], s32 offen offset:3072 sc1 lds
    s_add_u32 s32, s32, 128
    s_waitcnt vmcnt(4)
    s_barrier
    s_mov_b32 s35, 24
L_ld_102:
    s_add_u32 m0, s34, s40
    s_nop 0
    buffer_load_dwordx4 v4, s[8:11], s32 offen offset:0 sc1 lds
    buffer_load_dwordx4 v5, s[8:11], s32 offen offset:1024 sc1 lds
    buffer_load_dwordx4 v6, s[8:11], s32 offen offset:2048 sc1 lds
    buffer_load_dwordx4 v7, s[8:11], s32 offen offset:3072 sc1 lds
    s_add_u32 s32, s32, 128
    s_add_u32 m0, s34, s41
    s_nop 0
    buffer_load_dwordx4 v8, s[12:15], s33 offen offset:0 lds
    buffer_load_dwordx4 v9, s[12:15], s33 offen offset:1024 lds
    s_add_u32 m0, s34, s42
    s_nop 0
    buffer_load_dwordx4 v10, s[12:15], s33 offen offset:0 lds
    buffer_load_dwordx4 v11, s[12:15], s33 offen offset:1024 lds
    s_add_u32 s33, s33, 131072
    s_add_u32 s34, s34, 32768
    s_cmp_eq_u32 s34, 98304
    s_cselect_b32 s34, 0, s34
    s_waitcnt vmcnt(8)
    s_barrier
    s_sub_u32 s35, s35, 1
    s_cmp_lg_u32 s35, 0
    s_cbranch_scc1 L_ld_102
    s_add_u32 m0, s34, s40
    s_nop 0
    buffer_load_dwordx4 v4, s[8:11], s32 offen offset:0 sc1 lds
    buffer_load_dwordx4 v5, s[8:11], s32 offen offset:1024 sc1 lds
    buffer_load_dwordx4 v6, s[8:11], s32 offen offset:2048 sc1 lds
    buffer_load_dwordx4 v7, s[8:11], s32 offen offset:3072 sc1 lds
    s_add_u32 s32, s32, 128
    s_add_u32 m0, s34, s41
    s_nop 0
    buffer_load_dwordx4 v8, s[12:15], s33 offen offset:0 lds
    buffer_load_dwordx4 v9, s[12:15], s33 offen offset:1024 lds
    s_add_u32 m0, s34, s42
    s_nop 0
    buffer_load_dwordx4 v10, s[12:15], s33 offen offset:0 lds
    buffer_load_dwordx4 v11, s[12:15], s33 offen offset:1024 lds
    s_add_u32 s33, s33, 131072
    s_add_u32 s34, s34, 32768
    s_cmp_eq_u32 s34, 98304
    s_cselect_b32 s34, 0, s34
    s_lshl_b32 s37, s5, 8
    s_lshr_b32 s38, s3, 1
    s_lshl_b32 s38, s38, 7
    s_add_u32 s37, s37, s38
    s_lshl_b32 s38, s3, 12
    s_add_u32 m0, s38, 135168
    s_nop 0
    buffer_load_dwordx4 v15, s[20:23], s37 offen offset:0 sc1 lds
    buffer_load_dwordx4 v16, s[20:23], s37 offen offset:1024 sc1 lds
    buffer_load_dwordx4 v17, s[20:23], s37 offen offset:2048 sc1 lds
    buffer_load_dwordx4 v18, s[20:23], s37 offen offset:3072 sc1 lds
    s_waitcnt vmcnt(12)
    s_barrier
    s_waitcnt vmcnt(4)
    s_barrier
    s_waitcnt vmcnt(0) lgkmcnt(0)
    s_barrier
    s_barrier
L_end_1:
    s_endpgm
L_kernel_end:
.section .rodata,"a"
.p2align 6
.amdhsa_kernel interleave_layers__linear_attn_block__dense_activation_silu__prompt_kernel
  .amdhsa_next_free_vgpr 256
  .amdhsa_next_free_sgpr 102
  .amdhsa_accum_offset 256
  .amdhsa_group_segment_fixed_size 0
  .amdhsa_kernarg_size 72
  .amdhsa_user_sgpr_count 2
  .amdhsa_user_sgpr_kernarg_segment_ptr 1
  .amdhsa_system_sgpr_workgroup_id_x 1
.end_amdhsa_kernel
```
